```python
import torch

def _softmax(x, axis=-1):
    return torch.softmax(x, dim=axis)
def _gelu(x):
    return torch.nn.functional.gelu(x, approximate="tanh")
def _silu(x):
    return torch.nn.functional.silu(x)
def _sigmoid(x):
    return torch.sigmoid(x)
def _layernorm(x, axis=-1, eps=1e-5):
    m = x.mean(dim=axis, keepdim=True)
    v = x.var(dim=axis, keepdim=True, unbiased=False)
    return (x - m) / torch.sqrt(v + eps)
def _scatter_add(tgt, idx, src, axis=0):
    return tgt.clone().index_add_(axis, idx, src)
def _segment_sum(src, seg, n):
    out = torch.zeros((n,) + src.shape[1:], dtype=src.dtype)
    return out.index_add_(0, seg, src)
def _pad(x, pw):
    flat = tuple(v for pair in reversed(pw) for v in pair)
    return torch.nn.functional.pad(x, flat)

kernel_name = 'interleave_layers__grouped_kv_mqa__dense_activation_relu__prompt'

def setup_inputs():

    _w = (lambda a: (lambda t: t.to(torch.bfloat16) if t.is_floating_point() else t)(torch.as_tensor(a)))
    def _A_setup():
        B, S, D, H = 1, 2048, 512, 32
        Dh = D // H
        return {
            "x": _w((lambda *s: torch.randn(*s, dtype=torch.bfloat16) * 0.05)(B, S, D)),
            "wq": _w((lambda *s: torch.randn(*s, dtype=torch.bfloat16) * 0.05)(D, H * Dh)),
            "wk": _w((lambda *s: torch.randn(*s, dtype=torch.bfloat16) * 0.05)(D, Dh)),
            "wv": _w((lambda *s: torch.randn(*s, dtype=torch.bfloat16) * 0.05)(D, Dh)),
            "wo": _w((lambda *s: torch.randn(*s, dtype=torch.bfloat16) * 0.05)(H * Dh, D)),
        }
    _A_in = _A_setup()

    def _B_setup():
        B, S, D, Dff = 1, 2048, 512, 1792
        return {
            "x": _w((lambda *s: torch.randn(*s, dtype=torch.bfloat16) * 0.05)(B, S, D)),
            "w1": _w((lambda *s: torch.randn(*s, dtype=torch.bfloat16) * 0.05)(D, Dff)),
            "w2": _w((lambda *s: torch.randn(*s, dtype=torch.bfloat16) * 0.05)(Dff, D)),
        }
    _B_in = _B_setup()

    return {
        "A_x": _A_in["x"],
        "A_wq": _A_in["wq"],
        "A_wk": _A_in["wk"],
        "A_wv": _A_in["wv"],
        "A_wo": _A_in["wo"],
        "B_x": _B_in["x"],
        "B_w1": _B_in["w1"],
        "B_w2": _B_in["w2"],
    }

def reference(A_x, A_wq, A_wk, A_wv, A_wo, B_x, B_w1, B_w2):
    def _A_ref(x, wq, wk, wv, wo):
        B, S, D = x.shape
        H = 32
        Dh = D // H
        q = (lambda x, *d: x.permute(*d))((x @ wq).reshape(B, S, H, Dh), 0, 2, 1, 3)
        k = x @ wk
        v = x @ wv
        scores = torch.einsum("bhqd,bkd->bhqk", q, k) * (Dh ** -0.5)
        p = _softmax(scores, axis=-1)
        o = torch.einsum("bhqk,bkd->bhqd", p, v)
        return (lambda x, *d: x.permute(*d))(o, 0, 2, 1, 3).reshape(B, S, H * Dh) @ wo

    def _B_ref(x, w1, w2):
        h = torch.einsum("bsd,df->bsf", x, w1)
        zero = torch.zeros_like(h)
        h = torch.maximum(h, zero)
        return torch.einsum("bsf,fd->bsd", h, w2)

    x = A_x
    x = x + _A_ref(_layernorm(x, axis=-1), A_wq, A_wk, A_wv, A_wo)
    x = x + _B_ref(_layernorm(x, axis=-1), B_w1, B_w2)
    x = x + _A_ref(_layernorm(x, axis=-1), A_wq, A_wk, A_wv, A_wo)
    x = x + _B_ref(_layernorm(x, axis=-1), B_w1, B_w2)
    return x
```

```asm
; @launch kernel=k0_kernel grid=(256,1,1) block=(1024,1,1) lds=152576
; @launch kernel=f1_kernel grid=(256,1,1) block=(512,1,1) lds=157760
; @launch kernel=f2_kernel grid=(256,1,1) block=(512,1,1) lds=157760
.amdgcn_target "amdgcn-amd-amdhsa--gfx950"
.text
.globl k0_kernel
.p2align 8
.type k0_kernel,@function
k0_kernel:
    s_cmp_ge_u32 s2, 256
    s_cbranch_scc1 k0_kernel_endx
    s_load_dwordx16 s[16:31], s[0:1], 0
    s_load_dwordx2 s[6:7], s[0:1], 80
    v_and_b32 v1, 63, v0
    v_lshrrev_b32 v2, 6, v0
    v_and_b32 v3, 31, v1
    v_readfirstlane_b32 s60, v2
    v_lshrrev_b32 v4, 5, v1
    v_lshlrev_b32 v2, 4, v1
    s_and_b32 s4, s2, 31
    s_lshr_b32 s5, s2, 5
    s_and_b32 s3, s60, 7
    s_mov_b32 s61, 0x3f803f80
    s_waitcnt lgkmcnt(0)
    s_mov_b32 s8, s6
    s_mov_b32 s9, s7
    s_mov_b32 s10, 0x4400000
    s_mov_b32 s11, 0x00020000
    s_cmp_ge_u32 s60, 8
    s_cbranch_scc1 K0_prep
    s_mov_b32 s12, s16
    s_mov_b32 s13, s17
    s_mov_b32 s14, 0x200000
    s_mov_b32 s15, 0x00020000
    s_mov_b32 s48, s18
    s_mov_b32 s49, s19
    s_mov_b32 s50, 0x80000
    s_mov_b32 s51, 0x00020000
    s_cmp_ge_u32 s5, 2
    s_cbranch_scc1 K0_nokv
    s_cmp_eq_u32 s5, 0
    s_cselect_b32 s52, s20, s22
    s_cselect_b32 s53, s21, s23
    s_mov_b32 s54, 16384
    s_mov_b32 s55, 0x00020000
    s_lshl_b32 s32, s3, 11
    s_add_u32 m0, s32, 131072
    s_nop 0
    buffer_load_dwordx4 v2, s[52:55], s32 offen lds
    buffer_load_dwordx4 v2, s[52:55], s32 offen offset:1024 lds
K0_nokv:
    s_lshl_b32 s32, s4, 16
    s_lshl_b32 s33, s3, 13
    s_add_u32 s32, s32, s33
    s_add_u32 s33, s33, 65536
    s_and_b32 s35, s3, 1
    s_lshl_b32 s35, s35, 7
    v_xor_b32 v7, s35, v2
    v_xor_b32 v5, 0, v7
    s_add_u32 m0, s33, 0
    s_add_u32 s34, s32, 0
    buffer_load_dwordx4 v5, s[12:15], s34 offen lds
    v_xor_b32 v5, 16, v7
    s_add_u32 m0, s33, 1024
    s_add_u32 s34, s32, 1024
    buffer_load_dwordx4 v5, s[12:15], s34 offen lds
    v_xor_b32 v5, 32, v7
    s_add_u32 m0, s33, 2048
    s_add_u32 s34, s32, 2048
    buffer_load_dwordx4 v5, s[12:15], s34 offen lds
    v_xor_b32 v5, 48, v7
    s_add_u32 m0, s33, 3072
    s_add_u32 s34, s32, 3072
    buffer_load_dwordx4 v5, s[12:15], s34 offen lds
    v_xor_b32 v5, 64, v7
    s_add_u32 m0, s33, 4096
    s_add_u32 s34, s32, 4096
    buffer_load_dwordx4 v5, s[12:15], s34 offen lds
    v_xor_b32 v5, 80, v7
    s_add_u32 m0, s33, 5120
    s_add_u32 s34, s32, 5120
    buffer_load_dwordx4 v5, s[12:15], s34 offen lds
    v_xor_b32 v5, 96, v7
    s_add_u32 m0, s33, 6144
    s_add_u32 s34, s32, 6144
    buffer_load_dwordx4 v5, s[12:15], s34 offen lds
    v_xor_b32 v5, 112, v7
    s_add_u32 m0, s33, 7168
    s_add_u32 s34, s32, 7168
    buffer_load_dwordx4 v5, s[12:15], s34 offen lds
    v_lshrrev_b32 v6, 3, v1
    v_lshlrev_b32 v6, 10, v6
    v_and_b32 v7, 7, v1
    v_lshl_add_u32 v6, v7, 4, v6
    s_lshl_b32 s32, s3, 16
    s_lshl_b32 s33, s5, 7
    s_add_u32 s32, s32, s33
    s_lshl_b32 s33, s3, 13
    s_add_u32 m0, s33, 0
    s_add_u32 s34, s32, 0
    buffer_load_dwordx4 v6, s[48:51], s34 offen lds
    s_add_u32 m0, s33, 1024
    s_add_u32 s34, s32, 8192
    buffer_load_dwordx4 v6, s[48:51], s34 offen lds
    s_add_u32 m0, s33, 2048
    s_add_u32 s34, s32, 16384
    buffer_load_dwordx4 v6, s[48:51], s34 offen lds
    s_add_u32 m0, s33, 3072
    s_add_u32 s34, s32, 24576
    buffer_load_dwordx4 v6, s[48:51], s34 offen lds
    s_add_u32 m0, s33, 4096
    s_add_u32 s34, s32, 32768
    buffer_load_dwordx4 v6, s[48:51], s34 offen lds
    s_add_u32 m0, s33, 5120
    s_add_u32 s34, s32, 40960
    buffer_load_dwordx4 v6, s[48:51], s34 offen lds
    s_add_u32 m0, s33, 6144
    s_add_u32 s34, s32, 49152
    buffer_load_dwordx4 v6, s[48:51], s34 offen lds
    s_add_u32 m0, s33, 7168
    s_add_u32 s34, s32, 57344
    buffer_load_dwordx4 v6, s[48:51], s34 offen lds
    s_and_b32 s43, s3, 1
    s_lshr_b32 s44, s3, 1
    s_lshl_b32 s45, s4, 1
    s_add_u32 s45, s45, s43
    s_lshl_b32 s46, s5, 1
    s_add_u32 s46, s46, s44
    s_lshl_b32 s42, s45, 5
    s_lshl_b32 s32, s46, 1
    s_add_u32 s42, s42, s32
    s_lshl_b32 s42, s42, 10
    s_add_u32 s42, s42, 0x700000
    s_mul_i32 s47, s45, 2176
    s_add_u32 s47, s47, 0x1800000
    s_cmp_lt_u32 s3, 4
    s_cselect_b32 s32, s42, s47
    v_min_u32 v5, 16, v1
    v_lshlrev_b32 v5, 7, v5
    buffer_load_dword v0, v5, s[8:11], s32 offen
    v_and_b32 v5, 15, v3
    v_xor_b32 v5, v5, v4
    v_lshlrev_b32 v5, 4, v5
    v_lshl_add_u32 v5, v3, 10, v5
    s_lshl_b32 s32, s43, 15
    s_add_u32 s32, s32, 65536
    v_add_u32 v5, s32, v5
    v_xor_b32 v120, 0, v5
    v_xor_b32 v121, 32, v5
    v_xor_b32 v122, 64, v5
    v_xor_b32 v123, 96, v5
    v_xor_b32 v124, 128, v5
    v_xor_b32 v125, 160, v5
    v_xor_b32 v126, 192, v5
    v_xor_b32 v127, 224, v5
    v_lshrrev_b32 v5, 5, v1
    v_lshlrev_b32 v5, 2, v5
    v_bfe_u32 v6, v1, 2, 2
    v_add_u32 v5, v5, v6
    v_mul_u32_u24 v118, 128, v5
    v_bfe_u32 v5, v1, 4, 1
    v_lshlrev_b32 v5, 5, v5
    v_and_b32 v6, 3, v1
    v_lshlrev_b32 v6, 3, v6
    v_add3_u32 v118, v118, v5, v6
    v_lshl_add_u32 v118, v4, 9, v118
    s_lshl_b32 s32, s44, 6
    v_add_u32 v118, s32, v118
    v_lshlrev_b32 v5, 3, v4
    v_bfe_u32 v6, v1, 2, 2
    v_add_u32 v5, v5, v6
    v_lshlrev_b32 v5, 5, v5
    v_and_b32 v6, 3, v1
    v_lshl_add_u32 v5, v6, 3, v5
    v_add_u32 v119, 131072, v5
    v_lshrrev_b32 v5, 3, v1
    v_lshlrev_b32 v5, 10, v5
    v_and_b32 v6, 7, v1
    v_lshl_add_u32 v5, v6, 4, v5
    s_lshl_b32 s32, s3, 13
    s_add_u32 s32, s32, 65536
    v_add_u32 v5, s32, v5
    v_mov_b32 v8, 0
    v_mov_b32 v9, 0
    v_mov_b32 v10, 0
    v_mov_b32 v11, 0
    v_mov_b32 v12, 0
    v_mov_b32 v13, 0
    v_mov_b32 v14, 0
    v_mov_b32 v15, 0
    s_waitcnt vmcnt(9)
    ds_read_b128 v[16:19], v5 offset:0
    ds_read_b128 v[20:23], v5 offset:128
    ds_read_b128 v[24:27], v5 offset:256
    ds_read_b128 v[28:31], v5 offset:384
    ds_read_b128 v[32:35], v5 offset:512
    ds_read_b128 v[36:39], v5 offset:640
    ds_read_b128 v[40:43], v5 offset:768
    ds_read_b128 v[44:47], v5 offset:896
    s_waitcnt lgkmcnt(7)
    v_dot2_f32_bf16 v8, v16, s61, v8
    v_dot2_f32_bf16 v12, v16, v16, v12
    v_dot2_f32_bf16 v9, v17, s61, v9
    v_dot2_f32_bf16 v13, v17, v17, v13
    v_dot2_f32_bf16 v10, v18, s61, v10
    v_dot2_f32_bf16 v14, v18, v18, v14
    v_dot2_f32_bf16 v11, v19, s61, v11
    v_dot2_f32_bf16 v15, v19, v19, v15
    s_waitcnt lgkmcnt(6)
    v_dot2_f32_bf16 v8, v20, s61, v8
    v_dot2_f32_bf16 v12, v20, v20, v12
    v_dot2_f32_bf16 v9, v21, s61, v9
    v_dot2_f32_bf16 v13, v21, v21, v13
    v_dot2_f32_bf16 v10, v22, s61, v10
    v_dot2_f32_bf16 v14, v22, v22, v14
    v_dot2_f32_bf16 v11, v23, s61, v11
    v_dot2_f32_bf16 v15, v23, v23, v15
    s_waitcnt lgkmcnt(5)
    v_dot2_f32_bf16 v8, v24, s61, v8
    v_dot2_f32_bf16 v12, v24, v24, v12
    v_dot2_f32_bf16 v9, v25, s61, v9
    v_dot2_f32_bf16 v13, v25, v25, v13
    v_dot2_f32_bf16 v10, v26, s61, v10
    v_dot2_f32_bf16 v14, v26, v26, v14
    v_dot2_f32_bf16 v11, v27, s61, v11
    v_dot2_f32_bf16 v15, v27, v27, v15
    s_waitcnt lgkmcnt(4)
    v_dot2_f32_bf16 v8, v28, s61, v8
    v_dot2_f32_bf16 v12, v28, v28, v12
    v_dot2_f32_bf16 v9, v29, s61, v9
    v_dot2_f32_bf16 v13, v29, v29, v13
    v_dot2_f32_bf16 v10, v30, s61, v10
    v_dot2_f32_bf16 v14, v30, v30, v14
    v_dot2_f32_bf16 v11, v31, s61, v11
    v_dot2_f32_bf16 v15, v31, v31, v15
    s_waitcnt lgkmcnt(3)
    v_dot2_f32_bf16 v8, v32, s61, v8
    v_dot2_f32_bf16 v12, v32, v32, v12
    v_dot2_f32_bf16 v9, v33, s61, v9
    v_dot2_f32_bf16 v13, v33, v33, v13
    v_dot2_f32_bf16 v10, v34, s61, v10
    v_dot2_f32_bf16 v14, v34, v34, v14
    v_dot2_f32_bf16 v11, v35, s61, v11
    v_dot2_f32_bf16 v15, v35, v35, v15
    s_waitcnt lgkmcnt(2)
    v_dot2_f32_bf16 v8, v36, s61, v8
    v_dot2_f32_bf16 v12, v36, v36, v12
    v_dot2_f32_bf16 v9, v37, s61, v9
    v_dot2_f32_bf16 v13, v37, v37, v13
    v_dot2_f32_bf16 v10, v38, s61, v10
    v_dot2_f32_bf16 v14, v38, v38, v14
    v_dot2_f32_bf16 v11, v39, s61, v11
    v_dot2_f32_bf16 v15, v39, v39, v15
    s_waitcnt lgkmcnt(1)
    v_dot2_f32_bf16 v8, v40, s61, v8
    v_dot2_f32_bf16 v12, v40, v40, v12
    v_dot2_f32_bf16 v9, v41, s61, v9
    v_dot2_f32_bf16 v13, v41, v41, v13
    v_dot2_f32_bf16 v10, v42, s61, v10
    v_dot2_f32_bf16 v14, v42, v42, v14
    v_dot2_f32_bf16 v11, v43, s61, v11
    v_dot2_f32_bf16 v15, v43, v43, v15
    s_waitcnt lgkmcnt(0)
    v_dot2_f32_bf16 v8, v44, s61, v8
    v_dot2_f32_bf16 v12, v44, v44, v12
    v_dot2_f32_bf16 v9, v45, s61, v9
    v_dot2_f32_bf16 v13, v45, v45, v13
    v_dot2_f32_bf16 v10, v46, s61, v10
    v_dot2_f32_bf16 v14, v46, v46, v14
    v_dot2_f32_bf16 v11, v47, s61, v11
    v_dot2_f32_bf16 v15, v47, v47, v15
    s_nop 2
    v_add_f32 v8, v8, v9
    v_add_f32 v10, v10, v11
    v_add_f32 v8, v8, v10
    v_add_f32 v12, v12, v13
    v_add_f32 v14, v14, v15
    v_add_f32 v12, v12, v14
    ds_swizzle_b32 v9, v8 offset:0x41f
    ds_swizzle_b32 v13, v12 offset:0x41f
    s_waitcnt lgkmcnt(0)
    v_add_f32 v8, v8, v9
    v_add_f32 v12, v12, v13
    ds_swizzle_b32 v9, v8 offset:0x81f
    ds_swizzle_b32 v13, v12 offset:0x81f
    s_waitcnt lgkmcnt(0)
    v_add_f32 v8, v8, v9
    v_add_f32 v12, v12, v13
    ds_swizzle_b32 v9, v8 offset:0x101f
    ds_swizzle_b32 v13, v12 offset:0x101f
    s_waitcnt lgkmcnt(0)
    v_add_f32 v8, v8, v9
    v_add_f32 v12, v12, v13
    v_mul_f32 v8, 0x3b000000, v8
    v_mul_f32 v12, 0x3b000000, v12
    v_fma_f32 v12, -v8, v8, v12
    v_max_f32 v12, 0, v12
    v_add_f32 v12, 0x3727c5ac, v12
    v_rsq_f32 v12, v12
    s_nop 0
    v_mul_f32 v13, v8, v12
    v_sub_f32 v13, 0, v13
    s_lshr_b32 s32, s3, 2
    s_lshl_b32 s32, s32, 8
    s_and_b32 s33, s3, 3
    s_lshl_b32 s33, s33, 5
    s_add_u32 s32, s32, s33
    s_add_u32 s32, s32, 147456
    v_lshrrev_b32 v5, 3, v1
    v_lshlrev_b32 v5, 2, v5
    v_add_u32 v5, s32, v5
    ds_write_b32 v5, v12
    ds_write_b32 v5, v13 offset:128
    s_lshl_b32 s32, s44, 6
    v_subrev_u32 v6, s32, v118
    s_lshl_b32 s32, s3, 13
    v_add_u32 v6, s32, v6
    s_lshl_b32 s32, s3, 11
    v_add_u32 v7, s32, v119
    v_mov_b32 v8, 0
    v_mov_b32 v9, 0
    v_mov_b32 v10, 0
    ds_read_b64_tr_b16 v[48:49], v7 offset:0
    ds_read_b64_tr_b16 v[50:51], v7 offset:128
    ds_read_b64_tr_b16 v[52:53], v7 offset:512
    ds_read_b64_tr_b16 v[54:55], v7 offset:640
    ds_read_b64_tr_b16 v[56:57], v7 offset:1024
    ds_read_b64_tr_b16 v[58:59], v7 offset:1152
    ds_read_b64_tr_b16 v[60:61], v7 offset:1536
    ds_read_b64_tr_b16 v[62:63], v7 offset:1664
    s_waitcnt lgkmcnt(0)
    v_dot2_f32_bf16 v10, v48, s61, v10
    v_dot2_f32_bf16 v10, v49, s61, v10
    v_dot2_f32_bf16 v10, v50, s61, v10
    v_dot2_f32_bf16 v10, v51, s61, v10
    v_dot2_f32_bf16 v10, v52, s61, v10
    v_dot2_f32_bf16 v10, v53, s61, v10
    v_dot2_f32_bf16 v10, v54, s61, v10
    v_dot2_f32_bf16 v10, v55, s61, v10
    v_dot2_f32_bf16 v10, v56, s61, v10
    v_dot2_f32_bf16 v10, v57, s61, v10
    v_dot2_f32_bf16 v10, v58, s61, v10
    v_dot2_f32_bf16 v10, v59, s61, v10
    v_dot2_f32_bf16 v10, v60, s61, v10
    v_dot2_f32_bf16 v10, v61, s61, v10
    v_dot2_f32_bf16 v10, v62, s61, v10
    v_dot2_f32_bf16 v10, v63, s61, v10
    s_waitcnt vmcnt(1)
    ds_read_b64_tr_b16 v[16:17], v6 offset:0
    ds_read_b64_tr_b16 v[18:19], v6 offset:512
    ds_read_b64_tr_b16 v[20:21], v6 offset:2048
    ds_read_b64_tr_b16 v[22:23], v6 offset:2560
    ds_read_b64_tr_b16 v[24:25], v6 offset:4096
    ds_read_b64_tr_b16 v[26:27], v6 offset:4608
    ds_read_b64_tr_b16 v[28:29], v6 offset:6144
    ds_read_b64_tr_b16 v[30:31], v6 offset:6656
    ds_read_b64_tr_b16 v[32:33], v6 offset:64
    ds_read_b64_tr_b16 v[34:35], v6 offset:576
    ds_read_b64_tr_b16 v[36:37], v6 offset:2112
    ds_read_b64_tr_b16 v[38:39], v6 offset:2624
    ds_read_b64_tr_b16 v[40:41], v6 offset:4160
    ds_read_b64_tr_b16 v[42:43], v6 offset:4672
    ds_read_b64_tr_b16 v[44:45], v6 offset:6208
    ds_read_b64_tr_b16 v[46:47], v6 offset:6720
    s_waitcnt lgkmcnt(8)
    v_dot2_f32_bf16 v8, v16, s61, v8
    v_dot2_f32_bf16 v8, v17, s61, v8
    v_dot2_f32_bf16 v8, v18, s61, v8
    v_dot2_f32_bf16 v8, v19, s61, v8
    v_dot2_f32_bf16 v8, v20, s61, v8
    v_dot2_f32_bf16 v8, v21, s61, v8
    v_dot2_f32_bf16 v8, v22, s61, v8
    v_dot2_f32_bf16 v8, v23, s61, v8
    v_dot2_f32_bf16 v8, v24, s61, v8
    v_dot2_f32_bf16 v8, v25, s61, v8
    v_dot2_f32_bf16 v8, v26, s61, v8
    v_dot2_f32_bf16 v8, v27, s61, v8
    v_dot2_f32_bf16 v8, v28, s61, v8
    v_dot2_f32_bf16 v8, v29, s61, v8
    v_dot2_f32_bf16 v8, v30, s61, v8
    v_dot2_f32_bf16 v8, v31, s61, v8
    s_waitcnt lgkmcnt(0)
    v_dot2_f32_bf16 v9, v32, s61, v9
    v_dot2_f32_bf16 v9, v33, s61, v9
    v_dot2_f32_bf16 v9, v34, s61, v9
    v_dot2_f32_bf16 v9, v35, s61, v9
    v_dot2_f32_bf16 v9, v36, s61, v9
    v_dot2_f32_bf16 v9, v37, s61, v9
    v_dot2_f32_bf16 v9, v38, s61, v9
    v_dot2_f32_bf16 v9, v39, s61, v9
    v_dot2_f32_bf16 v9, v40, s61, v9
    v_dot2_f32_bf16 v9, v41, s61, v9
    v_dot2_f32_bf16 v9, v42, s61, v9
    v_dot2_f32_bf16 v9, v43, s61, v9
    v_dot2_f32_bf16 v9, v44, s61, v9
    v_dot2_f32_bf16 v9, v45, s61, v9
    v_dot2_f32_bf16 v9, v46, s61, v9
    v_dot2_f32_bf16 v9, v47, s61, v9
    s_nop 2
    v_mov_b32 v11, v8
    s_nop 1
    v_permlane32_swap_b32 v8, v11
    s_nop 0
    v_add_f32 v8, v8, v11
    v_mov_b32 v11, v9
    s_nop 1
    v_permlane32_swap_b32 v9, v11
    s_nop 0
    v_add_f32 v9, v9, v11
    v_mov_b32 v11, v10
    s_nop 1
    v_permlane32_swap_b32 v10, v11
    s_nop 0
    v_add_f32 v10, v10, v11
    s_mul_i32 s32, s3, 384
    s_add_u32 s32, s32, 148480
    v_lshlrev_b32 v5, 2, v3
    v_add_u32 v5, s32, v5
    ds_write_b32 v5, v8 offset:0
    ds_write_b32 v5, v9 offset:128
    ds_write_b32 v5, v10 offset:256
    s_waitcnt lgkmcnt(0)
    s_barrier
    s_cmp_ge_u32 s3, 6
    s_cbranch_scc1 K0_stats
    s_cmp_ge_u32 s3, 4
    s_cbranch_scc1 K0_kv
    ds_read_b128 v[16:19], v120 offset:0
    ds_read_b64_tr_b16 v[40:41], v118 offset:0
    ds_read_b64_tr_b16 v[42:43], v118 offset:512
    ds_read_b128 v[20:23], v121 offset:0
    ds_read_b64_tr_b16 v[44:45], v118 offset:2048
    ds_read_b64_tr_b16 v[46:47], v118 offset:2560
    ds_read_b128 v[24:27], v122 offset:0
    ds_read_b64_tr_b16 v[48:49], v118 offset:4096
    ds_read_b64_tr_b16 v[50:51], v118 offset:4608
    ds_read_b128 v[28:31], v123 offset:0
    ds_read_b64_tr_b16 v[52:53], v118 offset:6144
    ds_read_b64_tr_b16 v[54:55], v118 offset:6656
    ds_read_b128 v[32:35], v124 offset:0
    ds_read_b64_tr_b16 v[56:57], v118 offset:8192
    ds_read_b64_tr_b16 v[58:59], v118 offset:8704
    ds_read_b128 v[36:39], v125 offset:0
    ds_read_b64_tr_b16 v[60:61], v118 offset:10240
    ds_read_b64_tr_b16 v[62:63], v118 offset:10752
    s_waitcnt lgkmcnt(15)
    v_mfma_f32_32x32x16_bf16 v[96:111], v[40:43], v[16:19], 0
    ds_read_b128 v[16:19], v126 offset:0
    ds_read_b64_tr_b16 v[40:41], v118 offset:12288
    ds_read_b64_tr_b16 v[42:43], v118 offset:12800
    s_waitcnt lgkmcnt(15)
    v_mfma_f32_32x32x16_bf16 v[96:111], v[44:47], v[20:23], v[96:111]
    ds_read_b128 v[20:23], v127 offset:0
    ds_read_b64_tr_b16 v[44:45], v118 offset:14336
    ds_read_b64_tr_b16 v[46:47], v118 offset:14848
    s_waitcnt lgkmcnt(15)
    v_mfma_f32_32x32x16_bf16 v[96:111], v[48:51], v[24:27], v[96:111]
    ds_read_b128 v[24:27], v120 offset:256
    ds_read_b64_tr_b16 v[48:49], v118 offset:16384
    ds_read_b64_tr_b16 v[50:51], v118 offset:16896
    s_waitcnt lgkmcnt(15)
    v_mfma_f32_32x32x16_bf16 v[96:111], v[52:55], v[28:31], v[96:111]
    ds_read_b128 v[28:31], v121 offset:256
    ds_read_b64_tr_b16 v[52:53], v118 offset:18432
    ds_read_b64_tr_b16 v[54:55], v118 offset:18944
    s_waitcnt lgkmcnt(15)
    v_mfma_f32_32x32x16_bf16 v[96:111], v[56:59], v[32:35], v[96:111]
    ds_read_b128 v[32:35], v122 offset:256
    ds_read_b64_tr_b16 v[56:57], v118 offset:20480
    ds_read_b64_tr_b16 v[58:59], v118 offset:20992
    s_waitcnt lgkmcnt(15)
    v_mfma_f32_32x32x16_bf16 v[96:111], v[60:63], v[36:39], v[96:111]
    ds_read_b128 v[36:39], v123 offset:256
    ds_read_b64_tr_b16 v[60:61], v118 offset:22528
    ds_read_b64_tr_b16 v[62:63], v118 offset:23040
    s_waitcnt lgkmcnt(15)
    v_mfma_f32_32x32x16_bf16 v[96:111], v[40:43], v[16:19], v[96:111]
    ds_read_b128 v[16:19], v124 offset:256
    ds_read_b64_tr_b16 v[40:41], v118 offset:24576
    ds_read_b64_tr_b16 v[42:43], v118 offset:25088
    s_waitcnt lgkmcnt(15)
    v_mfma_f32_32x32x16_bf16 v[96:111], v[44:47], v[20:23], v[96:111]
    ds_read_b128 v[20:23], v125 offset:256
    ds_read_b64_tr_b16 v[44:45], v118 offset:26624
    ds_read_b64_tr_b16 v[46:47], v118 offset:27136
    s_waitcnt lgkmcnt(15)
    v_mfma_f32_32x32x16_bf16 v[96:111], v[48:51], v[24:27], v[96:111]
    ds_read_b128 v[24:27], v126 offset:256
    ds_read_b64_tr_b16 v[48:49], v118 offset:28672
    ds_read_b64_tr_b16 v[50:51], v118 offset:29184
    s_waitcnt lgkmcnt(15)
    v_mfma_f32_32x32x16_bf16 v[96:111], v[52:55], v[28:31], v[96:111]
    ds_read_b128 v[28:31], v127 offset:256
    ds_read_b64_tr_b16 v[52:53], v118 offset:30720
    ds_read_b64_tr_b16 v[54:55], v118 offset:31232
    s_waitcnt lgkmcnt(15)
    v_mfma_f32_32x32x16_bf16 v[96:111], v[56:59], v[32:35], v[96:111]
    ds_read_b128 v[32:35], v120 offset:512
    ds_read_b64_tr_b16 v[56:57], v118 offset:32768
    ds_read_b64_tr_b16 v[58:59], v118 offset:33280
    s_waitcnt lgkmcnt(15)
    v_mfma_f32_32x32x16_bf16 v[96:111], v[60:63], v[36:39], v[96:111]
    ds_read_b128 v[36:39], v121 offset:512
    ds_read_b64_tr_b16 v[60:61], v118 offset:34816
    ds_read_b64_tr_b16 v[62:63], v118 offset:35328
    s_waitcnt lgkmcnt(15)
    v_mfma_f32_32x32x16_bf16 v[96:111], v[40:43], v[16:19], v[96:111]
    ds_read_b128 v[16:19], v122 offset:512
    ds_read_b64_tr_b16 v[40:41], v118 offset:36864
    ds_read_b64_tr_b16 v[42:43], v118 offset:37376
    s_waitcnt lgkmcnt(15)
    v_mfma_f32_32x32x16_bf16 v[96:111], v[44:47], v[20:23], v[96:111]
    ds_read_b128 v[20:23], v123 offset:512
    ds_read_b64_tr_b16 v[44:45], v118 offset:38912
    ds_read_b64_tr_b16 v[46:47], v118 offset:39424
    s_waitcnt lgkmcnt(15)
    v_mfma_f32_32x32x16_bf16 v[96:111], v[48:51], v[24:27], v[96:111]
    ds_read_b128 v[24:27], v124 offset:512
    ds_read_b64_tr_b16 v[48:49], v118 offset:40960
    ds_read_b64_tr_b16 v[50:51], v118 offset:41472
    s_waitcnt lgkmcnt(15)
    v_mfma_f32_32x32x16_bf16 v[96:111], v[52:55], v[28:31], v[96:111]
    ds_read_b128 v[28:31], v125 offset:512
    ds_read_b64_tr_b16 v[52:53], v118 offset:43008
    ds_read_b64_tr_b16 v[54:55], v118 offset:43520
    s_waitcnt lgkmcnt(15)
    v_mfma_f32_32x32x16_bf16 v[96:111], v[56:59], v[32:35], v[96:111]
    ds_read_b128 v[32:35], v126 offset:512
    ds_read_b64_tr_b16 v[56:57], v118 offset:45056
    ds_read_b64_tr_b16 v[58:59], v118 offset:45568
    s_waitcnt lgkmcnt(15)
    v_mfma_f32_32x32x16_bf16 v[96:111], v[60:63], v[36:39], v[96:111]
    ds_read_b128 v[36:39], v127 offset:512
    ds_read_b64_tr_b16 v[60:61], v118 offset:47104
    ds_read_b64_tr_b16 v[62:63], v118 offset:47616
    s_waitcnt lgkmcnt(15)
    v_mfma_f32_32x32x16_bf16 v[96:111], v[40:43], v[16:19], v[96:111]
    ds_read_b128 v[16:19], v120 offset:768
    ds_read_b64_tr_b16 v[40:41], v118 offset:49152
    ds_read_b64_tr_b16 v[42:43], v118 offset:49664
    s_waitcnt lgkmcnt(15)
    v_mfma_f32_32x32x16_bf16 v[96:111], v[44:47], v[20:23], v[96:111]
    ds_read_b128 v[20:23], v121 offset:768
    ds_read_b64_tr_b16 v[44:45], v118 offset:51200
    ds_read_b64_tr_b16 v[46:47], v118 offset:51712
    s_waitcnt lgkmcnt(15)
    v_mfma_f32_32x32x16_bf16 v[96:111], v[48:51], v[24:27], v[96:111]
    ds_read_b128 v[24:27], v122 offset:768
    ds_read_b64_tr_b16 v[48:49], v118 offset:53248
    ds_read_b64_tr_b16 v[50:51], v118 offset:53760
    s_waitcnt lgkmcnt(15)
    v_mfma_f32_32x32x16_bf16 v[96:111], v[52:55], v[28:31], v[96:111]
    ds_read_b128 v[28:31], v123 offset:768
    ds_read_b64_tr_b16 v[52:53], v118 offset:55296
    ds_read_b64_tr_b16 v[54:55], v118 offset:55808
    s_waitcnt lgkmcnt(15)
    v_mfma_f32_32x32x16_bf16 v[96:111], v[56:59], v[32:35], v[96:111]
    ds_read_b128 v[32:35], v124 offset:768
    ds_read_b64_tr_b16 v[56:57], v118 offset:57344
    ds_read_b64_tr_b16 v[58:59], v118 offset:57856
    s_waitcnt lgkmcnt(15)
    v_mfma_f32_32x32x16_bf16 v[96:111], v[60:63], v[36:39], v[96:111]
    ds_read_b128 v[36:39], v125 offset:768
    ds_read_b64_tr_b16 v[60:61], v118 offset:59392
    ds_read_b64_tr_b16 v[62:63], v118 offset:59904
    s_waitcnt lgkmcnt(15)
    v_mfma_f32_32x32x16_bf16 v[96:111], v[40:43], v[16:19], v[96:111]
    ds_read_b128 v[16:19], v126 offset:768
    ds_read_b64_tr_b16 v[40:41], v118 offset:61440
    ds_read_b64_tr_b16 v[42:43], v118 offset:61952
    s_waitcnt lgkmcnt(15)
    v_mfma_f32_32x32x16_bf16 v[96:111], v[44:47], v[20:23], v[96:111]
    ds_read_b128 v[20:23], v127 offset:768
    ds_read_b64_tr_b16 v[44:45], v118 offset:63488
    ds_read_b64_tr_b16 v[46:47], v118 offset:64000
    s_waitcnt lgkmcnt(15)
    v_mfma_f32_32x32x16_bf16 v[96:111], v[48:51], v[24:27], v[96:111]
    s_waitcnt lgkmcnt(12)
    v_mfma_f32_32x32x16_bf16 v[96:111], v[52:55], v[28:31], v[96:111]
    s_waitcnt lgkmcnt(9)
    v_mfma_f32_32x32x16_bf16 v[96:111], v[56:59], v[32:35], v[96:111]
    s_waitcnt lgkmcnt(6)
    v_mfma_f32_32x32x16_bf16 v[96:111], v[60:63], v[36:39], v[96:111]
    s_waitcnt lgkmcnt(3)
    v_mfma_f32_32x32x16_bf16 v[96:111], v[40:43], v[16:19], v[96:111]
    s_waitcnt lgkmcnt(0)
    v_mfma_f32_32x32x16_bf16 v[96:111], v[44:47], v[20:23], v[96:111]
    s_barrier
    s_lshl_b32 s32, s44, 7
    s_add_u32 s32, s32, 147968
    v_lshlrev_b32 v5, 4, v4
    v_add_u32 v5, s32, v5
    ds_read_b128 v[64:67], v5 offset:0
    ds_read_b128 v[68:71], v5 offset:32
    ds_read_b128 v[72:75], v5 offset:64
    ds_read_b128 v[76:79], v5 offset:96
    s_lshl_b32 s32, s43, 8
    s_add_u32 s32, s32, 147456
    v_lshlrev_b32 v5, 2, v3
    v_add_u32 v5, s32, v5
    ds_read_b32 v12, v5
    ds_read_b32 v13, v5 offset:128
    s_waitcnt lgkmcnt(0)
    v_mul_f32 v12, 0x3eb8aa3b, v12
    v_mul_f32 v13, 0x3eb8aa3b, v13
    v_mul_f32 v64, v13, v64
    v_fma_f32 v96, v96, v12, v64
    v_mul_f32 v65, v13, v65
    v_fma_f32 v97, v97, v12, v65
    v_mul_f32 v66, v13, v66
    v_fma_f32 v98, v98, v12, v66
    v_mul_f32 v67, v13, v67
    v_fma_f32 v99, v99, v12, v67
    v_mul_f32 v68, v13, v68
    v_fma_f32 v100, v100, v12, v68
    v_mul_f32 v69, v13, v69
    v_fma_f32 v101, v101, v12, v69
    v_mul_f32 v70, v13, v70
    v_fma_f32 v102, v102, v12, v70
    v_mul_f32 v71, v13, v71
    v_fma_f32 v103, v103, v12, v71
    v_mul_f32 v72, v13, v72
    v_fma_f32 v104, v104, v12, v72
    v_mul_f32 v73, v13, v73
    v_fma_f32 v105, v105, v12, v73
    v_mul_f32 v74, v13, v74
    v_fma_f32 v106, v106, v12, v74
    v_mul_f32 v75, v13, v75
    v_fma_f32 v107, v107, v12, v75
    v_mul_f32 v76, v13, v76
    v_fma_f32 v108, v108, v12, v76
    v_mul_f32 v77, v13, v77
    v_fma_f32 v109, v109, v12, v77
    v_mul_f32 v78, v13, v78
    v_fma_f32 v110, v110, v12, v78
    v_mul_f32 v79, v13, v79
    v_fma_f32 v111, v111, v12, v79
    v_cvt_pk_bf16_f32 v16, v96, v97
    v_cvt_pk_bf16_f32 v17, v98, v99
    v_cvt_pk_bf16_f32 v18, v100, v101
    v_cvt_pk_bf16_f32 v19, v102, v103
    v_cvt_pk_bf16_f32 v20, v104, v105
    v_cvt_pk_bf16_f32 v21, v106, v107
    v_cvt_pk_bf16_f32 v22, v108, v109
    v_cvt_pk_bf16_f32 v23, v110, v111
    buffer_store_dwordx4 v[16:19], v2, s[8:11], s42 offen
    buffer_store_dwordx4 v[20:23], v2, s[8:11], s42 offen offset:1024
    s_branch k0_kernel_end
K0_kv:
    s_cmp_ge_u32 s5, 2
    s_cbranch_scc1 k0_kernel_endx
    s_cmp_eq_u32 s5, 1
    s_cbranch_scc1 K0_v
    ds_read_b128 v[16:19], v120 offset:0
    ds_read_b64_tr_b16 v[40:41], v119 offset:0
    ds_read_b64_tr_b16 v[42:43], v119 offset:128
    ds_read_b128 v[20:23], v121 offset:0
    ds_read_b64_tr_b16 v[44:45], v119 offset:512
    ds_read_b64_tr_b16 v[46:47], v119 offset:640
    ds_read_b128 v[24:27], v122 offset:0
    ds_read_b64_tr_b16 v[48:49], v119 offset:1024
    ds_read_b64_tr_b16 v[50:51], v119 offset:1152
    ds_read_b128 v[28:31], v123 offset:0
    ds_read_b64_tr_b16 v[52:53], v119 offset:1536
    ds_read_b64_tr_b16 v[54:55], v119 offset:1664
    ds_read_b128 v[32:35], v124 offset:0
    ds_read_b64_tr_b16 v[56:57], v119 offset:2048
    ds_read_b64_tr_b16 v[58:59], v119 offset:2176
    ds_read_b128 v[36:39], v125 offset:0
    ds_read_b64_tr_b16 v[60:61], v119 offset:2560
    ds_read_b64_tr_b16 v[62:63], v119 offset:2688
    s_waitcnt lgkmcnt(15)
    v_mfma_f32_32x32x16_bf16 v[96:111], v[40:43], v[16:19], 0
    ds_read_b128 v[16:19], v126 offset:0
    ds_read_b64_tr_b16 v[40:41], v119 offset:3072
    ds_read_b64_tr_b16 v[42:43], v119 offset:3200
    s_waitcnt lgkmcnt(15)
    v_mfma_f32_32x32x16_bf16 v[96:111], v[44:47], v[20:23], v[96:111]
    ds_read_b128 v[20:23], v127 offset:0
    ds_read_b64_tr_b16 v[44:45], v119 offset:3584
    ds_read_b64_tr_b16 v[46:47], v119 offset:3712
    s_waitcnt lgkmcnt(15)
    v_mfma_f32_32x32x16_bf16 v[96:111], v[48:51], v[24:27], v[96:111]
    ds_read_b128 v[24:27], v120 offset:256
    ds_read_b64_tr_b16 v[48:49], v119 offset:4096
    ds_read_b64_tr_b16 v[50:51], v119 offset:4224
    s_waitcnt lgkmcnt(15)
    v_mfma_f32_32x32x16_bf16 v[96:111], v[52:55], v[28:31], v[96:111]
    ds_read_b128 v[28:31], v121 offset:256
    ds_read_b64_tr_b16 v[52:53], v119 offset:4608
    ds_read_b64_tr_b16 v[54:55], v119 offset:4736
    s_waitcnt lgkmcnt(15)
    v_mfma_f32_32x32x16_bf16 v[96:111], v[56:59], v[32:35], v[96:111]
    ds_read_b128 v[32:35], v122 offset:256
    ds_read_b64_tr_b16 v[56:57], v119 offset:5120
    ds_read_b64_tr_b16 v[58:59], v119 offset:5248
    s_waitcnt lgkmcnt(15)
    v_mfma_f32_32x32x16_bf16 v[96:111], v[60:63], v[36:39], v[96:111]
    ds_read_b128 v[36:39], v123 offset:256
    ds_read_b64_tr_b16 v[60:61], v119 offset:5632
    ds_read_b64_tr_b16 v[62:63], v119 offset:5760
    s_waitcnt lgkmcnt(15)
    v_mfma_f32_32x32x16_bf16 v[96:111], v[40:43], v[16:19], v[96:111]
    ds_read_b128 v[16:19], v124 offset:256
    ds_read_b64_tr_b16 v[40:41], v119 offset:6144
    ds_read_b64_tr_b16 v[42:43], v119 offset:6272
    s_waitcnt lgkmcnt(15)
    v_mfma_f32_32x32x16_bf16 v[96:111], v[44:47], v[20:23], v[96:111]
    ds_read_b128 v[20:23], v125 offset:256
    ds_read_b64_tr_b16 v[44:45], v119 offset:6656
    ds_read_b64_tr_b16 v[46:47], v119 offset:6784
    s_waitcnt lgkmcnt(15)
    v_mfma_f32_32x32x16_bf16 v[96:111], v[48:51], v[24:27], v[96:111]
    ds_read_b128 v[24:27], v126 offset:256
    ds_read_b64_tr_b16 v[48:49], v119 offset:7168
    ds_read_b64_tr_b16 v[50:51], v119 offset:7296
    s_waitcnt lgkmcnt(15)
    v_mfma_f32_32x32x16_bf16 v[96:111], v[52:55], v[28:31], v[96:111]
    ds_read_b128 v[28:31], v127 offset:256
    ds_read_b64_tr_b16 v[52:53], v119 offset:7680
    ds_read_b64_tr_b16 v[54:55], v119 offset:7808
    s_waitcnt lgkmcnt(15)
    v_mfma_f32_32x32x16_bf16 v[96:111], v[56:59], v[32:35], v[96:111]
    ds_read_b128 v[32:35], v120 offset:512
    ds_read_b64_tr_b16 v[56:57], v119 offset:8192
    ds_read_b64_tr_b16 v[58:59], v119 offset:8320
    s_waitcnt lgkmcnt(15)
    v_mfma_f32_32x32x16_bf16 v[96:111], v[60:63], v[36:39], v[96:111]
    ds_read_b128 v[36:39], v121 offset:512
    ds_read_b64_tr_b16 v[60:61], v119 offset:8704
    ds_read_b64_tr_b16 v[62:63], v119 offset:8832
    s_waitcnt lgkmcnt(15)
    v_mfma_f32_32x32x16_bf16 v[96:111], v[40:43], v[16:19], v[96:111]
    ds_read_b128 v[16:19], v122 offset:512
    ds_read_b64_tr_b16 v[40:41], v119 offset:9216
    ds_read_b64_tr_b16 v[42:43], v119 offset:9344
    s_waitcnt lgkmcnt(15)
    v_mfma_f32_32x32x16_bf16 v[96:111], v[44:47], v[20:23], v[96:111]
    ds_read_b128 v[20:23], v123 offset:512
    ds_read_b64_tr_b16 v[44:45], v119 offset:9728
    ds_read_b64_tr_b16 v[46:47], v119 offset:9856
    s_waitcnt lgkmcnt(15)
    v_mfma_f32_32x32x16_bf16 v[96:111], v[48:51], v[24:27], v[96:111]
    ds_read_b128 v[24:27], v124 offset:512
    ds_read_b64_tr_b16 v[48:49], v119 offset:10240
    ds_read_b64_tr_b16 v[50:51], v119 offset:10368
    s_waitcnt lgkmcnt(15)
    v_mfma_f32_32x32x16_bf16 v[96:111], v[52:55], v[28:31], v[96:111]
    ds_read_b128 v[28:31], v125 offset:512
    ds_read_b64_tr_b16 v[52:53], v119 offset:10752
    ds_read_b64_tr_b16 v[54:55], v119 offset:10880
    s_waitcnt lgkmcnt(15)
    v_mfma_f32_32x32x16_bf16 v[96:111], v[56:59], v[32:35], v[96:111]
    ds_read_b128 v[32:35], v126 offset:512
    ds_read_b64_tr_b16 v[56:57], v119 offset:11264
    ds_read_b64_tr_b16 v[58:59], v119 offset:11392
    s_waitcnt lgkmcnt(15)
    v_mfma_f32_32x32x16_bf16 v[96:111], v[60:63], v[36:39], v[96:111]
    ds_read_b128 v[36:39], v127 offset:512
    ds_read_b64_tr_b16 v[60:61], v119 offset:11776
    ds_read_b64_tr_b16 v[62:63], v119 offset:11904
    s_waitcnt lgkmcnt(15)
    v_mfma_f32_32x32x16_bf16 v[96:111], v[40:43], v[16:19], v[96:111]
    ds_read_b128 v[16:19], v120 offset:768
    ds_read_b64_tr_b16 v[40:41], v119 offset:12288
    ds_read_b64_tr_b16 v[42:43], v119 offset:12416
    s_waitcnt lgkmcnt(15)
    v_mfma_f32_32x32x16_bf16 v[96:111], v[44:47], v[20:23], v[96:111]
    ds_read_b128 v[20:23], v121 offset:768
    ds_read_b64_tr_b16 v[44:45], v119 offset:12800
    ds_read_b64_tr_b16 v[46:47], v119 offset:12928
    s_waitcnt lgkmcnt(15)
    v_mfma_f32_32x32x16_bf16 v[96:111], v[48:51], v[24:27], v[96:111]
    ds_read_b128 v[24:27], v122 offset:768
    ds_read_b64_tr_b16 v[48:49], v119 offset:13312
    ds_read_b64_tr_b16 v[50:51], v119 offset:13440
    s_waitcnt lgkmcnt(15)
    v_mfma_f32_32x32x16_bf16 v[96:111], v[52:55], v[28:31], v[96:111]
    ds_read_b128 v[28:31], v123 offset:768
    ds_read_b64_tr_b16 v[52:53], v119 offset:13824
    ds_read_b64_tr_b16 v[54:55], v119 offset:13952
    s_waitcnt lgkmcnt(15)
    v_mfma_f32_32x32x16_bf16 v[96:111], v[56:59], v[32:35], v[96:111]
    ds_read_b128 v[32:35], v124 offset:768
    ds_read_b64_tr_b16 v[56:57], v119 offset:14336
    ds_read_b64_tr_b16 v[58:59], v119 offset:14464
    s_waitcnt lgkmcnt(15)
    v_mfma_f32_32x32x16_bf16 v[96:111], v[60:63], v[36:39], v[96:111]
    ds_read_b128 v[36:39], v125 offset:768
    ds_read_b64_tr_b16 v[60:61], v119 offset:14848
    ds_read_b64_tr_b16 v[62:63], v119 offset:14976
    s_waitcnt lgkmcnt(15)
    v_mfma_f32_32x32x16_bf16 v[96:111], v[40:43], v[16:19], v[96:111]
    ds_read_b128 v[16:19], v126 offset:768
    ds_read_b64_tr_b16 v[40:41], v119 offset:15360
    ds_read_b64_tr_b16 v[42:43], v119 offset:15488
    s_waitcnt lgkmcnt(15)
    v_mfma_f32_32x32x16_bf16 v[96:111], v[44:47], v[20:23], v[96:111]
    ds_read_b128 v[20:23], v127 offset:768
    ds_read_b64_tr_b16 v[44:45], v119 offset:15872
    ds_read_b64_tr_b16 v[46:47], v119 offset:16000
    s_waitcnt lgkmcnt(15)
    v_mfma_f32_32x32x16_bf16 v[96:111], v[48:51], v[24:27], v[96:111]
    s_waitcnt lgkmcnt(12)
    v_mfma_f32_32x32x16_bf16 v[96:111], v[52:55], v[28:31], v[96:111]
    s_waitcnt lgkmcnt(9)
    v_mfma_f32_32x32x16_bf16 v[96:111], v[56:59], v[32:35], v[96:111]
    s_waitcnt lgkmcnt(6)
    v_mfma_f32_32x32x16_bf16 v[96:111], v[60:63], v[36:39], v[96:111]
    s_waitcnt lgkmcnt(3)
    v_mfma_f32_32x32x16_bf16 v[96:111], v[40:43], v[16:19], v[96:111]
    s_waitcnt lgkmcnt(0)
    v_mfma_f32_32x32x16_bf16 v[96:111], v[44:47], v[20:23], v[96:111]
    s_barrier
    s_mov_b32 s32, 148224
    v_lshlrev_b32 v5, 4, v4
    v_add_u32 v5, s32, v5
    ds_read_b128 v[64:67], v5 offset:0
    ds_read_b128 v[68:71], v5 offset:32
    s_lshl_b32 s32, s43, 8
    s_add_u32 s32, s32, 147456
    v_lshlrev_b32 v5, 2, v3
    v_add_u32 v5, s32, v5
    ds_read_b32 v12, v5
    ds_read_b32 v13, v5 offset:128
    s_waitcnt lgkmcnt(0)
    v_mov_b32 v14, 0
    v_mul_f32 v64, v13, v64
    v_fma_f32 v96, v96, v12, v64
    v_fma_f32 v14, v96, v96, v14
    v_mul_f32 v65, v13, v65
    v_fma_f32 v97, v97, v12, v65
    v_fma_f32 v14, v97, v97, v14
    v_mul_f32 v66, v13, v66
    v_fma_f32 v98, v98, v12, v66
    v_fma_f32 v14, v98, v98, v14
    v_mul_f32 v67, v13, v67
    v_fma_f32 v99, v99, v12, v67
    v_fma_f32 v14, v99, v99, v14
    v_mul_f32 v68, v13, v68
    v_fma_f32 v100, v100, v12, v68
    v_fma_f32 v14, v100, v100, v14
    v_mul_f32 v69, v13, v69
    v_fma_f32 v101, v101, v12, v69
    v_fma_f32 v14, v101, v101, v14
    v_mul_f32 v70, v13, v70
    v_fma_f32 v102, v102, v12, v70
    v_fma_f32 v14, v102, v102, v14
    v_mul_f32 v71, v13, v71
    v_fma_f32 v103, v103, v12, v71
    v_fma_f32 v14, v103, v103, v14
    v_cvt_pk_bf16_f32 v16, v96, v97
    v_cvt_pk_bf16_f32 v17, v98, v99
    v_cvt_pk_bf16_f32 v18, v100, v101
    v_cvt_pk_bf16_f32 v19, v102, v103
    buffer_store_dwordx4 v[16:19], v2, s[8:11], s47 offen
    v_mov_b32 v15, v14
    s_nop 1
    v_permlane32_swap_b32 v14, v15
    s_nop 0
    v_add_f32 v14, v14, v15
    s_lshl_b32 s32, s45, 7
    s_add_u32 s32, s32, 0x1880000
    v_lshlrev_b32 v15, 2, v3
    v_cmp_gt_u32 vcc, 32, v1
    s_and_saveexec_b64 s[38:39], vcc
    buffer_store_dword v14, v15, s[8:11], s32 offen
    s_branch k0_kernel_end
K0_v:
    ds_read_b128 v[16:19], v120 offset:0
    ds_read_b64_tr_b16 v[40:41], v119 offset:0
    ds_read_b64_tr_b16 v[42:43], v119 offset:128
    ds_read_b128 v[20:23], v121 offset:0
    ds_read_b64_tr_b16 v[44:45], v119 offset:512
    ds_read_b64_tr_b16 v[46:47], v119 offset:640
    ds_read_b128 v[24:27], v122 offset:0
    ds_read_b64_tr_b16 v[48:49], v119 offset:1024
    ds_read_b64_tr_b16 v[50:51], v119 offset:1152
    ds_read_b128 v[28:31], v123 offset:0
    ds_read_b64_tr_b16 v[52:53], v119 offset:1536
    ds_read_b64_tr_b16 v[54:55], v119 offset:1664
    ds_read_b128 v[32:35], v124 offset:0
    ds_read_b64_tr_b16 v[56:57], v119 offset:2048
    ds_read_b64_tr_b16 v[58:59], v119 offset:2176
    ds_read_b128 v[36:39], v125 offset:0
    ds_read_b64_tr_b16 v[60:61], v119 offset:2560
    ds_read_b64_tr_b16 v[62:63], v119 offset:2688
    s_waitcnt lgkmcnt(15)
    v_mfma_f32_32x32x16_bf16 v[96:111], v[16:19], v[40:43], 0
    ds_read_b128 v[16:19], v126 offset:0
    ds_read_b64_tr_b16 v[40:41], v119 offset:3072
    ds_read_b64_tr_b16 v[42:43], v119 offset:3200
    s_waitcnt lgkmcnt(15)
    v_mfma_f32_32x32x16_bf16 v[96:111], v[20:23], v[44:47], v[96:111]
    ds_read_b128 v[20:23], v127 offset:0
    ds_read_b64_tr_b16 v[44:45], v119 offset:3584
    ds_read_b64_tr_b16 v[46:47], v119 offset:3712
    s_waitcnt lgkmcnt(15)
    v_mfma_f32_32x32x16_bf16 v[96:111], v[24:27], v[48:51], v[96:111]
    ds_read_b128 v[24:27], v120 offset:256
    ds_read_b64_tr_b16 v[48:49], v119 offset:4096
    ds_read_b64_tr_b16 v[50:51], v119 offset:4224
    s_waitcnt lgkmcnt(15)
    v_mfma_f32_32x32x16_bf16 v[96:111], v[28:31], v[52:55], v[96:111]
    ds_read_b128 v[28:31], v121 offset:256
    ds_read_b64_tr_b16 v[52:53], v119 offset:4608
    ds_read_b64_tr_b16 v[54:55], v119 offset:4736
    s_waitcnt lgkmcnt(15)
    v_mfma_f32_32x32x16_bf16 v[96:111], v[32:35], v[56:59], v[96:111]
    ds_read_b128 v[32:35], v122 offset:256
    ds_read_b64_tr_b16 v[56:57], v119 offset:5120
    ds_read_b64_tr_b16 v[58:59], v119 offset:5248
    s_waitcnt lgkmcnt(15)
    v_mfma_f32_32x32x16_bf16 v[96:111], v[36:39], v[60:63], v[96:111]
    ds_read_b128 v[36:39], v123 offset:256
    ds_read_b64_tr_b16 v[60:61], v119 offset:5632
    ds_read_b64_tr_b16 v[62:63], v119 offset:5760
    s_waitcnt lgkmcnt(15)
    v_mfma_f32_32x32x16_bf16 v[96:111], v[16:19], v[40:43], v[96:111]
    ds_read_b128 v[16:19], v124 offset:256
    ds_read_b64_tr_b16 v[40:41], v119 offset:6144
    ds_read_b64_tr_b16 v[42:43], v119 offset:6272
    s_waitcnt lgkmcnt(15)
    v_mfma_f32_32x32x16_bf16 v[96:111], v[20:23], v[44:47], v[96:111]
    ds_read_b128 v[20:23], v125 offset:256
    ds_read_b64_tr_b16 v[44:45], v119 offset:6656
    ds_read_b64_tr_b16 v[46:47], v119 offset:6784
    s_waitcnt lgkmcnt(15)
    v_mfma_f32_32x32x16_bf16 v[96:111], v[24:27], v[48:51], v[96:111]
    ds_read_b128 v[24:27], v126 offset:256
    ds_read_b64_tr_b16 v[48:49], v119 offset:7168
    ds_read_b64_tr_b16 v[50:51], v119 offset:7296
    s_waitcnt lgkmcnt(15)
    v_mfma_f32_32x32x16_bf16 v[96:111], v[28:31], v[52:55], v[96:111]
    ds_read_b128 v[28:31], v127 offset:256
    ds_read_b64_tr_b16 v[52:53], v119 offset:7680
    ds_read_b64_tr_b16 v[54:55], v119 offset:7808
    s_waitcnt lgkmcnt(15)
    v_mfma_f32_32x32x16_bf16 v[96:111], v[32:35], v[56:59], v[96:111]
    ds_read_b128 v[32:35], v120 offset:512
    ds_read_b64_tr_b16 v[56:57], v119 offset:8192
    ds_read_b64_tr_b16 v[58:59], v119 offset:8320
    s_waitcnt lgkmcnt(15)
    v_mfma_f32_32x32x16_bf16 v[96:111], v[36:39], v[60:63], v[96:111]
    ds_read_b128 v[36:39], v121 offset:512
    ds_read_b64_tr_b16 v[60:61], v119 offset:8704
    ds_read_b64_tr_b16 v[62:63], v119 offset:8832
    s_waitcnt lgkmcnt(15)
    v_mfma_f32_32x32x16_bf16 v[96:111], v[16:19], v[40:43], v[96:111]
    ds_read_b128 v[16:19], v122 offset:512
    ds_read_b64_tr_b16 v[40:41], v119 offset:9216
    ds_read_b64_tr_b16 v[42:43], v119 offset:9344
    s_waitcnt lgkmcnt(15)
    v_mfma_f32_32x32x16_bf16 v[96:111], v[20:23], v[44:47], v[96:111]
    ds_read_b128 v[20:23], v123 offset:512
    ds_read_b64_tr_b16 v[44:45], v119 offset:9728
    ds_read_b64_tr_b16 v[46:47], v119 offset:9856
    s_waitcnt lgkmcnt(15)
    v_mfma_f32_32x32x16_bf16 v[96:111], v[24:27], v[48:51], v[96:111]
    ds_read_b128 v[24:27], v124 offset:512
    ds_read_b64_tr_b16 v[48:49], v119 offset:10240
    ds_read_b64_tr_b16 v[50:51], v119 offset:10368
    s_waitcnt lgkmcnt(15)
    v_mfma_f32_32x32x16_bf16 v[96:111], v[28:31], v[52:55], v[96:111]
    ds_read_b128 v[28:31], v125 offset:512
    ds_read_b64_tr_b16 v[52:53], v119 offset:10752
    ds_read_b64_tr_b16 v[54:55], v119 offset:10880
    s_waitcnt lgkmcnt(15)
    v_mfma_f32_32x32x16_bf16 v[96:111], v[32:35], v[56:59], v[96:111]
    ds_read_b128 v[32:35], v126 offset:512
    ds_read_b64_tr_b16 v[56:57], v119 offset:11264
    ds_read_b64_tr_b16 v[58:59], v119 offset:11392
    s_waitcnt lgkmcnt(15)
    v_mfma_f32_32x32x16_bf16 v[96:111], v[36:39], v[60:63], v[96:111]
    ds_read_b128 v[36:39], v127 offset:512
    ds_read_b64_tr_b16 v[60:61], v119 offset:11776
    ds_read_b64_tr_b16 v[62:63], v119 offset:11904
    s_waitcnt lgkmcnt(15)
    v_mfma_f32_32x32x16_bf16 v[96:111], v[16:19], v[40:43], v[96:111]
    ds_read_b128 v[16:19], v120 offset:768
    ds_read_b64_tr_b16 v[40:41], v119 offset:12288
    ds_read_b64_tr_b16 v[42:43], v119 offset:12416
    s_waitcnt lgkmcnt(15)
    v_mfma_f32_32x32x16_bf16 v[96:111], v[20:23], v[44:47], v[96:111]
    ds_read_b128 v[20:23], v121 offset:768
    ds_read_b64_tr_b16 v[44:45], v119 offset:12800
    ds_read_b64_tr_b16 v[46:47], v119 offset:12928
    s_waitcnt lgkmcnt(15)
    v_mfma_f32_32x32x16_bf16 v[96:111], v[24:27], v[48:51], v[96:111]
    ds_read_b128 v[24:27], v122 offset:768
    ds_read_b64_tr_b16 v[48:49], v119 offset:13312
    ds_read_b64_tr_b16 v[50:51], v119 offset:13440
    s_waitcnt lgkmcnt(15)
    v_mfma_f32_32x32x16_bf16 v[96:111], v[28:31], v[52:55], v[96:111]
    ds_read_b128 v[28:31], v123 offset:768
    ds_read_b64_tr_b16 v[52:53], v119 offset:13824
    ds_read_b64_tr_b16 v[54:55], v119 offset:13952
    s_waitcnt lgkmcnt(15)
    v_mfma_f32_32x32x16_bf16 v[96:111], v[32:35], v[56:59], v[96:111]
    ds_read_b128 v[32:35], v124 offset:768
    ds_read_b64_tr_b16 v[56:57], v119 offset:14336
    ds_read_b64_tr_b16 v[58:59], v119 offset:14464
    s_waitcnt lgkmcnt(15)
    v_mfma_f32_32x32x16_bf16 v[96:111], v[36:39], v[60:63], v[96:111]
    ds_read_b128 v[36:39], v125 offset:768
    ds_read_b64_tr_b16 v[60:61], v119 offset:14848
    ds_read_b64_tr_b16 v[62:63], v119 offset:14976
    s_waitcnt lgkmcnt(15)
    v_mfma_f32_32x32x16_bf16 v[96:111], v[16:19], v[40:43], v[96:111]
    ds_read_b128 v[16:19], v126 offset:768
    ds_read_b64_tr_b16 v[40:41], v119 offset:15360
    ds_read_b64_tr_b16 v[42:43], v119 offset:15488
    s_waitcnt lgkmcnt(15)
    v_mfma_f32_32x32x16_bf16 v[96:111], v[20:23], v[44:47], v[96:111]
    ds_read_b128 v[20:23], v127 offset:768
    ds_read_b64_tr_b16 v[44:45], v119 offset:15872
    ds_read_b64_tr_b16 v[46:47], v119 offset:16000
    s_waitcnt lgkmcnt(15)
    v_mfma_f32_32x32x16_bf16 v[96:111], v[24:27], v[48:51], v[96:111]
    s_waitcnt lgkmcnt(12)
    v_mfma_f32_32x32x16_bf16 v[96:111], v[28:31], v[52:55], v[96:111]
    s_waitcnt lgkmcnt(9)
    v_mfma_f32_32x32x16_bf16 v[96:111], v[32:35], v[56:59], v[96:111]
    s_waitcnt lgkmcnt(6)
    v_mfma_f32_32x32x16_bf16 v[96:111], v[36:39], v[60:63], v[96:111]
    s_waitcnt lgkmcnt(3)
    v_mfma_f32_32x32x16_bf16 v[96:111], v[16:19], v[40:43], v[96:111]
    s_waitcnt lgkmcnt(0)
    v_mfma_f32_32x32x16_bf16 v[96:111], v[20:23], v[44:47], v[96:111]
    s_barrier
    v_lshlrev_b32 v5, 2, v3
    v_add_u32 v5, 148224, v5
    ds_read_b32 v8, v5
    s_lshl_b32 s32, s43, 8
    s_add_u32 s32, s32, 147456
    v_lshlrev_b32 v5, 4, v4
    v_add_u32 v5, s32, v5
    ds_read_b128 v[64:67], v5 offset:0
    ds_read_b128 v[80:83], v5 offset:128
    ds_read_b128 v[68:71], v5 offset:32
    ds_read_b128 v[84:87], v5 offset:160
    ds_read_b128 v[72:75], v5 offset:64
    ds_read_b128 v[88:91], v5 offset:192
    ds_read_b128 v[76:79], v5 offset:96
    ds_read_b128 v[92:95], v5 offset:224
    s_waitcnt lgkmcnt(0)
    v_mul_f32 v80, v8, v80
    v_fma_f32 v96, v96, v64, v80
    v_mul_f32 v81, v8, v81
    v_fma_f32 v97, v97, v65, v81
    v_mul_f32 v82, v8, v82
    v_fma_f32 v98, v98, v66, v82
    v_mul_f32 v83, v8, v83
    v_fma_f32 v99, v99, v67, v83
    v_mul_f32 v84, v8, v84
    v_fma_f32 v100, v100, v68, v84
    v_mul_f32 v85, v8, v85
    v_fma_f32 v101, v101, v69, v85
    v_mul_f32 v86, v8, v86
    v_fma_f32 v102, v102, v70, v86
    v_mul_f32 v87, v8, v87
    v_fma_f32 v103, v103, v71, v87
    v_mul_f32 v88, v8, v88
    v_fma_f32 v104, v104, v72, v88
    v_mul_f32 v89, v8, v89
    v_fma_f32 v105, v105, v73, v89
    v_mul_f32 v90, v8, v90
    v_fma_f32 v106, v106, v74, v90
    v_mul_f32 v91, v8, v91
    v_fma_f32 v107, v107, v75, v91
    v_mul_f32 v92, v8, v92
    v_fma_f32 v108, v108, v76, v92
    v_mul_f32 v93, v8, v93
    v_fma_f32 v109, v109, v77, v93
    v_mul_f32 v94, v8, v94
    v_fma_f32 v110, v110, v78, v94
    v_mul_f32 v95, v8, v95
    v_fma_f32 v111, v111, v79, v95
    v_cvt_pk_bf16_f32 v16, v96, v97
    v_cvt_pk_bf16_f32 v17, v98, v99
    v_cvt_pk_bf16_f32 v18, v100, v101
    v_cvt_pk_bf16_f32 v19, v102, v103
    v_cvt_pk_bf16_f32 v20, v104, v105
    v_cvt_pk_bf16_f32 v21, v106, v107
    v_cvt_pk_bf16_f32 v22, v108, v109
    v_cvt_pk_bf16_f32 v23, v110, v111
    v_cmp_eq_u32 s[38:39], 16, v3
    v_mov_b32 v14, 0x3f803f80
    v_mov_b32 v15, 0
    v_cndmask_b32 v14, v15, v14, s[38:39]
    v_cmp_gt_u32 vcc, 16, v3
    v_lshlrev_b32 v5, 4, v3
    v_mul_u32_u24 v15, 288, v4
    v_cndmask_b32 v16, v14, v16, vcc
    v_cndmask_b32 v17, v14, v17, vcc
    v_cndmask_b32 v18, v14, v18, vcc
    v_cndmask_b32 v19, v14, v19, vcc
    v_cndmask_b32 v20, v14, v20, vcc
    v_cndmask_b32 v21, v14, v21, vcc
    v_cndmask_b32 v22, v14, v22, vcc
    v_cndmask_b32 v23, v14, v23, vcc
    v_add_u32 v5, v5, v15
    v_cmp_gt_u32 vcc, 18, v3
    s_and_saveexec_b64 s[38:39], vcc
    buffer_store_dwordx4 v[16:19], v5, s[8:11], s47 offen offset:1024
    buffer_store_dwordx4 v[20:23], v5, s[8:11], s47 offen offset:1600
    s_branch k0_kernel_end
K0_stats:
    s_lshl_b32 s32, s43, 8
    v_lshlrev_b32 v5, 2, v1
    v_lshlrev_b32 v6, 2, v3
    s_cmp_eq_u32 s43, 0
    s_cbranch_scc1 K0_cs6
    v_mov_b32 v5, v6
K0_cs6:
    v_add_u32 v5, s32, v5
    v_add_u32 v6, 148480, v5
    ds_read_b32 v16, v6 offset:0
    ds_read_b32 v17, v6 offset:384
    ds_read_b32 v18, v6 offset:768
    ds_read_b32 v19, v6 offset:1152
    ds_read_b32 v20, v6 offset:1536
    ds_read_b32 v21, v6 offset:1920
    ds_read_b32 v22, v6 offset:2304
    ds_read_b32 v23, v6 offset:2688
    s_waitcnt lgkmcnt(0)
    v_add_f32 v16, v16, v17
    v_add_f32 v16, v16, v18
    v_add_f32 v16, v16, v19
    v_add_f32 v16, v16, v20
    v_add_f32 v16, v16, v21
    v_add_f32 v16, v16, v22
    v_add_f32 v16, v16, v23
    v_add_u32 v5, 147968, v5
    ds_write_b32 v5, v16
    s_waitcnt lgkmcnt(0)
    s_barrier
    s_branch k0_kernel_endx
K0_prep:
    s_sub_u32 s63, 255, s2
    s_mov_b32 s52, s20
    s_mov_b32 s53, s21
    s_mov_b32 s54, 0x4000
    s_mov_b32 s55, 0x00020000
    s_mov_b32 s56, s22
    s_mov_b32 s57, s23
    s_mov_b32 s58, 0x4000
    s_mov_b32 s59, 0x00020000
    s_cmp_lt_u32 s63, 154
    s_cbranch_scc1 K0_ptask
K0_pidle:
    s_branch k0_kernel_endx
K0_ptask:
    s_cmp_lg_u32 s63, 153
    s_cbranch_scc1 K0_pw
    s_lshl_b32 s32, s3, 11
    s_add_u32 s32, s32, 0x490000
    v_mov_b32 v16, 0
    v_mov_b32 v17, 0
    v_mov_b32 v18, 0
    v_mov_b32 v19, 0
    buffer_store_dwordx4 v[16:19], v2, s[8:11], s32 offen
    buffer_store_dwordx4 v[16:19], v2, s[8:11], s32 offen offset:1024
    s_branch K0_pidle
K0_pw:
    s_mov_b32 s46, 0
    s_mov_b32 s36, 32
    s_cmp_eq_u32 s63, 152
    s_cbranch_scc1 K0_pkv
    s_cmp_ge_u32 s63, 88
    s_cbranch_scc1 K0_pw2
    s_cmp_ge_u32 s63, 32
    s_cbranch_scc1 K0_pw1
    s_cmp_ge_u32 s63, 16
    s_cbranch_scc1 K0_pwo
    s_mov_b32 s40, s18
    s_mov_b32 s41, s19
    s_mov_b32 s42, 0x80000
    s_mov_b32 s43, 0x00020000
    s_mov_b32 s44, 1024
    s_mov_b32 s45, s63
    s_lshl_b32 s47, s45, 15
    s_add_u32 s47, s47, 0x0
    s_lshl_b32 s49, s45, 7
    s_add_u32 s49, s49, 0x488000
    s_branch K0_pgo
K0_pwo:
    s_mov_b32 s40, s24
    s_mov_b32 s41, s25
    s_mov_b32 s42, 0x80000
    s_mov_b32 s43, 0x00020000
    s_mov_b32 s44, 1024
    s_sub_u32 s45, s63, 16
    s_lshl_b32 s47, s45, 15
    s_add_u32 s47, s47, 0x80000
    s_mov_b32 s49, 0
    s_branch K0_pgo
K0_pw1:
    s_mov_b32 s40, s28
    s_mov_b32 s41, s29
    s_mov_b32 s42, 0x1c0000
    s_mov_b32 s43, 0x00020000
    s_mov_b32 s44, 3584
    s_sub_u32 s45, s63, 32
    s_lshl_b32 s47, s45, 15
    s_add_u32 s47, s47, 0x100000
    s_lshl_b32 s49, s45, 7
    s_add_u32 s49, s49, 0x488800
    s_branch K0_pgo
K0_pw2:
    s_mov_b32 s40, s30
    s_mov_b32 s41, s31
    s_mov_b32 s42, 0x1c0000
    s_mov_b32 s43, 0x00020000
    s_mov_b32 s44, 1024
    s_sub_u32 s45, s63, 88
    s_and_b32 s46, s45, 3
    s_mul_i32 s46, s46, 28
    s_lshr_b32 s45, s45, 2
    s_mul_i32 s47, s45, 112
    s_add_u32 s47, s47, s46
    s_lshl_b32 s47, s47, 10
    s_add_u32 s47, s47, 0x2c0000
    s_mov_b32 s36, 28
    s_mov_b32 s49, 0
K0_pgo:
    s_lshl_b32 s50, s3, 2
    s_cmp_ge_u32 s50, s36
    s_cbranch_scc1 k0_kernel_endx
    v_lshrrev_b32 v5, 2, v1
    v_mul_lo_u32 v5, v5, s44
    v_and_b32 v6, 3, v1
    v_lshl_add_u32 v5, v6, 4, v5
    s_add_u32 s51, s46, s50
    s_lshl_b32 s51, s51, 4
    s_mul_i32 s51, s51, s44
    s_lshl_b32 s32, s45, 6
    s_add_u32 s51, s51, s32
    s_lshl_b32 s33, s44, 4
    buffer_load_dwordx4 v[32:35], v5, s[40:43], s51 offen
    s_add_u32 s51, s51, s33
    buffer_load_dwordx4 v[36:39], v5, s[40:43], s51 offen
    s_add_u32 s51, s51, s33
    buffer_load_dwordx4 v[40:43], v5, s[40:43], s51 offen
    s_add_u32 s51, s51, s33
    buffer_load_dwordx4 v[44:47], v5, s[40:43], s51 offen
    s_add_u32 s51, s51, s33
    s_branch K0_ptr
K0_pkv:
    s_lshl_b32 s50, s3, 2
    v_lshrrev_b32 v7, 2, v1
    v_lshlrev_b32 v7, 5, v7
    v_and_b32 v5, 1, v1
    v_lshl_add_u32 v7, v5, 4, v7
    v_and_b32 v5, 2, v1
    v_cmp_eq_u32 vcc, 0, v5
    s_lshl_b32 s20, s3, 11
    s_and_saveexec_b64 s[38:39], vcc
    buffer_load_dwordx4 v[32:35], v7, s[52:55], s20 offen offset:0
    buffer_load_dwordx4 v[36:39], v7, s[52:55], s20 offen offset:512
    buffer_load_dwordx4 v[40:43], v7, s[52:55], s20 offen offset:1024
    buffer_load_dwordx4 v[44:47], v7, s[52:55], s20 offen offset:1536
    s_andn2_b64 exec, s[38:39], exec
    buffer_load_dwordx4 v[32:35], v7, s[56:59], s20 offen offset:0
    buffer_load_dwordx4 v[36:39], v7, s[56:59], s20 offen offset:512
    buffer_load_dwordx4 v[40:43], v7, s[56:59], s20 offen offset:1024
    buffer_load_dwordx4 v[44:47], v7, s[56:59], s20 offen offset:1536
    s_mov_b64 exec, s[38:39]
    s_mov_b32 s47, 0x480000
    s_mov_b32 s49, 0x48a400
K0_ptr:
    s_lshl_b32 s32, s50, 10
    s_add_u32 s47, s47, s32
    v_lshlrev_b32 v9, 7, v3
    buffer_load_dword v10, v9, s[8:11], s47 offen
    s_lshl_b32 s62, s3, 10
    s_add_u32 s62, s62, 131072
    v_lshrrev_b32 v5, 5, v1
    v_lshlrev_b32 v5, 2, v5
    v_bfe_u32 v6, v1, 2, 2
    v_add_u32 v5, v5, v6
    v_mul_u32_u24 v8, 64, v5
    v_bfe_u32 v5, v1, 4, 1
    v_lshlrev_b32 v5, 5, v5
    v_and_b32 v6, 3, v1
    v_lshlrev_b32 v6, 3, v6
    v_add3_u32 v8, v8, v5, v6
    v_add_u32 v8, s62, v8
    v_add_u32 v9, s62, v2
    v_mov_b32 v7, 0
    s_barrier
    s_waitcnt vmcnt(1)
    ds_write_b128 v9, v[32:35]
    ds_read_b64_tr_b16 v[16:17], v8
    ds_read_b64_tr_b16 v[18:19], v8 offset:512
    ds_write_b128 v9, v[36:39]
    ds_read_b64_tr_b16 v[20:21], v8
    ds_read_b64_tr_b16 v[22:23], v8 offset:512
    ds_write_b128 v9, v[40:43]
    ds_read_b64_tr_b16 v[24:25], v8
    ds_read_b64_tr_b16 v[26:27], v8 offset:512
    ds_write_b128 v9, v[44:47]
    ds_read_b64_tr_b16 v[28:29], v8
    ds_read_b64_tr_b16 v[30:31], v8 offset:512
    s_waitcnt lgkmcnt(9)
    buffer_store_dwordx4 v[16:19], v2, s[8:11], s47 offen offset:0
    v_dot2_f32_bf16 v7, v16, s61, v7
    v_dot2_f32_bf16 v7, v17, s61, v7
    v_dot2_f32_bf16 v7, v18, s61, v7
    v_dot2_f32_bf16 v7, v19, s61, v7
    s_waitcnt lgkmcnt(6)
    buffer_store_dwordx4 v[20:23], v2, s[8:11], s47 offen offset:1024
    v_dot2_f32_bf16 v7, v20, s61, v7
    v_dot2_f32_bf16 v7, v21, s61, v7
    v_dot2_f32_bf16 v7, v22, s61, v7
    v_dot2_f32_bf16 v7, v23, s61, v7
    s_waitcnt lgkmcnt(3)
    buffer_store_dwordx4 v[24:27], v2, s[8:11], s47 offen offset:2048
    v_dot2_f32_bf16 v7, v24, s61, v7
    v_dot2_f32_bf16 v7, v25, s61, v7
    v_dot2_f32_bf16 v7, v26, s61, v7
    v_dot2_f32_bf16 v7, v27, s61, v7
    s_waitcnt lgkmcnt(0)
    buffer_store_dwordx4 v[28:31], v2, s[8:11], s47 offen offset:3072
    v_dot2_f32_bf16 v7, v28, s61, v7
    v_dot2_f32_bf16 v7, v29, s61, v7
    v_dot2_f32_bf16 v7, v30, s61, v7
    v_dot2_f32_bf16 v7, v31, s61, v7
    s_cmp_eq_u32 s49, 0
    s_cbranch_scc1 k0_kernel_endx
    s_nop 1
    v_mov_b32 v5, v7
    s_nop 1
    v_permlane32_swap_b32 v7, v5
    s_nop 0
    v_add_f32 v7, v7, v5
    s_lshl_b32 s32, s3, 7
    s_add_u32 s32, s32, 151552
    v_lshlrev_b32 v6, 2, v3
    v_add_u32 v5, s32, v6
    ds_write_b32 v5, v7
    s_waitcnt lgkmcnt(0)
    s_barrier
    s_cmp_lg_u32 s3, 0
    s_cbranch_scc1 k0_kernel_endx
    v_add_u32 v5, 151552, v6
    ds_read_b32 v16, v5 offset:0
    ds_read_b32 v17, v5 offset:128
    ds_read_b32 v18, v5 offset:256
    ds_read_b32 v19, v5 offset:384
    ds_read_b32 v20, v5 offset:512
    ds_read_b32 v21, v5 offset:640
    ds_read_b32 v22, v5 offset:768
    ds_read_b32 v23, v5 offset:896
    s_waitcnt lgkmcnt(0)
    v_add_f32 v16, v16, v17
    v_add_f32 v16, v16, v18
    v_add_f32 v16, v16, v19
    v_add_f32 v16, v16, v20
    v_add_f32 v16, v16, v21
    v_add_f32 v16, v16, v22
    v_add_f32 v16, v16, v23
    v_cmp_gt_u32 vcc, 32, v1
    s_and_saveexec_b64 s[38:39], vcc
    buffer_store_dword v16, v6, s[8:11], s49 offen
    s_branch k0_kernel_endx
k0_kernel_end:
k0_kernel_endx:
    s_endpgm
.globl f1_kernel
.p2align 8
.type f1_kernel,@function
f1_kernel:
    s_cmp_ge_u32 s2, 256
    s_cbranch_scc1 f1_kernel_endx
    s_load_dwordx2 s[6:7], s[0:1], 80
    s_load_dwordx2 s[12:13], s[0:1], 0
    v_and_b32 v1, 63, v0
    v_lshrrev_b32 v2, 6, v0
    v_and_b32 v3, 31, v1
    v_readfirstlane_b32 s3, v2
    v_lshrrev_b32 v4, 5, v1
    v_lshlrev_b32 v2, 4, v1
    s_and_b32 s4, s2, 31
    s_lshr_b32 s5, s2, 5
    s_waitcnt lgkmcnt(0)
    s_mov_b32 s8, s6
    s_mov_b32 s9, s7
    s_mov_b32 s10, 0x4400000
    s_mov_b32 s11, 0x00020000
    s_mov_b32 s16, s12
    s_mov_b32 s17, s13
    s_mov_b32 s18, 0x200000
    s_mov_b32 s19, 0x00020000
    s_and_b32 s20, s3, 3
    s_lshr_b32 s30, s3, 2
    s_and_b32 s21, s20, 1
    s_lshl_b32 s21, s21, 1
    s_lshl_b32 s22, s5, 2
    s_add_u32 s21, s21, s22
    s_lshr_b32 s22, s20, 1
    s_lshl_b32 s23, s4, 1
    s_add_u32 s22, s22, s23
    s_lshl_b32 s22, s22, 5
    s_add_u32 s22, s22, s21
    s_add_u32 s23, s22, s30
    s_xor_b32 s24, s30, 1
    s_add_u32 s24, s22, s24
    s_lshl_b32 s22, s23, 10
    s_lshl_b32 s24, s24, 10
    s_add_u32 s23, s22, 0x700000
    s_add_u32 s24, s24, 0x700000
    buffer_load_dwordx4 v[8:11], v2, s[8:11], s23 offen
    buffer_load_dwordx4 v[12:15], v2, s[8:11], s24 offen
    s_lshl_b32 s23, s3, 10
    s_add_u32 s23, s23, 0x1880000
    buffer_load_dwordx4 v[112:115], v2, s[8:11], s23 offen
    s_lshr_b32 s24, s3, 1
    s_lshl_b32 s24, s24, 10
    s_and_b32 s25, s3, 1
    s_mul_i32 s25, s25, 69632
    s_add_u32 s34, s24, s25
    s_add_u32 s35, s34, 0x1800000
    s_mov_b32 m0, s34
    s_add_u32 s34, s34, 4096
    buffer_load_dwordx4 v2, s[8:11], s35 offen lds
    s_add_u32 s35, s35, 4096
    s_mov_b32 m0, s34
    s_add_u32 s34, s34, 4096
    buffer_load_dwordx4 v2, s[8:11], s35 offen lds
    s_add_u32 s35, s35, 4096
    s_mov_b32 m0, s34
    s_add_u32 s34, s34, 4096
    buffer_load_dwordx4 v2, s[8:11], s35 offen lds
    s_add_u32 s35, s35, 4096
    s_mov_b32 m0, s34
    s_add_u32 s34, s34, 4096
    buffer_load_dwordx4 v2, s[8:11], s35 offen lds
    s_add_u32 s35, s35, 4096
    s_mov_b32 m0, s34
    s_add_u32 s34, s34, 4096
    buffer_load_dwordx4 v2, s[8:11], s35 offen lds
    s_add_u32 s35, s35, 4096
    s_mov_b32 m0, s34
    s_add_u32 s34, s34, 4096
    buffer_load_dwordx4 v2, s[8:11], s35 offen lds
    s_add_u32 s35, s35, 4096
    s_lshl_b32 s40, s4, 8
    s_add_u32 s40, s40, 0x490000
    s_lshl_b32 s41, s3, 2
    s_add_u32 s41, s41, s40
    s_lshl_b32 s32, s5, 2
    s_add_u32 s40, s40, s32
    s_lshr_b32 s32, s3, 1
    s_and_b32 s43, s32, 1
    s_lshr_b32 s44, s3, 2
    s_lshl_b32 s45, s4, 1
    s_add_u32 s45, s45, s43
    s_lshl_b32 s46, s5, 1
    s_add_u32 s46, s46, s44
    s_lshl_b32 s42, s45, 5
    s_lshl_b32 s32, s46, 1
    s_add_u32 s42, s42, s32
    s_and_b32 s47, s3, 1
    s_add_u32 s42, s42, s47
    s_lshl_b32 s42, s42, 10
    s_getreg_b32 s61, hwreg(HW_REG_XCC_ID)
    s_and_b32 s61, s61, 15
    s_add_u32 s61, s61, 1
    v_min_u32 v6, 17, v3
    v_mov_b32 v5, 16
    v_cmp_eq_u32 vcc, 20, v3
    s_mul_i32 s25, s30, 69632
    s_nop 0
    v_cndmask_b32 v6, v6, v5, vcc
    v_lshlrev_b32 v6, 4, v6
    v_mul_u32_u24 v5, 288, v4
    v_add3_u32 v158, v6, v5, 64
    v_add_u32 v158, 960, v158
    v_add_u32 v156, s25, v2
    v_add_u32 v157, s25, v158
    s_waitcnt vmcnt(6)
    v_mov_b32 v5, 0
    v_mov_b32 v6, 0
    v_dot2_f32_bf16 v5, v8, v8, v5
    v_dot2_f32_bf16 v6, v12, v12, v6
    v_dot2_f32_bf16 v5, v9, v9, v5
    v_dot2_f32_bf16 v6, v13, v13, v6
    v_dot2_f32_bf16 v5, v10, v10, v5
    v_dot2_f32_bf16 v6, v14, v14, v6
    v_dot2_f32_bf16 v5, v11, v11, v5
    v_dot2_f32_bf16 v6, v15, v15, v6
    s_nop 2
    v_mov_b32 v154, v5
    s_nop 1
    v_permlane32_swap_b32 v5, v154
    s_nop 0
    v_add_f32 v5, v5, v154
    v_mov_b32 v154, v6
    s_nop 1
    v_permlane32_swap_b32 v6, v154
    s_nop 0
    v_add_f32 v6, v6, v154
    v_max_f32 v5, v5, v6
    v_max3_f32 v7, v112, v113, v114
    v_max_f32 v7, v7, v115
    ds_swizzle_b32 v6, v5 offset:0x41f
    ds_swizzle_b32 v154, v7 offset:0x41f
    s_waitcnt lgkmcnt(0)
    v_max_f32 v5, v5, v6
    v_max_f32 v7, v7, v154
    ds_swizzle_b32 v6, v5 offset:0x81f
    ds_swizzle_b32 v154, v7 offset:0x81f
    s_waitcnt lgkmcnt(0)
    v_max_f32 v5, v5, v6
    v_max_f32 v7, v7, v154
    ds_swizzle_b32 v6, v5 offset:0x101f
    ds_swizzle_b32 v154, v7 offset:0x101f
    s_waitcnt lgkmcnt(0)
    v_max_f32 v5, v5, v6
    v_max_f32 v7, v7, v154
    ds_swizzle_b32 v6, v5 offset:0x201f
    ds_swizzle_b32 v154, v7 offset:0x201f
    s_waitcnt lgkmcnt(0)
    v_max_f32 v5, v5, v6
    v_max_f32 v7, v7, v154
    ds_swizzle_b32 v6, v5 offset:0x401f
    ds_swizzle_b32 v154, v7 offset:0x401f
    s_waitcnt lgkmcnt(0)
    v_max_f32 v5, v5, v6
    v_max_f32 v7, v7, v154
    v_mov_b32 v154, v7
    s_nop 1
    v_permlane32_swap_b32 v7, v154
    s_nop 0
    v_max_f32 v7, v7, v154
    v_readfirstlane_b32 s63, v5
    s_lshl_b32 s23, s3, 2
    s_add_u32 s23, s23, 157696
    v_mov_b32 v6, s23
    ds_write_b32 v6, v7
    v_mov_b32 v32, 0
    v_mov_b32 v48, 0
    v_mov_b32 v112, 0
    v_mov_b32 v33, 0
    v_mov_b32 v49, 0
    v_mov_b32 v113, 0
    v_mov_b32 v34, 0
    v_mov_b32 v50, 0
    v_mov_b32 v114, 0
    v_mov_b32 v35, 0
    v_mov_b32 v51, 0
    v_mov_b32 v115, 0
    v_mov_b32 v36, 0
    v_mov_b32 v52, 0
    v_mov_b32 v116, 0
    v_mov_b32 v37, 0
    v_mov_b32 v53, 0
    v_mov_b32 v117, 0
    v_mov_b32 v38, 0
    v_mov_b32 v54, 0
    v_mov_b32 v118, 0
    v_mov_b32 v39, 0
    v_mov_b32 v55, 0
    v_mov_b32 v119, 0
    v_mov_b32 v40, 0
    v_mov_b32 v56, 0
    v_mov_b32 v120, 0
    v_mov_b32 v41, 0
    v_mov_b32 v57, 0
    v_mov_b32 v121, 0
    v_mov_b32 v42, 0
    v_mov_b32 v58, 0
    v_mov_b32 v122, 0
    v_mov_b32 v43, 0
    v_mov_b32 v59, 0
    v_mov_b32 v123, 0
    v_mov_b32 v44, 0
    v_mov_b32 v60, 0
    v_mov_b32 v124, 0
    v_mov_b32 v45, 0
    v_mov_b32 v61, 0
    v_mov_b32 v125, 0
    v_mov_b32 v46, 0
    v_mov_b32 v62, 0
    v_mov_b32 v126, 0
    v_mov_b32 v47, 0
    v_mov_b32 v63, 0
    v_mov_b32 v127, 0
    v_mov_b32 v104, 0
    v_mov_b32 v144, 0
    v_mov_b32 v105, 0
    v_mov_b32 v145, 0
    v_mov_b32 v106, 0
    v_mov_b32 v146, 0
    v_mov_b32 v107, 0
    v_mov_b32 v147, 0
    v_mov_b32 v108, 0
    v_mov_b32 v148, 0
    v_mov_b32 v109, 0
    v_mov_b32 v149, 0
    v_mov_b32 v110, 0
    v_mov_b32 v150, 0
    v_mov_b32 v111, 0
    v_mov_b32 v151, 0
    s_lshl_b32 s32, s5, 1
    s_lshl_b32 s48, s32, 5
    s_lshl_b32 s33, s3, 2
    s_add_u32 s48, s48, s33
    s_lshl_b32 s48, s48, 10
    s_add_u32 s48, s48, 0x80000
    s_add_u32 s49, s48, 32768
    s_min_u32 s32, s3, 6
    s_mul_i32 s51, s5, 7
    s_add_u32 s51, s51, s32
    s_lshl_b32 s50, s51, 15
    s_add_u32 s50, s50, 0x100000
    s_add_u32 s52, s42, 0x500000
    v_lshlrev_b32 v159, 10, v3
    v_lshl_add_u32 v159, v4, 3, v159
    s_lshl_b32 s52, s45, 15
    s_lshl_b32 s32, s46, 6
    s_add_u32 s52, s52, s32
    s_lshl_b32 s32, s47, 5
    s_add_u32 s52, s52, s32
    s_waitcnt vmcnt(0) lgkmcnt(0)
    s_barrier
    ds_read_b128 v[128:131], v156
    ds_read_b128 v[132:135], v156 offset:2176
    ds_read_b128 v[136:139], v157
    ds_read_b128 v[140:143], v157 offset:576
    s_cmp_lt_u32 s3, 4
    s_cbranch_scc1 F0_noprio
    s_setprio 1
F0_noprio:
    s_waitcnt lgkmcnt(3)
    v_mfma_f32_32x32x16_bf16 v[64:79], v[128:131], v[8:11], 0
    s_nop 9
    s_mov_b32 s29, 0
    v_mfma_f32_32x32x16_bf16 v[80:95], v[128:131], v[12:15], 0
    v_exp_f32 v112, v64
    v_exp_f32 v113, v65
    v_cvt_pk_bf16_f32 v110, v124, v125
    v_exp_f32 v114, v66
    v_exp_f32 v115, v67
    v_cvt_pk_bf16_f32 v111, v126, v127
    s_mov_b32 m0, s34
    s_add_u32 s34, s34, 4096
    buffer_load_dwordx4 v2, s[8:11], s35 offen lds
    s_add_u32 s35, s35, 4096
    v_exp_f32 v116, v68
    v_exp_f32 v117, v69
    v_cvt_pk_bf16_f32 v96, v112, v113
    v_exp_f32 v118, v70
    v_exp_f32 v119, v71
    v_cvt_pk_bf16_f32 v97, v114, v115
    v_mfma_f32_32x32x16_bf16 v[48:63], v[144:147], v[104:107], v[48:63]
    v_exp_f32 v120, v72
    v_exp_f32 v121, v73
    v_cvt_pk_bf16_f32 v98, v116, v117
    s_mov_b32 m0, s34
    s_add_u32 s34, s34, 4096
    buffer_load_dwordx4 v2, s[8:11], s35 offen lds
    s_add_u32 s35, s35, 4096
    v_exp_f32 v122, v74
    v_exp_f32 v123, v75
    v_cvt_pk_bf16_f32 v99, v118, v119
    s_mov_b32 m0, s34
    s_add_u32 s34, s34, 4096
    buffer_load_dwordx4 v2, s[8:11], s35 offen lds
    s_add_u32 s35, s35, 4096
    v_exp_f32 v124, v76
    v_exp_f32 v125, v77
    v_cvt_pk_bf16_f32 v100, v120, v121
    v_mfma_f32_32x32x16_bf16 v[48:63], v[148:151], v[108:111], v[48:63]
    v_exp_f32 v126, v78
    v_exp_f32 v127, v79
    v_cvt_pk_bf16_f32 v101, v122, v123
    s_waitcnt lgkmcnt(0)
    v_mfma_f32_32x32x16_bf16 v[64:79], v[132:135], v[8:11], 0
    ds_read_b128 v[128:131], v156 offset:4352
    ds_read_b128 v[144:147], v157 offset:2176
    ds_read_b128 v[148:151], v157 offset:2752
    v_exp_f32 v112, v80
    v_exp_f32 v113, v81
    v_cvt_pk_bf16_f32 v102, v124, v125
    v_exp_f32 v114, v82
    v_exp_f32 v115, v83
    v_cvt_pk_bf16_f32 v103, v126, v127
    s_mov_b32 m0, s34
    s_add_u32 s34, s34, 4096
    buffer_load_dwordx4 v2, s[8:11], s35 offen lds
    s_add_u32 s35, s35, 4096
    v_exp_f32 v116, v84
    v_exp_f32 v117, v85
    v_cvt_pk_bf16_f32 v104, v112, v113
    v_exp_f32 v118, v86
    v_exp_f32 v119, v87
    v_cvt_pk_bf16_f32 v105, v114, v115
    v_mfma_f32_32x32x16_bf16 v[32:47], v[136:139], v[96:99], v[32:47]
    v_exp_f32 v120, v88
    v_exp_f32 v121, v89
    v_cvt_pk_bf16_f32 v106, v116, v117
    s_mov_b32 m0, s34
    s_add_u32 s34, s34, 4096
    buffer_load_dwordx4 v2, s[8:11], s35 offen lds
    s_add_u32 s35, s35, 4096
    v_exp_f32 v122, v90
    v_exp_f32 v123, v91
    v_cvt_pk_bf16_f32 v107, v118, v119
    s_mov_b32 m0, s34
    s_add_u32 s34, s34, 4096
    buffer_load_dwordx4 v2, s[8:11], s35 offen lds
    s_add_u32 s35, s35, 4096
    v_exp_f32 v124, v92
    v_exp_f32 v125, v93
    v_cvt_pk_bf16_f32 v108, v120, v121
    v_mfma_f32_32x32x16_bf16 v[32:47], v[140:143], v[100:103], v[32:47]
    v_exp_f32 v126, v94
    v_exp_f32 v127, v95
    v_cvt_pk_bf16_f32 v109, v122, v123
    v_mfma_f32_32x32x16_bf16 v[80:95], v[132:135], v[12:15], 0
    v_exp_f32 v112, v64
    v_exp_f32 v113, v65
    v_cvt_pk_bf16_f32 v110, v124, v125
    v_exp_f32 v114, v66
    v_exp_f32 v115, v67
    v_cvt_pk_bf16_f32 v111, v126, v127
    s_mov_b32 m0, s34
    s_add_u32 s34, s34, 4096
    buffer_load_dwordx4 v2, s[8:11], s35 offen lds
    s_add_u32 s35, s35, 4096
    v_exp_f32 v116, v68
    v_exp_f32 v117, v69
    v_cvt_pk_bf16_f32 v96, v112, v113
    v_exp_f32 v118, v70
    v_exp_f32 v119, v71
    v_cvt_pk_bf16_f32 v97, v114, v115
    v_mfma_f32_32x32x16_bf16 v[48:63], v[136:139], v[104:107], v[48:63]
    v_exp_f32 v120, v72
    v_exp_f32 v121, v73
    v_cvt_pk_bf16_f32 v98, v116, v117
    s_mov_b32 m0, s34
    s_add_u32 s34, s34, 4096
    buffer_load_dwordx4 v2, s[8:11], s35 offen lds
    s_add_u32 s35, s35, 4096
    v_exp_f32 v122, v74
    v_exp_f32 v123, v75
    v_cvt_pk_bf16_f32 v99, v118, v119
    s_mov_b32 m0, s34
    s_add_u32 s34, s34, 4096
    buffer_load_dwordx4 v2, s[8:11], s35 offen lds
    s_add_u32 s35, s35, 4096
    v_exp_f32 v124, v76
    v_exp_f32 v125, v77
    v_cvt_pk_bf16_f32 v100, v120, v121
    v_mfma_f32_32x32x16_bf16 v[48:63], v[140:143], v[108:111], v[48:63]
    v_exp_f32 v126, v78
    v_exp_f32 v127, v79
    v_cvt_pk_bf16_f32 v101, v122, v123
    s_waitcnt lgkmcnt(0)
    v_mfma_f32_32x32x16_bf16 v[64:79], v[128:131], v[8:11], 0
    ds_read_b128 v[132:135], v156 offset:6528
    ds_read_b128 v[136:139], v157 offset:4352
    ds_read_b128 v[140:143], v157 offset:4928
    v_exp_f32 v112, v80
    v_exp_f32 v113, v81
    v_cvt_pk_bf16_f32 v102, v124, v125
    v_exp_f32 v114, v82
    v_exp_f32 v115, v83
    v_cvt_pk_bf16_f32 v103, v126, v127
    s_mov_b32 m0, s34
    s_add_u32 s34, s34, 4096
    buffer_load_dwordx4 v2, s[8:11], s35 offen lds
    s_add_u32 s35, s35, 4096
    v_exp_f32 v116, v84
    v_exp_f32 v117, v85
    v_cvt_pk_bf16_f32 v104, v112, v113
    v_exp_f32 v118, v86
    v_exp_f32 v119, v87
    v_cvt_pk_bf16_f32 v105, v114, v115
    v_mfma_f32_32x32x16_bf16 v[32:47], v[144:147], v[96:99], v[32:47]
    v_exp_f32 v120, v88
    v_exp_f32 v121, v89
    v_cvt_pk_bf16_f32 v106, v116, v117
    s_mov_b32 m0, s34
    s_add_u32 s34, s34, 4096
    buffer_load_dwordx4 v2, s[8:11], s35 offen lds
    s_add_u32 s35, s35, 4096
    v_exp_f32 v122, v90
    v_exp_f32 v123, v91
    v_cvt_pk_bf16_f32 v107, v118, v119
    v_exp_f32 v124, v92
    v_exp_f32 v125, v93
    v_cvt_pk_bf16_f32 v108, v120, v121
    v_mfma_f32_32x32x16_bf16 v[32:47], v[148:151], v[100:103], v[32:47]
    v_exp_f32 v126, v94
    v_exp_f32 v127, v95
    v_cvt_pk_bf16_f32 v109, v122, v123
    v_mfma_f32_32x32x16_bf16 v[80:95], v[128:131], v[12:15], 0
    v_exp_f32 v112, v64
    v_exp_f32 v113, v65
    v_cvt_pk_bf16_f32 v110, v124, v125
    v_exp_f32 v114, v66
    v_exp_f32 v115, v67
    v_cvt_pk_bf16_f32 v111, v126, v127
    v_exp_f32 v116, v68
    v_exp_f32 v117, v69
    v_cvt_pk_bf16_f32 v96, v112, v113
    v_exp_f32 v118, v70
    v_exp_f32 v119, v71
    v_cvt_pk_bf16_f32 v97, v114, v115
    v_mfma_f32_32x32x16_bf16 v[48:63], v[144:147], v[104:107], v[48:63]
    v_exp_f32 v120, v72
    v_exp_f32 v121, v73
    v_cvt_pk_bf16_f32 v98, v116, v117
    v_exp_f32 v122, v74
    v_exp_f32 v123, v75
    v_cvt_pk_bf16_f32 v99, v118, v119
    v_exp_f32 v124, v76
    v_exp_f32 v125, v77
    v_cvt_pk_bf16_f32 v100, v120, v121
    v_mfma_f32_32x32x16_bf16 v[48:63], v[148:151], v[108:111], v[48:63]
    v_exp_f32 v126, v78
    v_exp_f32 v127, v79
    v_cvt_pk_bf16_f32 v101, v122, v123
    s_waitcnt lgkmcnt(0)
    v_mfma_f32_32x32x16_bf16 v[64:79], v[132:135], v[8:11], 0
    ds_read_b128 v[128:131], v156 offset:8704
    ds_read_b128 v[144:147], v157 offset:6528
    ds_read_b128 v[148:151], v157 offset:7104
    v_exp_f32 v112, v80
    v_exp_f32 v113, v81
    v_cvt_pk_bf16_f32 v102, v124, v125
    v_exp_f32 v114, v82
    v_exp_f32 v115, v83
    v_cvt_pk_bf16_f32 v103, v126, v127
    v_exp_f32 v116, v84
    v_exp_f32 v117, v85
    v_cvt_pk_bf16_f32 v104, v112, v113
    v_exp_f32 v118, v86
    v_exp_f32 v119, v87
    v_cvt_pk_bf16_f32 v105, v114, v115
    v_mfma_f32_32x32x16_bf16 v[32:47], v[136:139], v[96:99], v[32:47]
    v_exp_f32 v120, v88
    v_exp_f32 v121, v89
    v_cvt_pk_bf16_f32 v106, v116, v117
    v_exp_f32 v122, v90
    v_exp_f32 v123, v91
    v_cvt_pk_bf16_f32 v107, v118, v119
    v_exp_f32 v124, v92
    v_exp_f32 v125, v93
    v_cvt_pk_bf16_f32 v108, v120, v121
    v_mfma_f32_32x32x16_bf16 v[32:47], v[140:143], v[100:103], v[32:47]
    v_exp_f32 v126, v94
    v_exp_f32 v127, v95
    v_cvt_pk_bf16_f32 v109, v122, v123
    v_mfma_f32_32x32x16_bf16 v[80:95], v[132:135], v[12:15], 0
    v_exp_f32 v112, v64
    v_exp_f32 v113, v65
    v_cvt_pk_bf16_f32 v110, v124, v125
    v_exp_f32 v114, v66
    v_exp_f32 v115, v67
    v_cvt_pk_bf16_f32 v111, v126, v127
    v_exp_f32 v116, v68
    v_exp_f32 v117, v69
    v_cvt_pk_bf16_f32 v96, v112, v113
    v_exp_f32 v118, v70
    v_exp_f32 v119, v71
    v_cvt_pk_bf16_f32 v97, v114, v115
    v_mfma_f32_32x32x16_bf16 v[48:63], v[136:139], v[104:107], v[48:63]
    v_exp_f32 v120, v72
    v_exp_f32 v121, v73
    v_cvt_pk_bf16_f32 v98, v116, v117
    v_exp_f32 v122, v74
    v_exp_f32 v123, v75
    v_cvt_pk_bf16_f32 v99, v118, v119
    v_exp_f32 v124, v76
    v_exp_f32 v125, v77
    v_cvt_pk_bf16_f32 v100, v120, v121
    v_mfma_f32_32x32x16_bf16 v[48:63], v[140:143], v[108:111], v[48:63]
    v_exp_f32 v126, v78
    v_exp_f32 v127, v79
    v_cvt_pk_bf16_f32 v101, v122, v123
    s_waitcnt lgkmcnt(0)
    v_mfma_f32_32x32x16_bf16 v[64:79], v[128:131], v[8:11], 0
    ds_read_b128 v[132:135], v156 offset:10880
    ds_read_b128 v[136:139], v157 offset:8704
    ds_read_b128 v[140:143], v157 offset:9280
    v_exp_f32 v112, v80
    v_exp_f32 v113, v81
    v_cvt_pk_bf16_f32 v102, v124, v125
    v_exp_f32 v114, v82
    v_exp_f32 v115, v83
    v_cvt_pk_bf16_f32 v103, v126, v127
    v_exp_f32 v116, v84
    v_exp_f32 v117, v85
    v_cvt_pk_bf16_f32 v104, v112, v113
    v_exp_f32 v118, v86
    v_exp_f32 v119, v87
    v_cvt_pk_bf16_f32 v105, v114, v115
    v_mfma_f32_32x32x16_bf16 v[32:47], v[144:147], v[96:99], v[32:47]
    v_exp_f32 v120, v88
    v_exp_f32 v121, v89
    v_cvt_pk_bf16_f32 v106, v116, v117
    v_exp_f32 v122, v90
    v_exp_f32 v123, v91
    v_cvt_pk_bf16_f32 v107, v118, v119
    v_exp_f32 v124, v92
    v_exp_f32 v125, v93
    v_cvt_pk_bf16_f32 v108, v120, v121
    v_mfma_f32_32x32x16_bf16 v[32:47], v[148:151], v[100:103], v[32:47]
    v_exp_f32 v126, v94
    v_exp_f32 v127, v95
    v_cvt_pk_bf16_f32 v109, v122, v123
    v_add_u32 v156, 8704, v156
    v_add_u32 v157, 8704, v157
    s_add_u32 s29, s29, 1
    s_cmp_lg_u32 s29, 8
    v_mfma_f32_32x32x16_bf16 v[80:95], v[128:131], v[12:15], 0
    v_exp_f32 v112, v64
    v_exp_f32 v113, v65
    v_cvt_pk_bf16_f32 v110, v124, v125
    v_exp_f32 v114, v66
    v_exp_f32 v115, v67
    v_cvt_pk_bf16_f32 v111, v126, v127
    v_exp_f32 v116, v68
    v_exp_f32 v117, v69
    v_cvt_pk_bf16_f32 v96, v112, v113
    v_exp_f32 v118, v70
    v_exp_f32 v119, v71
    v_cvt_pk_bf16_f32 v97, v114, v115
    v_mfma_f32_32x32x16_bf16 v[48:63], v[144:147], v[104:107], v[48:63]
    v_exp_f32 v120, v72
    v_exp_f32 v121, v73
    v_cvt_pk_bf16_f32 v98, v116, v117
    v_exp_f32 v122, v74
    v_exp_f32 v123, v75
    v_cvt_pk_bf16_f32 v99, v118, v119
    v_exp_f32 v124, v76
    v_exp_f32 v125, v77
    v_cvt_pk_bf16_f32 v100, v120, v121
    v_mfma_f32_32x32x16_bf16 v[48:63], v[148:151], v[108:111], v[48:63]
    v_exp_f32 v126, v78
    v_exp_f32 v127, v79
    v_cvt_pk_bf16_f32 v101, v122, v123
    s_waitcnt lgkmcnt(0)
    v_mfma_f32_32x32x16_bf16 v[64:79], v[132:135], v[8:11], 0
    ds_read_b128 v[128:131], v156 offset:4352
    ds_read_b128 v[144:147], v157 offset:2176
    ds_read_b128 v[148:151], v157 offset:2752
    v_exp_f32 v112, v80
    v_exp_f32 v113, v81
    v_cvt_pk_bf16_f32 v102, v124, v125
    v_exp_f32 v114, v82
    v_exp_f32 v115, v83
    v_cvt_pk_bf16_f32 v103, v126, v127
    v_exp_f32 v116, v84
    v_exp_f32 v117, v85
    v_cvt_pk_bf16_f32 v104, v112, v113
    v_exp_f32 v118, v86
    v_exp_f32 v119, v87
    v_cvt_pk_bf16_f32 v105, v114, v115
    v_mfma_f32_32x32x16_bf16 v[32:47], v[136:139], v[96:99], v[32:47]
    v_exp_f32 v120, v88
    v_exp_f32 v121, v89
    v_cvt_pk_bf16_f32 v106, v116, v117
    v_exp_f32 v122, v90
    v_exp_f32 v123, v91
    v_cvt_pk_bf16_f32 v107, v118, v119
    v_exp_f32 v124, v92
    v_exp_f32 v125, v93
    v_cvt_pk_bf16_f32 v108, v120, v121
    v_mfma_f32_32x32x16_bf16 v[32:47], v[140:143], v[100:103], v[32:47]
    v_exp_f32 v126, v94
    v_exp_f32 v127, v95
    v_cvt_pk_bf16_f32 v109, v122, v123
    v_mfma_f32_32x32x16_bf16 v[80:95], v[132:135], v[12:15], 0
    v_exp_f32 v112, v64
    v_exp_f32 v113, v65
    v_cvt_pk_bf16_f32 v110, v124, v125
    v_exp_f32 v114, v66
    v_exp_f32 v115, v67
    v_cvt_pk_bf16_f32 v111, v126, v127
    v_exp_f32 v116, v68
    v_exp_f32 v117, v69
    v_cvt_pk_bf16_f32 v96, v112, v113
    v_exp_f32 v118, v70
    v_exp_f32 v119, v71
    v_cvt_pk_bf16_f32 v97, v114, v115
    v_mfma_f32_32x32x16_bf16 v[48:63], v[136:139], v[104:107], v[48:63]
    v_exp_f32 v120, v72
    v_exp_f32 v121, v73
    v_cvt_pk_bf16_f32 v98, v116, v117
    v_exp_f32 v122, v74
    v_exp_f32 v123, v75
    v_cvt_pk_bf16_f32 v99, v118, v119
    v_exp_f32 v124, v76
    v_exp_f32 v125, v77
    v_cvt_pk_bf16_f32 v100, v120, v121
    v_mfma_f32_32x32x16_bf16 v[48:63], v[140:143], v[108:111], v[48:63]
    v_exp_f32 v126, v78
    v_exp_f32 v127, v79
    v_cvt_pk_bf16_f32 v101, v122, v123
    s_waitcnt lgkmcnt(0)
    v_mfma_f32_32x32x16_bf16 v[64:79], v[128:131], v[8:11], 0
    ds_read_b128 v[132:135], v156 offset:6528
    ds_read_b128 v[136:139], v157 offset:4352
    ds_read_b128 v[140:143], v157 offset:4928
    v_exp_f32 v112, v80
    v_exp_f32 v113, v81
    v_cvt_pk_bf16_f32 v102, v124, v125
    v_exp_f32 v114, v82
    v_exp_f32 v115, v83
    v_cvt_pk_bf16_f32 v103, v126, v127
    v_exp_f32 v116, v84
    v_exp_f32 v117, v85
    v_cvt_pk_bf16_f32 v104, v112, v113
    v_exp_f32 v118, v86
    v_exp_f32 v119, v87
    v_cvt_pk_bf16_f32 v105, v114, v115
    v_mfma_f32_32x32x16_bf16 v[32:47], v[144:147], v[96:99], v[32:47]
    v_exp_f32 v120, v88
    v_exp_f32 v121, v89
    v_cvt_pk_bf16_f32 v106, v116, v117
    v_exp_f32 v122, v90
    v_exp_f32 v123, v91
    v_cvt_pk_bf16_f32 v107, v118, v119
    v_exp_f32 v124, v92
    v_exp_f32 v125, v93
    v_cvt_pk_bf16_f32 v108, v120, v121
    v_mfma_f32_32x32x16_bf16 v[32:47], v[148:151], v[100:103], v[32:47]
    v_exp_f32 v126, v94
    v_exp_f32 v127, v95
    v_cvt_pk_bf16_f32 v109, v122, v123
    v_mfma_f32_32x32x16_bf16 v[80:95], v[128:131], v[12:15], 0
    v_exp_f32 v112, v64
    v_exp_f32 v113, v65
    v_cvt_pk_bf16_f32 v110, v124, v125
    v_exp_f32 v114, v66
    v_exp_f32 v115, v67
    v_cvt_pk_bf16_f32 v111, v126, v127
    v_exp_f32 v116, v68
    v_exp_f32 v117, v69
    v_cvt_pk_bf16_f32 v96, v112, v113
    v_exp_f32 v118, v70
    v_exp_f32 v119, v71
    v_cvt_pk_bf16_f32 v97, v114, v115
    v_mfma_f32_32x32x16_bf16 v[48:63], v[144:147], v[104:107], v[48:63]
    v_exp_f32 v120, v72
    v_exp_f32 v121, v73
    v_cvt_pk_bf16_f32 v98, v116, v117
    v_exp_f32 v122, v74
    v_exp_f32 v123, v75
    v_cvt_pk_bf16_f32 v99, v118, v119
    v_exp_f32 v124, v76
    v_exp_f32 v125, v77
    v_cvt_pk_bf16_f32 v100, v120, v121
    v_mfma_f32_32x32x16_bf16 v[48:63], v[148:151], v[108:111], v[48:63]
    v_exp_f32 v126, v78
    v_exp_f32 v127, v79
    v_cvt_pk_bf16_f32 v101, v122, v123
    s_waitcnt lgkmcnt(0)
    v_mfma_f32_32x32x16_bf16 v[64:79], v[132:135], v[8:11], 0
    ds_read_b128 v[128:131], v156 offset:8704
    ds_read_b128 v[144:147], v157 offset:6528
    ds_read_b128 v[148:151], v157 offset:7104
    v_exp_f32 v112, v80
    v_exp_f32 v113, v81
    v_cvt_pk_bf16_f32 v102, v124, v125
    v_exp_f32 v114, v82
    v_exp_f32 v115, v83
    v_cvt_pk_bf16_f32 v103, v126, v127
    v_exp_f32 v116, v84
    v_exp_f32 v117, v85
    v_cvt_pk_bf16_f32 v104, v112, v113
    v_exp_f32 v118, v86
    v_exp_f32 v119, v87
    v_cvt_pk_bf16_f32 v105, v114, v115
    v_mfma_f32_32x32x16_bf16 v[32:47], v[136:139], v[96:99], v[32:47]
    v_exp_f32 v120, v88
    v_exp_f32 v121, v89
    v_cvt_pk_bf16_f32 v106, v116, v117
    v_exp_f32 v122, v90
    v_exp_f32 v123, v91
    v_cvt_pk_bf16_f32 v107, v118, v119
    v_exp_f32 v124, v92
    v_exp_f32 v125, v93
    v_cvt_pk_bf16_f32 v108, v120, v121
    v_mfma_f32_32x32x16_bf16 v[32:47], v[140:143], v[100:103], v[32:47]
    v_exp_f32 v126, v94
    v_exp_f32 v127, v95
    v_cvt_pk_bf16_f32 v109, v122, v123
    v_mfma_f32_32x32x16_bf16 v[80:95], v[132:135], v[12:15], 0
    v_exp_f32 v112, v64
    v_exp_f32 v113, v65
    v_cvt_pk_bf16_f32 v110, v124, v125
    v_exp_f32 v114, v66
    v_exp_f32 v115, v67
    v_cvt_pk_bf16_f32 v111, v126, v127
    v_exp_f32 v116, v68
    v_exp_f32 v117, v69
    v_cvt_pk_bf16_f32 v96, v112, v113
    v_exp_f32 v118, v70
    v_exp_f32 v119, v71
    v_cvt_pk_bf16_f32 v97, v114, v115
    v_mfma_f32_32x32x16_bf16 v[48:63], v[136:139], v[104:107], v[48:63]
    v_exp_f32 v120, v72
    v_exp_f32 v121, v73
    v_cvt_pk_bf16_f32 v98, v116, v117
    v_exp_f32 v122, v74
    v_exp_f32 v123, v75
    v_cvt_pk_bf16_f32 v99, v118, v119
    v_exp_f32 v124, v76
    v_exp_f32 v125, v77
    v_cvt_pk_bf16_f32 v100, v120, v121
    v_mfma_f32_32x32x16_bf16 v[48:63], v[140:143], v[108:111], v[48:63]
    v_exp_f32 v126, v78
    v_exp_f32 v127, v79
    v_cvt_pk_bf16_f32 v101, v122, v123
    s_waitcnt lgkmcnt(0)
    v_mfma_f32_32x32x16_bf16 v[64:79], v[128:131], v[8:11], 0
    ds_read_b128 v[132:135], v156 offset:10880
    ds_read_b128 v[136:139], v157 offset:8704
    ds_read_b128 v[140:143], v157 offset:9280
    v_exp_f32 v112, v80
    v_exp_f32 v113, v81
    v_cvt_pk_bf16_f32 v102, v124, v125
    v_exp_f32 v114, v82
    v_exp_f32 v115, v83
    v_cvt_pk_bf16_f32 v103, v126, v127
    v_exp_f32 v116, v84
    v_exp_f32 v117, v85
    v_cvt_pk_bf16_f32 v104, v112, v113
    v_exp_f32 v118, v86
    v_exp_f32 v119, v87
    v_cvt_pk_bf16_f32 v105, v114, v115
    v_mfma_f32_32x32x16_bf16 v[32:47], v[144:147], v[96:99], v[32:47]
    v_exp_f32 v120, v88
    v_exp_f32 v121, v89
    v_cvt_pk_bf16_f32 v106, v116, v117
    v_exp_f32 v122, v90
    v_exp_f32 v123, v91
    v_cvt_pk_bf16_f32 v107, v118, v119
    v_exp_f32 v124, v92
    v_exp_f32 v125, v93
    v_cvt_pk_bf16_f32 v108, v120, v121
    v_mfma_f32_32x32x16_bf16 v[32:47], v[148:151], v[100:103], v[32:47]
    v_exp_f32 v126, v94
    v_exp_f32 v127, v95
    v_cvt_pk_bf16_f32 v109, v122, v123
    v_add_u32 v156, 8704, v156
    v_add_u32 v157, 8704, v157
    s_add_u32 s29, s29, 1
    s_cmp_lg_u32 s29, 8
    s_waitcnt vmcnt(0)
    s_barrier
    s_cmp_lg_u32 s3, 0
    s_cbranch_scc1 F0_noxid
    v_mov_b32 v5, s61
    v_mov_b32 v6, 0
    s_mov_b64 exec, 1
    buffer_store_dword v5, v6, s[8:11], s40 offen offset:64 sc0 sc1
    s_mov_b64 exec, -1
F0_noxid:
    v_mfma_f32_32x32x16_bf16 v[80:95], v[128:131], v[12:15], 0
    v_exp_f32 v112, v64
    v_exp_f32 v113, v65
    v_cvt_pk_bf16_f32 v110, v124, v125
    v_exp_f32 v114, v66
    v_exp_f32 v115, v67
    v_cvt_pk_bf16_f32 v111, v126, v127
    v_exp_f32 v116, v68
    v_exp_f32 v117, v69
    v_cvt_pk_bf16_f32 v96, v112, v113
    buffer_load_dwordx4 a[0:3], v2, s[8:11], s48 offen offset:0
    v_exp_f32 v118, v70
    v_exp_f32 v119, v71
    v_cvt_pk_bf16_f32 v97, v114, v115
    v_mfma_f32_32x32x16_bf16 v[48:63], v[144:147], v[104:107], v[48:63]
    v_exp_f32 v120, v72
    v_exp_f32 v121, v73
    v_cvt_pk_bf16_f32 v98, v116, v117
    v_exp_f32 v122, v74
    v_exp_f32 v123, v75
    v_cvt_pk_bf16_f32 v99, v118, v119
    v_exp_f32 v124, v76
    v_exp_f32 v125, v77
    v_cvt_pk_bf16_f32 v100, v120, v121
    v_mfma_f32_32x32x16_bf16 v[48:63], v[148:151], v[108:111], v[48:63]
    buffer_load_dwordx4 a[4:7], v2, s[8:11], s49 offen offset:0
    v_exp_f32 v126, v78
    v_exp_f32 v127, v79
    v_cvt_pk_bf16_f32 v101, v122, v123
    s_waitcnt lgkmcnt(0)
    v_mfma_f32_32x32x16_bf16 v[64:79], v[132:135], v[8:11], 0
    ds_read_b128 v[128:131], v156 offset:4352
    ds_read_b128 v[144:147], v157 offset:2176
    ds_read_b128 v[148:151], v157 offset:2752
    v_exp_f32 v112, v80
    v_exp_f32 v113, v81
    v_cvt_pk_bf16_f32 v102, v124, v125
    v_exp_f32 v114, v82
    v_exp_f32 v115, v83
    v_cvt_pk_bf16_f32 v103, v126, v127
    v_exp_f32 v116, v84
    v_exp_f32 v117, v85
    v_cvt_pk_bf16_f32 v104, v112, v113
    buffer_load_dwordx4 a[8:11], v2, s[8:11], s48 offen offset:1024
    v_exp_f32 v118, v86
    v_exp_f32 v119, v87
    v_cvt_pk_bf16_f32 v105, v114, v115
    v_mfma_f32_32x32x16_bf16 v[32:47], v[136:139], v[96:99], v[32:47]
    v_exp_f32 v120, v88
    v_exp_f32 v121, v89
    v_cvt_pk_bf16_f32 v106, v116, v117
    v_exp_f32 v122, v90
    v_exp_f32 v123, v91
    v_cvt_pk_bf16_f32 v107, v118, v119
    v_exp_f32 v124, v92
    v_exp_f32 v125, v93
    v_cvt_pk_bf16_f32 v108, v120, v121
    v_mfma_f32_32x32x16_bf16 v[32:47], v[140:143], v[100:103], v[32:47]
    buffer_load_dwordx4 a[12:15], v2, s[8:11], s49 offen offset:1024
    v_exp_f32 v126, v94
    v_exp_f32 v127, v95
    v_cvt_pk_bf16_f32 v109, v122, v123
    v_mfma_f32_32x32x16_bf16 v[80:95], v[132:135], v[12:15], 0
    v_exp_f32 v112, v64
    v_exp_f32 v113, v65
    v_cvt_pk_bf16_f32 v110, v124, v125
    v_exp_f32 v114, v66
    v_exp_f32 v115, v67
    v_cvt_pk_bf16_f32 v111, v126, v127
    v_exp_f32 v116, v68
    v_exp_f32 v117, v69
    v_cvt_pk_bf16_f32 v96, v112, v113
    buffer_load_dwordx4 a[16:19], v2, s[8:11], s48 offen offset:2048
    v_exp_f32 v118, v70
    v_exp_f32 v119, v71
    v_cvt_pk_bf16_f32 v97, v114, v115
    v_mfma_f32_32x32x16_bf16 v[48:63], v[136:139], v[104:107], v[48:63]
    v_exp_f32 v120, v72
    v_exp_f32 v121, v73
    v_cvt_pk_bf16_f32 v98, v116, v117
    v_exp_f32 v122, v74
    v_exp_f32 v123, v75
    v_cvt_pk_bf16_f32 v99, v118, v119
    v_exp_f32 v124, v76
    v_exp_f32 v125, v77
    v_cvt_pk_bf16_f32 v100, v120, v121
    v_mfma_f32_32x32x16_bf16 v[48:63], v[140:143], v[108:111], v[48:63]
    buffer_load_dwordx4 a[20:23], v2, s[8:11], s49 offen offset:2048
    v_exp_f32 v126, v78
    v_exp_f32 v127, v79
    v_cvt_pk_bf16_f32 v101, v122, v123
    s_waitcnt lgkmcnt(0)
    v_mfma_f32_32x32x16_bf16 v[64:79], v[128:131], v[8:11], 0
    ds_read_b128 v[132:135], v156 offset:6528
    ds_read_b128 v[136:139], v157 offset:4352
    ds_read_b128 v[140:143], v157 offset:4928
    v_exp_f32 v112, v80
    v_exp_f32 v113, v81
    v_cvt_pk_bf16_f32 v102, v124, v125
    v_exp_f32 v114, v82
    v_exp_f32 v115, v83
    v_cvt_pk_bf16_f32 v103, v126, v127
    v_exp_f32 v116, v84
    v_exp_f32 v117, v85
    v_cvt_pk_bf16_f32 v104, v112, v113
    buffer_load_dwordx4 a[24:27], v2, s[8:11], s48 offen offset:3072
    v_exp_f32 v118, v86
    v_exp_f32 v119, v87
    v_cvt_pk_bf16_f32 v105, v114, v115
    v_mfma_f32_32x32x16_bf16 v[32:47], v[144:147], v[96:99], v[32:47]
    v_exp_f32 v120, v88
    v_exp_f32 v121, v89
    v_cvt_pk_bf16_f32 v106, v116, v117
    v_exp_f32 v122, v90
    v_exp_f32 v123, v91
    v_cvt_pk_bf16_f32 v107, v118, v119
    v_exp_f32 v124, v92
    v_exp_f32 v125, v93
    v_cvt_pk_bf16_f32 v108, v120, v121
    v_mfma_f32_32x32x16_bf16 v[32:47], v[148:151], v[100:103], v[32:47]
    buffer_load_dwordx4 a[28:31], v2, s[8:11], s49 offen offset:3072
    v_exp_f32 v126, v94
    v_exp_f32 v127, v95
    v_cvt_pk_bf16_f32 v109, v122, v123
    v_mfma_f32_32x32x16_bf16 v[80:95], v[128:131], v[12:15], 0
    v_exp_f32 v112, v64
    v_exp_f32 v113, v65
    v_cvt_pk_bf16_f32 v110, v124, v125
    v_exp_f32 v114, v66
    v_exp_f32 v115, v67
    v_cvt_pk_bf16_f32 v111, v126, v127
    v_exp_f32 v116, v68
    v_exp_f32 v117, v69
    v_cvt_pk_bf16_f32 v96, v112, v113
    buffer_load_dwordx2 a[32:33], v159, s[16:19], s52 offen
    buffer_load_dwordx2 a[34:35], v159, s[16:19], s52 offen offset:16
    v_exp_f32 v118, v70
    v_exp_f32 v119, v71
    v_cvt_pk_bf16_f32 v97, v114, v115
    v_mfma_f32_32x32x16_bf16 v[48:63], v[144:147], v[104:107], v[48:63]
    v_exp_f32 v120, v72
    v_exp_f32 v121, v73
    v_cvt_pk_bf16_f32 v98, v116, v117
    v_exp_f32 v122, v74
    v_exp_f32 v123, v75
    v_cvt_pk_bf16_f32 v99, v118, v119
    v_exp_f32 v124, v76
    v_exp_f32 v125, v77
    v_cvt_pk_bf16_f32 v100, v120, v121
    v_mfma_f32_32x32x16_bf16 v[48:63], v[148:151], v[108:111], v[48:63]
    buffer_load_dwordx4 a[36:39], v2, s[8:11], s50 offen offset:0
    v_exp_f32 v126, v78
    v_exp_f32 v127, v79
    v_cvt_pk_bf16_f32 v101, v122, v123
    s_waitcnt lgkmcnt(0)
    v_mfma_f32_32x32x16_bf16 v[64:79], v[132:135], v[8:11], 0
    ds_read_b128 v[128:131], v156 offset:8704
    ds_read_b128 v[144:147], v157 offset:6528
    ds_read_b128 v[148:151], v157 offset:7104
    v_exp_f32 v112, v80
    v_exp_f32 v113, v81
    v_cvt_pk_bf16_f32 v102, v124, v125
    v_exp_f32 v114, v82
    v_exp_f32 v115, v83
    v_cvt_pk_bf16_f32 v103, v126, v127
    v_exp_f32 v116, v84
    v_exp_f32 v117, v85
    v_cvt_pk_bf16_f32 v104, v112, v113
    v_exp_f32 v118, v86
    v_exp_f32 v119, v87
    v_cvt_pk_bf16_f32 v105, v114, v115
    v_mfma_f32_32x32x16_bf16 v[32:47], v[136:139], v[96:99], v[32:47]
    v_exp_f32 v120, v88
    v_exp_f32 v121, v89
    v_cvt_pk_bf16_f32 v106, v116, v117
    v_exp_f32 v122, v90
    v_exp_f32 v123, v91
    v_cvt_pk_bf16_f32 v107, v118, v119
    v_exp_f32 v124, v92
    v_exp_f32 v125, v93
    v_cvt_pk_bf16_f32 v108, v120, v121
    v_mfma_f32_32x32x16_bf16 v[32:47], v[140:143], v[100:103], v[32:47]
    v_exp_f32 v126, v94
    v_exp_f32 v127, v95
    v_cvt_pk_bf16_f32 v109, v122, v123
    v_mfma_f32_32x32x16_bf16 v[80:95], v[132:135], v[12:15], 0
    v_exp_f32 v112, v64
    v_exp_f32 v113, v65
    v_cvt_pk_bf16_f32 v110, v124, v125
    v_exp_f32 v114, v66
    v_exp_f32 v115, v67
    v_cvt_pk_bf16_f32 v111, v126, v127
    v_exp_f32 v116, v68
    v_exp_f32 v117, v69
    v_cvt_pk_bf16_f32 v96, v112, v113
    v_exp_f32 v118, v70
    v_exp_f32 v119, v71
    v_cvt_pk_bf16_f32 v97, v114, v115
    v_mfma_f32_32x32x16_bf16 v[48:63], v[136:139], v[104:107], v[48:63]
    v_exp_f32 v120, v72
    v_exp_f32 v121, v73
    v_cvt_pk_bf16_f32 v98, v116, v117
    v_exp_f32 v122, v74
    v_exp_f32 v123, v75
    v_cvt_pk_bf16_f32 v99, v118, v119
    v_exp_f32 v124, v76
    v_exp_f32 v125, v77
    v_cvt_pk_bf16_f32 v100, v120, v121
    v_mfma_f32_32x32x16_bf16 v[48:63], v[140:143], v[108:111], v[48:63]
    v_exp_f32 v126, v78
    v_exp_f32 v127, v79
    v_cvt_pk_bf16_f32 v101, v122, v123
    s_waitcnt lgkmcnt(0)
    v_mfma_f32_32x32x16_bf16 v[64:79], v[128:131], v[8:11], 0
    ds_read_b128 v[132:135], v156 offset:10880
    ds_read_b128 v[136:139], v157 offset:8704
    ds_read_b128 v[140:143], v157 offset:9280
    v_exp_f32 v112, v80
    v_exp_f32 v113, v81
    v_cvt_pk_bf16_f32 v102, v124, v125
    v_exp_f32 v114, v82
    v_exp_f32 v115, v83
    v_cvt_pk_bf16_f32 v103, v126, v127
    v_exp_f32 v116, v84
    v_exp_f32 v117, v85
    v_cvt_pk_bf16_f32 v104, v112, v113
    v_exp_f32 v118, v86
    v_exp_f32 v119, v87
    v_cvt_pk_bf16_f32 v105, v114, v115
    v_mfma_f32_32x32x16_bf16 v[32:47], v[144:147], v[96:99], v[32:47]
    v_exp_f32 v120, v88
    v_exp_f32 v121, v89
    v_cvt_pk_bf16_f32 v106, v116, v117
    v_exp_f32 v122, v90
    v_exp_f32 v123, v91
    v_cvt_pk_bf16_f32 v107, v118, v119
    v_exp_f32 v124, v92
    v_exp_f32 v125, v93
    v_cvt_pk_bf16_f32 v108, v120, v121
    v_mfma_f32_32x32x16_bf16 v[32:47], v[148:151], v[100:103], v[32:47]
    v_exp_f32 v126, v94
    v_exp_f32 v127, v95
    v_cvt_pk_bf16_f32 v109, v122, v123
    v_add_u32 v156, 8704, v156
    v_add_u32 v157, 8704, v157
    s_add_u32 s29, s29, 1
    s_cmp_lg_u32 s29, 8
    v_mfma_f32_32x32x16_bf16 v[80:95], v[128:131], v[12:15], 0
    v_exp_f32 v112, v64
    v_exp_f32 v113, v65
    v_cvt_pk_bf16_f32 v110, v124, v125
    v_exp_f32 v114, v66
    v_exp_f32 v115, v67
    v_cvt_pk_bf16_f32 v111, v126, v127
    v_exp_f32 v116, v68
    v_exp_f32 v117, v69
    v_cvt_pk_bf16_f32 v96, v112, v113
    buffer_load_dwordx4 a[40:43], v2, s[8:11], s50 offen offset:1024
    v_exp_f32 v118, v70
    v_exp_f32 v119, v71
    v_cvt_pk_bf16_f32 v97, v114, v115
    v_mfma_f32_32x32x16_bf16 v[48:63], v[144:147], v[104:107], v[48:63]
    v_exp_f32 v120, v72
    v_exp_f32 v121, v73
    v_cvt_pk_bf16_f32 v98, v116, v117
    v_exp_f32 v122, v74
    v_exp_f32 v123, v75
    v_cvt_pk_bf16_f32 v99, v118, v119
    v_exp_f32 v124, v76
    v_exp_f32 v125, v77
    v_cvt_pk_bf16_f32 v100, v120, v121
    v_mfma_f32_32x32x16_bf16 v[48:63], v[148:151], v[108:111], v[48:63]
    buffer_load_dwordx4 a[44:47], v2, s[8:11], s50 offen offset:2048
    v_exp_f32 v126, v78
    v_exp_f32 v127, v79
    v_cvt_pk_bf16_f32 v101, v122, v123
    s_waitcnt lgkmcnt(0)
    v_mfma_f32_32x32x16_bf16 v[64:79], v[132:135], v[8:11], 0
    ds_read_b128 v[128:131], v156 offset:4352
    ds_read_b128 v[144:147], v157 offset:2176
    ds_read_b128 v[148:151], v157 offset:2752
    v_exp_f32 v112, v80
    v_exp_f32 v113, v81
    v_cvt_pk_bf16_f32 v102, v124, v125
    v_exp_f32 v114, v82
    v_exp_f32 v115, v83
    v_cvt_pk_bf16_f32 v103, v126, v127
    v_exp_f32 v116, v84
    v_exp_f32 v117, v85
    v_cvt_pk_bf16_f32 v104, v112, v113
    buffer_load_dwordx4 a[48:51], v2, s[8:11], s50 offen offset:3072
    v_exp_f32 v118, v86
    v_exp_f32 v119, v87
    v_cvt_pk_bf16_f32 v105, v114, v115
    v_mfma_f32_32x32x16_bf16 v[32:47], v[136:139], v[96:99], v[32:47]
    v_exp_f32 v120, v88
    v_exp_f32 v121, v89
    v_cvt_pk_bf16_f32 v106, v116, v117
    v_exp_f32 v122, v90
    v_exp_f32 v123, v91
    v_cvt_pk_bf16_f32 v107, v118, v119
    v_exp_f32 v124, v92
    v_exp_f32 v125, v93
    v_cvt_pk_bf16_f32 v108, v120, v121
    v_mfma_f32_32x32x16_bf16 v[32:47], v[140:143], v[100:103], v[32:47]
    s_add_u32 s33, s50, 4096
    buffer_load_dwordx4 a[52:55], v2, s[8:11], s33 offen offset:0
    v_exp_f32 v126, v94
    v_exp_f32 v127, v95
    v_cvt_pk_bf16_f32 v109, v122, v123
    v_mfma_f32_32x32x16_bf16 v[80:95], v[132:135], v[12:15], 0
    v_exp_f32 v112, v64
    v_exp_f32 v113, v65
    v_cvt_pk_bf16_f32 v110, v124, v125
    v_exp_f32 v114, v66
    v_exp_f32 v115, v67
    v_cvt_pk_bf16_f32 v111, v126, v127
    v_exp_f32 v116, v68
    v_exp_f32 v117, v69
    v_cvt_pk_bf16_f32 v96, v112, v113
    s_add_u32 s33, s50, 4096
    buffer_load_dwordx4 a[56:59], v2, s[8:11], s33 offen offset:1024
    v_exp_f32 v118, v70
    v_exp_f32 v119, v71
    v_cvt_pk_bf16_f32 v97, v114, v115
    v_mfma_f32_32x32x16_bf16 v[48:63], v[136:139], v[104:107], v[48:63]
    v_exp_f32 v120, v72
    v_exp_f32 v121, v73
    v_cvt_pk_bf16_f32 v98, v116, v117
    v_exp_f32 v122, v74
    v_exp_f32 v123, v75
    v_cvt_pk_bf16_f32 v99, v118, v119
    v_exp_f32 v124, v76
    v_exp_f32 v125, v77
    v_cvt_pk_bf16_f32 v100, v120, v121
    v_mfma_f32_32x32x16_bf16 v[48:63], v[140:143], v[108:111], v[48:63]
    s_add_u32 s33, s50, 4096
    buffer_load_dwordx4 a[60:63], v2, s[8:11], s33 offen offset:2048
    v_exp_f32 v126, v78
    v_exp_f32 v127, v79
    v_cvt_pk_bf16_f32 v101, v122, v123
    s_waitcnt lgkmcnt(0)
    v_mfma_f32_32x32x16_bf16 v[64:79], v[128:131], v[8:11], 0
    ds_read_b128 v[132:135], v156 offset:6528
    ds_read_b128 v[136:139], v157 offset:4352
    ds_read_b128 v[140:143], v157 offset:4928
    v_exp_f32 v112, v80
    v_exp_f32 v113, v81
    v_cvt_pk_bf16_f32 v102, v124, v125
    v_exp_f32 v114, v82
    v_exp_f32 v115, v83
    v_cvt_pk_bf16_f32 v103, v126, v127
    v_exp_f32 v116, v84
    v_exp_f32 v117, v85
    v_cvt_pk_bf16_f32 v104, v112, v113
    s_add_u32 s33, s50, 4096
    buffer_load_dwordx4 a[64:67], v2, s[8:11], s33 offen offset:3072
    v_exp_f32 v118, v86
    v_exp_f32 v119, v87
    v_cvt_pk_bf16_f32 v105, v114, v115
    v_mfma_f32_32x32x16_bf16 v[32:47], v[144:147], v[96:99], v[32:47]
    v_exp_f32 v120, v88
    v_exp_f32 v121, v89
    v_cvt_pk_bf16_f32 v106, v116, v117
    v_exp_f32 v122, v90
    v_exp_f32 v123, v91
    v_cvt_pk_bf16_f32 v107, v118, v119
    v_exp_f32 v124, v92
    v_exp_f32 v125, v93
    v_cvt_pk_bf16_f32 v108, v120, v121
    v_mfma_f32_32x32x16_bf16 v[32:47], v[148:151], v[100:103], v[32:47]
    s_add_u32 s33, s50, 8192
    buffer_load_dwordx4 a[68:71], v2, s[8:11], s33 offen offset:0
    v_exp_f32 v126, v94
    v_exp_f32 v127, v95
    v_cvt_pk_bf16_f32 v109, v122, v123
    v_mfma_f32_32x32x16_bf16 v[80:95], v[128:131], v[12:15], 0
    v_exp_f32 v112, v64
    v_exp_f32 v113, v65
    v_cvt_pk_bf16_f32 v110, v124, v125
    v_exp_f32 v114, v66
    v_exp_f32 v115, v67
    v_cvt_pk_bf16_f32 v111, v126, v127
    v_exp_f32 v116, v68
    v_exp_f32 v117, v69
    v_cvt_pk_bf16_f32 v96, v112, v113
    s_add_u32 s33, s50, 8192
    buffer_load_dwordx4 a[72:75], v2, s[8:11], s33 offen offset:1024
    v_exp_f32 v118, v70
    v_exp_f32 v119, v71
    v_cvt_pk_bf16_f32 v97, v114, v115
    v_mfma_f32_32x32x16_bf16 v[48:63], v[144:147], v[104:107], v[48:63]
    v_exp_f32 v120, v72
    v_exp_f32 v121, v73
    v_cvt_pk_bf16_f32 v98, v116, v117
    v_exp_f32 v122, v74
    v_exp_f32 v123, v75
    v_cvt_pk_bf16_f32 v99, v118, v119
    v_exp_f32 v124, v76
    v_exp_f32 v125, v77
    v_cvt_pk_bf16_f32 v100, v120, v121
    v_mfma_f32_32x32x16_bf16 v[48:63], v[148:151], v[108:111], v[48:63]
    s_add_u32 s33, s50, 8192
    buffer_load_dwordx4 a[76:79], v2, s[8:11], s33 offen offset:2048
    v_exp_f32 v126, v78
    v_exp_f32 v127, v79
    v_cvt_pk_bf16_f32 v101, v122, v123
    s_waitcnt lgkmcnt(0)
    v_mfma_f32_32x32x16_bf16 v[64:79], v[132:135], v[8:11], 0
    ds_read_b128 v[128:131], v156 offset:8704
    ds_read_b128 v[144:147], v157 offset:6528
    ds_read_b128 v[148:151], v157 offset:7104
    v_exp_f32 v112, v80
    v_exp_f32 v113, v81
    v_cvt_pk_bf16_f32 v102, v124, v125
    v_exp_f32 v114, v82
    v_exp_f32 v115, v83
    v_cvt_pk_bf16_f32 v103, v126, v127
    v_exp_f32 v116, v84
    v_exp_f32 v117, v85
    v_cvt_pk_bf16_f32 v104, v112, v113
    v_exp_f32 v118, v86
    v_exp_f32 v119, v87
    v_cvt_pk_bf16_f32 v105, v114, v115
    v_mfma_f32_32x32x16_bf16 v[32:47], v[136:139], v[96:99], v[32:47]
    v_exp_f32 v120, v88
    v_exp_f32 v121, v89
    v_cvt_pk_bf16_f32 v106, v116, v117
    v_exp_f32 v122, v90
    v_exp_f32 v123, v91
    v_cvt_pk_bf16_f32 v107, v118, v119
    v_exp_f32 v124, v92
    v_exp_f32 v125, v93
    v_cvt_pk_bf16_f32 v108, v120, v121
    v_mfma_f32_32x32x16_bf16 v[32:47], v[140:143], v[100:103], v[32:47]
    v_exp_f32 v126, v94
    v_exp_f32 v127, v95
    v_cvt_pk_bf16_f32 v109, v122, v123
    v_mfma_f32_32x32x16_bf16 v[80:95], v[132:135], v[12:15], 0
    v_exp_f32 v112, v64
    v_exp_f32 v113, v65
    v_cvt_pk_bf16_f32 v110, v124, v125
    v_exp_f32 v114, v66
    v_exp_f32 v115, v67
    v_cvt_pk_bf16_f32 v111, v126, v127
    v_exp_f32 v116, v68
    v_exp_f32 v117, v69
    v_cvt_pk_bf16_f32 v96, v112, v113
    v_exp_f32 v118, v70
    v_exp_f32 v119, v71
    v_cvt_pk_bf16_f32 v97, v114, v115
    v_mfma_f32_32x32x16_bf16 v[48:63], v[136:139], v[104:107], v[48:63]
    v_exp_f32 v120, v72
    v_exp_f32 v121, v73
    v_cvt_pk_bf16_f32 v98, v116, v117
    v_exp_f32 v122, v74
    v_exp_f32 v123, v75
    v_cvt_pk_bf16_f32 v99, v118, v119
    v_exp_f32 v124, v76
    v_exp_f32 v125, v77
    v_cvt_pk_bf16_f32 v100, v120, v121
    v_mfma_f32_32x32x16_bf16 v[48:63], v[140:143], v[108:111], v[48:63]
    v_exp_f32 v126, v78
    v_exp_f32 v127, v79
    v_cvt_pk_bf16_f32 v101, v122, v123
    s_waitcnt lgkmcnt(0)
    v_mfma_f32_32x32x16_bf16 v[64:79], v[128:131], v[8:11], 0
    ds_read_b128 v[132:135], v156 offset:10880
    ds_read_b128 v[136:139], v157 offset:8704
    ds_read_b128 v[140:143], v157 offset:9280
    v_exp_f32 v112, v80
    v_exp_f32 v113, v81
    v_cvt_pk_bf16_f32 v102, v124, v125
    v_exp_f32 v114, v82
    v_exp_f32 v115, v83
    v_cvt_pk_bf16_f32 v103, v126, v127
    v_exp_f32 v116, v84
    v_exp_f32 v117, v85
    v_cvt_pk_bf16_f32 v104, v112, v113
    v_exp_f32 v118, v86
    v_exp_f32 v119, v87
    v_cvt_pk_bf16_f32 v105, v114, v115
    v_mfma_f32_32x32x16_bf16 v[32:47], v[144:147], v[96:99], v[32:47]
    v_exp_f32 v120, v88
    v_exp_f32 v121, v89
    v_cvt_pk_bf16_f32 v106, v116, v117
    v_exp_f32 v122, v90
    v_exp_f32 v123, v91
    v_cvt_pk_bf16_f32 v107, v118, v119
    v_exp_f32 v124, v92
    v_exp_f32 v125, v93
    v_cvt_pk_bf16_f32 v108, v120, v121
    v_mfma_f32_32x32x16_bf16 v[32:47], v[148:151], v[100:103], v[32:47]
    v_exp_f32 v126, v94
    v_exp_f32 v127, v95
    v_cvt_pk_bf16_f32 v109, v122, v123
    v_add_u32 v156, 8704, v156
    v_add_u32 v157, 8704, v157
    s_add_u32 s29, s29, 1
    s_cmp_lg_u32 s29, 8
    s_lshr_b32 s56, s4, 3
    s_and_b32 s56, s56, 3
    s_and_b32 s57, s56, 1
    s_lshl_b32 s58, s5, 1
    s_add_u32 s57, s57, s58
    s_mul_i32 s57, s57, 112
    s_mul_i32 s58, s3, 14
    s_add_u32 s57, s57, s58
    s_lshr_b32 s58, s56, 1
    s_mul_i32 s58, s58, 7
    s_add_u32 s57, s57, s58
    s_lshl_b32 s57, s57, 10
    s_add_u32 s57, s57, 0x2c0000
    s_lshl_b32 s58, s56, 12
    s_add_u32 s58, s58, s50
    s_add_u32 s58, s58, 15360
    s_and_b32 s59, s56, 1
    s_lshl_b32 s59, s59, 15
    s_lshr_b32 s60, s56, 1
    s_lshl_b32 s60, s60, 11
    s_add_u32 s59, s59, s60
    s_add_u32 s59, s59, s48
    s_add_u32 s59, s59, 0xfff80000
    v_min_u32 v152, 55, v1
    v_lshlrev_b32 v152, 7, v152
    v_min_u32 v153, 39, v1
    v_lshlrev_b32 v153, 7, v153
    v_min_u32 v154, 15, v1
    v_lshlrev_b32 v154, 7, v154
    v_and_b32 v5, 7, v1
    v_lshlrev_b32 v5, 2, v5
    s_lshl_b32 s62, s4, 8
    s_add_u32 s62, s62, 0x490000
    s_add_u32 s20, s22, 0x900000
    s_add_u32 s21, s42, 0xb00000
    s_lshl_b32 s23, s4, 1
    s_mul_i32 s23, s23, 112
    s_lshl_b32 s24, s51, 1
    s_add_u32 s23, s23, s24
    s_lshl_b32 s23, s23, 10
    s_add_u32 s23, s23, 0x1000000
    s_add_u32 s24, s23, 1024
    s_add_u32 s25, s23, 114688
    s_add_u32 s26, s25, 1024
    s_add_u32 s27, s42, 0x2500000
    s_add_u32 s28, s42, 0x2700000
    v_mov_b32 v6, s20
    v_mov_b32 v7, s21
    v_cmp_le_u32 vcc, 8, v1
    s_nop 1
    v_cndmask_b32 v6, v6, v7, vcc
    v_mov_b32 v7, s23
    v_cmp_le_u32 vcc, 16, v1
    s_nop 1
    v_cndmask_b32 v6, v6, v7, vcc
    v_mov_b32 v7, s24
    v_cmp_le_u32 vcc, 24, v1
    s_nop 1
    v_cndmask_b32 v6, v6, v7, vcc
    v_mov_b32 v7, s25
    v_cmp_le_u32 vcc, 32, v1
    s_nop 1
    v_cndmask_b32 v6, v6, v7, vcc
    v_mov_b32 v7, s26
    v_cmp_le_u32 vcc, 40, v1
    s_nop 1
    v_cndmask_b32 v6, v6, v7, vcc
    v_mov_b32 v7, s27
    v_cmp_le_u32 vcc, 48, v1
    s_nop 1
    v_cndmask_b32 v6, v6, v7, vcc
    v_mov_b32 v7, s28
    v_cmp_le_u32 vcc, 56, v1
    s_nop 1
    v_cndmask_b32 v6, v6, v7, vcc
    v_and_b32 v7, 7, v1
    v_lshl_add_u32 v6, v7, 7, v6
    s_mul_i32 s31, s45, 2176
    s_add_u32 s31, s31, 0x3800000
    v_mfma_f32_32x32x16_bf16 v[80:95], v[128:131], v[12:15], 0
    v_exp_f32 v112, v64
    v_exp_f32 v113, v65
    v_cvt_pk_bf16_f32 v110, v124, v125
    v_exp_f32 v114, v66
    v_exp_f32 v115, v67
    v_cvt_pk_bf16_f32 v111, v126, v127
    s_add_u32 s33, s50, 8192
    buffer_load_dwordx4 a[80:83], v2, s[8:11], s33 offen offset:3072
    v_exp_f32 v116, v68
    v_exp_f32 v117, v69
    v_cvt_pk_bf16_f32 v96, v112, v113
    v_exp_f32 v118, v70
    v_exp_f32 v119, v71
    v_cvt_pk_bf16_f32 v97, v114, v115
    v_mfma_f32_32x32x16_bf16 v[48:63], v[144:147], v[104:107], v[48:63]
    v_exp_f32 v120, v72
    v_exp_f32 v121, v73
    v_cvt_pk_bf16_f32 v98, v116, v117
    v_exp_f32 v122, v74
    v_exp_f32 v123, v75
    v_cvt_pk_bf16_f32 v99, v118, v119
    s_add_u32 s33, s50, 12288
    buffer_load_dwordx4 a[84:87], v2, s[8:11], s33 offen offset:0
    v_exp_f32 v124, v76
    v_exp_f32 v125, v77
    v_cvt_pk_bf16_f32 v100, v120, v121
    v_mfma_f32_32x32x16_bf16 v[48:63], v[148:151], v[108:111], v[48:63]
    v_exp_f32 v126, v78
    v_exp_f32 v127, v79
    v_cvt_pk_bf16_f32 v101, v122, v123
    s_waitcnt lgkmcnt(0)
    v_mfma_f32_32x32x16_bf16 v[64:79], v[132:135], v[8:11], 0
    ds_read_b128 v[128:131], v156 offset:4352
    ds_read_b128 v[144:147], v157 offset:2176
    ds_read_b128 v[148:151], v157 offset:2752
    v_exp_f32 v112, v80
    v_exp_f32 v113, v81
    v_cvt_pk_bf16_f32 v102, v124, v125
    v_exp_f32 v114, v82
    v_exp_f32 v115, v83
    v_cvt_pk_bf16_f32 v103, v126, v127
    s_add_u32 s33, s50, 12288
    buffer_load_dwordx4 a[88:91], v2, s[8:11], s33 offen offset:1024
    v_exp_f32 v116, v84
    v_exp_f32 v117, v85
    v_cvt_pk_bf16_f32 v104, v112, v113
    v_exp_f32 v118, v86
    v_exp_f32 v119, v87
    v_cvt_pk_bf16_f32 v105, v114, v115
    v_mfma_f32_32x32x16_bf16 v[32:47], v[136:139], v[96:99], v[32:47]
    v_exp_f32 v120, v88
    v_exp_f32 v121, v89
    v_cvt_pk_bf16_f32 v106, v116, v117
    v_exp_f32 v122, v90
    v_exp_f32 v123, v91
    v_cvt_pk_bf16_f32 v107, v118, v119
    s_add_u32 s33, s50, 12288
    buffer_load_dwordx4 a[92:95], v2, s[8:11], s33 offen offset:2048
    v_exp_f32 v124, v92
    v_exp_f32 v125, v93
    v_cvt_pk_bf16_f32 v108, v120, v121
    v_mfma_f32_32x32x16_bf16 v[32:47], v[140:143], v[100:103], v[32:47]
    v_exp_f32 v126, v94
    v_exp_f32 v127, v95
    v_cvt_pk_bf16_f32 v109, v122, v123
    v_mfma_f32_32x32x16_bf16 v[80:95], v[132:135], v[12:15], 0
    v_exp_f32 v112, v64
    v_exp_f32 v113, v65
    v_cvt_pk_bf16_f32 v110, v124, v125
    v_exp_f32 v114, v66
    v_exp_f32 v115, v67
    v_cvt_pk_bf16_f32 v111, v126, v127
    s_add_u32 s33, s50, 20480
    buffer_load_dwordx4 v[16:19], v2, s[8:11], s33 offen offset:3072
    v_exp_f32 v116, v68
    v_exp_f32 v117, v69
    v_cvt_pk_bf16_f32 v96, v112, v113
    v_exp_f32 v118, v70
    v_exp_f32 v119, v71
    v_cvt_pk_bf16_f32 v97, v114, v115
    v_mfma_f32_32x32x16_bf16 v[48:63], v[136:139], v[104:107], v[48:63]
    v_exp_f32 v120, v72
    v_exp_f32 v121, v73
    v_cvt_pk_bf16_f32 v98, v116, v117
    v_exp_f32 v122, v74
    v_exp_f32 v123, v75
    v_cvt_pk_bf16_f32 v99, v118, v119
    s_add_u32 s33, s50, 24576
    buffer_load_dwordx4 v[20:23], v2, s[8:11], s33 offen offset:0
    v_exp_f32 v124, v76
    v_exp_f32 v125, v77
    v_cvt_pk_bf16_f32 v100, v120, v121
    v_mfma_f32_32x32x16_bf16 v[48:63], v[140:143], v[108:111], v[48:63]
    v_exp_f32 v126, v78
    v_exp_f32 v127, v79
    v_cvt_pk_bf16_f32 v101, v122, v123
    s_waitcnt lgkmcnt(0)
    v_mfma_f32_32x32x16_bf16 v[64:79], v[128:131], v[8:11], 0
    ds_read_b128 v[132:135], v156 offset:6528
    ds_read_b128 v[136:139], v157 offset:4352
    ds_read_b128 v[140:143], v157 offset:4928
    v_exp_f32 v112, v80
    v_exp_f32 v113, v81
    v_cvt_pk_bf16_f32 v102, v124, v125
    v_exp_f32 v114, v82
    v_exp_f32 v115, v83
    v_cvt_pk_bf16_f32 v103, v126, v127
    s_add_u32 s33, s50, 24576
    buffer_load_dwordx4 v[24:27], v2, s[8:11], s33 offen offset:1024
    v_exp_f32 v116, v84
    v_exp_f32 v117, v85
    v_cvt_pk_bf16_f32 v104, v112, v113
    v_exp_f32 v118, v86
    v_exp_f32 v119, v87
    v_cvt_pk_bf16_f32 v105, v114, v115
    v_mfma_f32_32x32x16_bf16 v[32:47], v[144:147], v[96:99], v[32:47]
    v_exp_f32 v120, v88
    v_exp_f32 v121, v89
    v_cvt_pk_bf16_f32 v106, v116, v117
    v_exp_f32 v122, v90
    v_exp_f32 v123, v91
    v_cvt_pk_bf16_f32 v107, v118, v119
    s_add_u32 s33, s50, 24576
    buffer_load_dwordx4 v[28:31], v2, s[8:11], s33 offen offset:2048
    v_exp_f32 v124, v92
    v_exp_f32 v125, v93
    v_cvt_pk_bf16_f32 v108, v120, v121
    v_mfma_f32_32x32x16_bf16 v[32:47], v[148:151], v[100:103], v[32:47]
    v_exp_f32 v126, v94
    v_exp_f32 v127, v95
    v_cvt_pk_bf16_f32 v109, v122, v123
    v_mfma_f32_32x32x16_bf16 v[80:95], v[128:131], v[12:15], 0
    v_exp_f32 v112, v64
    v_exp_f32 v113, v65
    v_cvt_pk_bf16_f32 v110, v124, v125
    v_exp_f32 v114, v66
    v_exp_f32 v115, v67
    v_cvt_pk_bf16_f32 v111, v126, v127
    buffer_load_dword v155, v152, s[8:11], s57 offen
    v_exp_f32 v116, v68
    v_exp_f32 v117, v69
    v_cvt_pk_bf16_f32 v96, v112, v113
    v_exp_f32 v118, v70
    v_exp_f32 v119, v71
    v_cvt_pk_bf16_f32 v97, v114, v115
    v_mfma_f32_32x32x16_bf16 v[48:63], v[144:147], v[104:107], v[48:63]
    v_exp_f32 v120, v72
    v_exp_f32 v121, v73
    v_cvt_pk_bf16_f32 v98, v116, v117
    v_exp_f32 v122, v74
    v_exp_f32 v123, v75
    v_cvt_pk_bf16_f32 v99, v118, v119
    buffer_load_dword v155, v153, s[8:11], s58 offen
    v_exp_f32 v124, v76
    v_exp_f32 v125, v77
    v_cvt_pk_bf16_f32 v100, v120, v121
    v_mfma_f32_32x32x16_bf16 v[48:63], v[148:151], v[108:111], v[48:63]
    v_exp_f32 v126, v78
    v_exp_f32 v127, v79
    v_cvt_pk_bf16_f32 v101, v122, v123
    s_waitcnt lgkmcnt(0)
    v_mfma_f32_32x32x16_bf16 v[64:79], v[132:135], v[8:11], 0
    ds_read_b128 v[128:131], v156 offset:8704
    ds_read_b128 v[144:147], v157 offset:6528
    ds_read_b128 v[148:151], v157 offset:7104
    v_exp_f32 v112, v80
    v_exp_f32 v113, v81
    v_cvt_pk_bf16_f32 v102, v124, v125
    v_exp_f32 v114, v82
    v_exp_f32 v115, v83
    v_cvt_pk_bf16_f32 v103, v126, v127
    buffer_load_dword v155, v154, s[8:11], s59 offen
    v_exp_f32 v116, v84
    v_exp_f32 v117, v85
    v_cvt_pk_bf16_f32 v104, v112, v113
    v_exp_f32 v118, v86
    v_exp_f32 v119, v87
    v_cvt_pk_bf16_f32 v105, v114, v115
    v_mfma_f32_32x32x16_bf16 v[32:47], v[136:139], v[96:99], v[32:47]
    v_exp_f32 v120, v88
    v_exp_f32 v121, v89
    v_cvt_pk_bf16_f32 v106, v116, v117
    v_exp_f32 v122, v90
    v_exp_f32 v123, v91
    v_cvt_pk_bf16_f32 v107, v118, v119
    buffer_load_dword v159, v5, s[8:11], s62 offen offset:64 sc0 sc1
    v_exp_f32 v124, v92
    v_exp_f32 v125, v93
    v_cvt_pk_bf16_f32 v108, v120, v121
    v_mfma_f32_32x32x16_bf16 v[32:47], v[140:143], v[100:103], v[32:47]
    v_exp_f32 v126, v94
    v_exp_f32 v127, v95
    v_cvt_pk_bf16_f32 v109, v122, v123
    v_mfma_f32_32x32x16_bf16 v[80:95], v[132:135], v[12:15], 0
    v_exp_f32 v112, v64
    v_exp_f32 v113, v65
    v_cvt_pk_bf16_f32 v110, v124, v125
    v_exp_f32 v114, v66
    v_exp_f32 v115, v67
    v_cvt_pk_bf16_f32 v111, v126, v127
    buffer_load_dword v7, v6, s[8:11], 0 offen
    v_exp_f32 v116, v68
    v_exp_f32 v117, v69
    v_cvt_pk_bf16_f32 v96, v112, v113
    v_exp_f32 v118, v70
    v_exp_f32 v119, v71
    v_cvt_pk_bf16_f32 v97, v114, v115
    v_mfma_f32_32x32x16_bf16 v[48:63], v[136:139], v[104:107], v[48:63]
    v_exp_f32 v120, v72
    v_exp_f32 v121, v73
    v_cvt_pk_bf16_f32 v98, v116, v117
    v_exp_f32 v122, v74
    v_exp_f32 v123, v75
    v_cvt_pk_bf16_f32 v99, v118, v119
    buffer_load_dword v155, v154, s[8:11], s31 offen
    v_exp_f32 v124, v76
    v_exp_f32 v125, v77
    v_cvt_pk_bf16_f32 v100, v120, v121
    v_mfma_f32_32x32x16_bf16 v[48:63], v[140:143], v[108:111], v[48:63]
    v_exp_f32 v126, v78
    v_exp_f32 v127, v79
    v_cvt_pk_bf16_f32 v101, v122, v123
    s_waitcnt lgkmcnt(0)
    v_mfma_f32_32x32x16_bf16 v[64:79], v[128:131], v[8:11], 0
    ds_read_b128 v[132:135], v156 offset:10880
    ds_read_b128 v[136:139], v157 offset:8704
    ds_read_b128 v[140:143], v157 offset:9280
    v_exp_f32 v112, v80
    v_exp_f32 v113, v81
    v_cvt_pk_bf16_f32 v102, v124, v125
    v_exp_f32 v114, v82
    v_exp_f32 v115, v83
    v_cvt_pk_bf16_f32 v103, v126, v127
    v_exp_f32 v116, v84
    v_exp_f32 v117, v85
    v_cvt_pk_bf16_f32 v104, v112, v113
    v_exp_f32 v118, v86
    v_exp_f32 v119, v87
    v_cvt_pk_bf16_f32 v105, v114, v115
    v_mfma_f32_32x32x16_bf16 v[32:47], v[144:147], v[96:99], v[32:47]
    v_exp_f32 v120, v88
    v_exp_f32 v121, v89
    v_cvt_pk_bf16_f32 v106, v116, v117
    v_exp_f32 v122, v90
    v_exp_f32 v123, v91
    v_cvt_pk_bf16_f32 v107, v118, v119
    v_exp_f32 v124, v92
    v_exp_f32 v125, v93
    v_cvt_pk_bf16_f32 v108, v120, v121
    v_mfma_f32_32x32x16_bf16 v[32:47], v[148:151], v[100:103], v[32:47]
    v_exp_f32 v126, v94
    v_exp_f32 v127, v95
    v_cvt_pk_bf16_f32 v109, v122, v123
    v_add_u32 v156, 8704, v156
    v_add_u32 v157, 8704, v157
    s_add_u32 s29, s29, 1
    s_cmp_lg_u32 s29, 8
F0_loop:
    s_cmp_lg_u32 s29, 7
    s_cbranch_scc1 F0_prio2
    s_setprio 0
F0_prio2:
    v_mfma_f32_32x32x16_bf16 v[80:95], v[128:131], v[12:15], 0
    v_exp_f32 v112, v64
    v_exp_f32 v113, v65
    v_cvt_pk_bf16_f32 v110, v124, v125
    v_exp_f32 v114, v66
    v_exp_f32 v115, v67
    v_cvt_pk_bf16_f32 v111, v126, v127
    v_exp_f32 v116, v68
    v_exp_f32 v117, v69
    v_cvt_pk_bf16_f32 v96, v112, v113
    v_exp_f32 v118, v70
    v_exp_f32 v119, v71
    v_cvt_pk_bf16_f32 v97, v114, v115
    v_mfma_f32_32x32x16_bf16 v[48:63], v[144:147], v[104:107], v[48:63]
    v_exp_f32 v120, v72
    v_exp_f32 v121, v73
    v_cvt_pk_bf16_f32 v98, v116, v117
    v_exp_f32 v122, v74
    v_exp_f32 v123, v75
    v_cvt_pk_bf16_f32 v99, v118, v119
    v_exp_f32 v124, v76
    v_exp_f32 v125, v77
    v_cvt_pk_bf16_f32 v100, v120, v121
    v_mfma_f32_32x32x16_bf16 v[48:63], v[148:151], v[108:111], v[48:63]
    v_exp_f32 v126, v78
    v_exp_f32 v127, v79
    v_cvt_pk_bf16_f32 v101, v122, v123
    s_waitcnt lgkmcnt(0)
    v_mfma_f32_32x32x16_bf16 v[64:79], v[132:135], v[8:11], 0
    ds_read_b128 v[128:131], v156 offset:4352
    ds_read_b128 v[144:147], v157 offset:2176
    ds_read_b128 v[148:151], v157 offset:2752
    v_exp_f32 v112, v80
    v_exp_f32 v113, v81
    v_cvt_pk_bf16_f32 v102, v124, v125
    v_exp_f32 v114, v82
    v_exp_f32 v115, v83
    v_cvt_pk_bf16_f32 v103, v126, v127
    v_exp_f32 v116, v84
    v_exp_f32 v117, v85
    v_cvt_pk_bf16_f32 v104, v112, v113
    v_exp_f32 v118, v86
    v_exp_f32 v119, v87
    v_cvt_pk_bf16_f32 v105, v114, v115
    v_mfma_f32_32x32x16_bf16 v[32:47], v[136:139], v[96:99], v[32:47]
    v_exp_f32 v120, v88
    v_exp_f32 v121, v89
    v_cvt_pk_bf16_f32 v106, v116, v117
    v_exp_f32 v122, v90
    v_exp_f32 v123, v91
    v_cvt_pk_bf16_f32 v107, v118, v119
    v_exp_f32 v124, v92
    v_exp_f32 v125, v93
    v_cvt_pk_bf16_f32 v108, v120, v121
    v_mfma_f32_32x32x16_bf16 v[32:47], v[140:143], v[100:103], v[32:47]
    v_exp_f32 v126, v94
    v_exp_f32 v127, v95
    v_cvt_pk_bf16_f32 v109, v122, v123
    v_mfma_f32_32x32x16_bf16 v[80:95], v[132:135], v[12:15], 0
    v_exp_f32 v112, v64
    v_exp_f32 v113, v65
    v_cvt_pk_bf16_f32 v110, v124, v125
    v_exp_f32 v114, v66
    v_exp_f32 v115, v67
    v_cvt_pk_bf16_f32 v111, v126, v127
    v_exp_f32 v116, v68
    v_exp_f32 v117, v69
    v_cvt_pk_bf16_f32 v96, v112, v113
    v_exp_f32 v118, v70
    v_exp_f32 v119, v71
    v_cvt_pk_bf16_f32 v97, v114, v115
    v_mfma_f32_32x32x16_bf16 v[48:63], v[136:139], v[104:107], v[48:63]
    v_exp_f32 v120, v72
    v_exp_f32 v121, v73
    v_cvt_pk_bf16_f32 v98, v116, v117
    v_exp_f32 v122, v74
    v_exp_f32 v123, v75
    v_cvt_pk_bf16_f32 v99, v118, v119
    v_exp_f32 v124, v76
    v_exp_f32 v125, v77
    v_cvt_pk_bf16_f32 v100, v120, v121
    v_mfma_f32_32x32x16_bf16 v[48:63], v[140:143], v[108:111], v[48:63]
    v_exp_f32 v126, v78
    v_exp_f32 v127, v79
    v_cvt_pk_bf16_f32 v101, v122, v123
    s_waitcnt lgkmcnt(0)
    v_mfma_f32_32x32x16_bf16 v[64:79], v[128:131], v[8:11], 0
    ds_read_b128 v[132:135], v156 offset:6528
    ds_read_b128 v[136:139], v157 offset:4352
    ds_read_b128 v[140:143], v157 offset:4928
    v_exp_f32 v112, v80
    v_exp_f32 v113, v81
    v_cvt_pk_bf16_f32 v102, v124, v125
    v_exp_f32 v114, v82
    v_exp_f32 v115, v83
    v_cvt_pk_bf16_f32 v103, v126, v127
    v_exp_f32 v116, v84
    v_exp_f32 v117, v85
    v_cvt_pk_bf16_f32 v104, v112, v113
    v_exp_f32 v118, v86
    v_exp_f32 v119, v87
    v_cvt_pk_bf16_f32 v105, v114, v115
    v_mfma_f32_32x32x16_bf16 v[32:47], v[144:147], v[96:99], v[32:47]
    v_exp_f32 v120, v88
    v_exp_f32 v121, v89
    v_cvt_pk_bf16_f32 v106, v116, v117
    v_exp_f32 v122, v90
    v_exp_f32 v123, v91
    v_cvt_pk_bf16_f32 v107, v118, v119
    v_exp_f32 v124, v92
    v_exp_f32 v125, v93
    v_cvt_pk_bf16_f32 v108, v120, v121
    v_mfma_f32_32x32x16_bf16 v[32:47], v[148:151], v[100:103], v[32:47]
    v_exp_f32 v126, v94
    v_exp_f32 v127, v95
    v_cvt_pk_bf16_f32 v109, v122, v123
    v_mfma_f32_32x32x16_bf16 v[80:95], v[128:131], v[12:15], 0
    v_exp_f32 v112, v64
    v_exp_f32 v113, v65
    v_cvt_pk_bf16_f32 v110, v124, v125
    v_exp_f32 v114, v66
    v_exp_f32 v115, v67
    v_cvt_pk_bf16_f32 v111, v126, v127
    v_exp_f32 v116, v68
    v_exp_f32 v117, v69
    v_cvt_pk_bf16_f32 v96, v112, v113
    v_exp_f32 v118, v70
    v_exp_f32 v119, v71
    v_cvt_pk_bf16_f32 v97, v114, v115
    v_mfma_f32_32x32x16_bf16 v[48:63], v[144:147], v[104:107], v[48:63]
    v_exp_f32 v120, v72
    v_exp_f32 v121, v73
    v_cvt_pk_bf16_f32 v98, v116, v117
    v_exp_f32 v122, v74
    v_exp_f32 v123, v75
    v_cvt_pk_bf16_f32 v99, v118, v119
    v_exp_f32 v124, v76
    v_exp_f32 v125, v77
    v_cvt_pk_bf16_f32 v100, v120, v121
    v_mfma_f32_32x32x16_bf16 v[48:63], v[148:151], v[108:111], v[48:63]
    v_exp_f32 v126, v78
    v_exp_f32 v127, v79
    v_cvt_pk_bf16_f32 v101, v122, v123
    s_waitcnt lgkmcnt(0)
    v_mfma_f32_32x32x16_bf16 v[64:79], v[132:135], v[8:11], 0
    ds_read_b128 v[128:131], v156 offset:8704
    ds_read_b128 v[144:147], v157 offset:6528
    ds_read_b128 v[148:151], v157 offset:7104
    v_exp_f32 v112, v80
    v_exp_f32 v113, v81
    v_cvt_pk_bf16_f32 v102, v124, v125
    v_exp_f32 v114, v82
    v_exp_f32 v115, v83
    v_cvt_pk_bf16_f32 v103, v126, v127
    v_exp_f32 v116, v84
    v_exp_f32 v117, v85
    v_cvt_pk_bf16_f32 v104, v112, v113
    v_exp_f32 v118, v86
    v_exp_f32 v119, v87
    v_cvt_pk_bf16_f32 v105, v114, v115
    v_mfma_f32_32x32x16_bf16 v[32:47], v[136:139], v[96:99], v[32:47]
    v_exp_f32 v120, v88
    v_exp_f32 v121, v89
    v_cvt_pk_bf16_f32 v106, v116, v117
    v_exp_f32 v122, v90
    v_exp_f32 v123, v91
    v_cvt_pk_bf16_f32 v107, v118, v119
    v_exp_f32 v124, v92
    v_exp_f32 v125, v93
    v_cvt_pk_bf16_f32 v108, v120, v121
    v_mfma_f32_32x32x16_bf16 v[32:47], v[140:143], v[100:103], v[32:47]
    v_exp_f32 v126, v94
    v_exp_f32 v127, v95
    v_cvt_pk_bf16_f32 v109, v122, v123
    v_mfma_f32_32x32x16_bf16 v[80:95], v[132:135], v[12:15], 0
    v_exp_f32 v112, v64
    v_exp_f32 v113, v65
    v_cvt_pk_bf16_f32 v110, v124, v125
    v_exp_f32 v114, v66
    v_exp_f32 v115, v67
    v_cvt_pk_bf16_f32 v111, v126, v127
    v_exp_f32 v116, v68
    v_exp_f32 v117, v69
    v_cvt_pk_bf16_f32 v96, v112, v113
    v_exp_f32 v118, v70
    v_exp_f32 v119, v71
    v_cvt_pk_bf16_f32 v97, v114, v115
    v_mfma_f32_32x32x16_bf16 v[48:63], v[136:139], v[104:107], v[48:63]
    v_exp_f32 v120, v72
    v_exp_f32 v121, v73
    v_cvt_pk_bf16_f32 v98, v116, v117
    v_exp_f32 v122, v74
    v_exp_f32 v123, v75
    v_cvt_pk_bf16_f32 v99, v118, v119
    v_exp_f32 v124, v76
    v_exp_f32 v125, v77
    v_cvt_pk_bf16_f32 v100, v120, v121
    v_mfma_f32_32x32x16_bf16 v[48:63], v[140:143], v[108:111], v[48:63]
    v_exp_f32 v126, v78
    v_exp_f32 v127, v79
    v_cvt_pk_bf16_f32 v101, v122, v123
    s_waitcnt lgkmcnt(0)
    v_mfma_f32_32x32x16_bf16 v[64:79], v[128:131], v[8:11], 0
    ds_read_b128 v[132:135], v156 offset:10880
    ds_read_b128 v[136:139], v157 offset:8704
    ds_read_b128 v[140:143], v157 offset:9280
    v_exp_f32 v112, v80
    v_exp_f32 v113, v81
    v_cvt_pk_bf16_f32 v102, v124, v125
    v_exp_f32 v114, v82
    v_exp_f32 v115, v83
    v_cvt_pk_bf16_f32 v103, v126, v127
    v_exp_f32 v116, v84
    v_exp_f32 v117, v85
    v_cvt_pk_bf16_f32 v104, v112, v113
    v_exp_f32 v118, v86
    v_exp_f32 v119, v87
    v_cvt_pk_bf16_f32 v105, v114, v115
    v_mfma_f32_32x32x16_bf16 v[32:47], v[144:147], v[96:99], v[32:47]
    v_exp_f32 v120, v88
    v_exp_f32 v121, v89
    v_cvt_pk_bf16_f32 v106, v116, v117
    v_exp_f32 v122, v90
    v_exp_f32 v123, v91
    v_cvt_pk_bf16_f32 v107, v118, v119
    v_exp_f32 v124, v92
    v_exp_f32 v125, v93
    v_cvt_pk_bf16_f32 v108, v120, v121
    v_mfma_f32_32x32x16_bf16 v[32:47], v[148:151], v[100:103], v[32:47]
    v_exp_f32 v126, v94
    v_exp_f32 v127, v95
    v_cvt_pk_bf16_f32 v109, v122, v123
    v_add_u32 v156, 8704, v156
    v_add_u32 v157, 8704, v157
    s_add_u32 s29, s29, 1
    s_cmp_lg_u32 s29, 8
    s_cbranch_scc1 F0_loop
    s_waitcnt vmcnt(0)
    v_cvt_pk_bf16_f32 v110, v124, v125
    v_cvt_pk_bf16_f32 v111, v126, v127
    s_nop 1
    v_mfma_f32_32x32x16_bf16 v[48:63], v[144:147], v[104:107], v[48:63]
    v_mfma_f32_32x32x16_bf16 v[48:63], v[148:151], v[108:111], v[48:63]
    s_mul_i32 s25, s3, 2304
    s_add_u32 s25, s25, 139264
    v_add_u32 v5, s25, v2
    v_lshlrev_b32 v6, 2, v1
    v_add_u32 v6, s25, v6
    s_xor_b32 s25, s3, 4
    s_mul_i32 s25, s25, 2304
    s_add_u32 s25, s25, 139264
    v_add_u32 v7, s25, v2
    s_waitcnt vmcnt(0)
    s_mov_b32 s37, 0
    v_and_b32 v153, 7, v1
    v_lshlrev_b32 v153, 2, v153
F0_xchk:
    v_cmp_eq_u32 vcc, 0, v159
    s_cmp_eq_u64 vcc, 0
    s_cbranch_scc1 F0_xok
    s_add_u32 s37, s37, 1
    s_cmp_gt_u32 s37, 200000
    s_cbranch_scc1 F0_xok
    s_sleep 1
    buffer_load_dword v159, v153, s[8:11], s62 offen offset:64 sc0 sc1
    s_waitcnt vmcnt(0)
    s_branch F0_xchk
F0_xok:
    v_cmp_ne_u32 vcc, s61, v159
    s_cmp_eq_u64 vcc, 0
    s_cselect_b32 s61, 1, 0
    v_lshlrev_b32 v154, 2, v1
    v_add_u32 v154, s25, v154
    s_waitcnt lgkmcnt(0)
    s_nop 7
    ds_write_b128 v5, v[48:51]
    ds_write_b128 v5, v[52:55] offset:1024
    ds_write_b32 v6, v56 offset:2048
    s_waitcnt lgkmcnt(0)
    s_barrier
    ds_read_b128 v[64:67], v7
    ds_read_b128 v[68:71], v7 offset:1024
    ds_read_b32 v72, v154 offset:2048
    v_mov_b32 v5, 157696
    ds_read_b128 v[80:83], v5
    ds_read_b128 v[84:87], v5 offset:16
    s_waitcnt lgkmcnt(0)
    v_add_f32 v32, v32, v64
    v_add_f32 v33, v33, v65
    v_add_f32 v34, v34, v66
    v_add_f32 v35, v35, v67
    v_add_f32 v36, v36, v68
    v_add_f32 v37, v37, v69
    v_add_f32 v38, v38, v70
    v_add_f32 v39, v39, v71
    v_add_f32 v40, v40, v72
    v_max3_f32 v5, v80, v81, v82
    v_max3_f32 v5, v5, v83, v84
    v_max3_f32 v5, v5, v85, v86
    v_max_f32 v5, v5, v87
    v_mul_f32 v5, s63, v5
    v_mov_b32 v6, 0x45800000
    v_cmp_nle_f32 vcc, v5, v6
    s_cmp_eq_u64 vcc, 0
    s_cbranch_scc1 F0_afin
    v_mov_b32 v156, v2
    v_mov_b32 v6, 0xff800000
    s_mov_b32 s29, 64
F0_fb:
    ds_read_b128 v[128:131], v156
    v_add_u32 v156, 2176, v156
    s_waitcnt lgkmcnt(0)
    v_mfma_f32_32x32x16_bf16 v[64:79], v[128:131], v[8:11], 0
    s_nop 15
    v_max3_f32 v6, v6, v64, v65
    v_max3_f32 v6, v6, v66, v67
    v_max3_f32 v6, v6, v68, v69
    v_max3_f32 v6, v6, v70, v71
    v_max3_f32 v6, v6, v72, v73
    v_max3_f32 v6, v6, v74, v75
    v_max3_f32 v6, v6, v76, v77
    v_max3_f32 v6, v6, v78, v79
    s_sub_u32 s29, s29, 1
    s_cmp_lg_u32 s29, 0
    s_cbranch_scc1 F0_fb
    v_mov_b32 v7, v6
    s_nop 1
    v_permlane32_swap_b32 v6, v7
    s_nop 0
    v_max_f32 v6, v6, v7
    v_sub_f32 v6, 0, v6
    v_mov_b32 v80, v6
    v_mov_b32 v32, 0
    v_mov_b32 v81, v6
    v_mov_b32 v33, 0
    v_mov_b32 v82, v6
    v_mov_b32 v34, 0
    v_mov_b32 v83, v6
    v_mov_b32 v35, 0
    v_mov_b32 v84, v6
    v_mov_b32 v36, 0
    v_mov_b32 v85, v6
    v_mov_b32 v37, 0
    v_mov_b32 v86, v6
    v_mov_b32 v38, 0
    v_mov_b32 v87, v6
    v_mov_b32 v39, 0
    v_mov_b32 v88, v6
    v_mov_b32 v40, 0
    v_mov_b32 v89, v6
    v_mov_b32 v41, 0
    v_mov_b32 v90, v6
    v_mov_b32 v42, 0
    v_mov_b32 v91, v6
    v_mov_b32 v43, 0
    v_mov_b32 v92, v6
    v_mov_b32 v44, 0
    v_mov_b32 v93, v6
    v_mov_b32 v45, 0
    v_mov_b32 v94, v6
    v_mov_b32 v46, 0
    v_mov_b32 v95, v6
    v_mov_b32 v47, 0
    v_mov_b32 v156, v2
    v_mov_b32 v157, v158
    s_mov_b32 s29, 64
F0_fb2:
    ds_read_b128 v[128:131], v156
    ds_read_b128 v[136:139], v157
    ds_read_b128 v[140:143], v157 offset:576
    v_add_u32 v156, 2176, v156
    v_add_u32 v157, 2176, v157
    s_waitcnt lgkmcnt(0)
    v_mfma_f32_32x32x16_bf16 v[64:79], v[128:131], v[8:11], v[80:95]
    s_nop 15
    v_exp_f32 v64, v64
    v_exp_f32 v65, v65
    v_exp_f32 v66, v66
    v_exp_f32 v67, v67
    v_exp_f32 v68, v68
    v_exp_f32 v69, v69
    v_exp_f32 v70, v70
    v_exp_f32 v71, v71
    v_exp_f32 v72, v72
    v_exp_f32 v73, v73
    v_exp_f32 v74, v74
    v_exp_f32 v75, v75
    v_exp_f32 v76, v76
    v_exp_f32 v77, v77
    v_exp_f32 v78, v78
    v_exp_f32 v79, v79
    s_nop 0
    v_cvt_pk_bf16_f32 v96, v64, v65
    v_cvt_pk_bf16_f32 v97, v66, v67
    v_cvt_pk_bf16_f32 v98, v68, v69
    v_cvt_pk_bf16_f32 v99, v70, v71
    v_cvt_pk_bf16_f32 v100, v72, v73
    v_cvt_pk_bf16_f32 v101, v74, v75
    v_cvt_pk_bf16_f32 v102, v76, v77
    v_cvt_pk_bf16_f32 v103, v78, v79
    s_nop 1
    v_mfma_f32_32x32x16_bf16 v[32:47], v[136:139], v[96:99], v[32:47]
    v_mfma_f32_32x32x16_bf16 v[32:47], v[140:143], v[100:103], v[32:47]
    s_nop 15
    s_sub_u32 s29, s29, 1
    s_cmp_lg_u32 s29, 0
    s_cbranch_scc1 F0_fb2
F0_afin:
    v_rcp_f32 v6, v40
    s_nop 0
    v_mul_f32 v32, v32, v6
    v_mul_f32 v33, v33, v6
    v_mul_f32 v34, v34, v6
    v_mul_f32 v35, v35, v6
    v_mul_f32 v36, v36, v6
    v_mul_f32 v37, v37, v6
    v_mul_f32 v38, v38, v6
    v_mul_f32 v39, v39, v6
    v_cvt_pk_bf16_f32 v64, v32, v33
    v_cvt_pk_bf16_f32 v65, v34, v35
    v_cvt_pk_bf16_f32 v66, v36, v37
    v_cvt_pk_bf16_f32 v67, v38, v39
    s_add_u32 s23, s22, 0x900000
    s_cmp_lg_u32 s61, 0
    s_cbranch_scc1 HS1_f
    buffer_store_dwordx4 v[64:67], v2, s[8:11], s23 offen sc0 sc1
    s_branch HS1_e
HS1_f:
    buffer_store_dwordx4 v[64:67], v2, s[8:11], s23 offen
HS1_e:
    s_waitcnt vmcnt(0)
    s_barrier
    s_cmp_lg_u32 s3, 0
    s_cbranch_scc1 F0_p1_np
    v_mov_b32 v5, 1
    v_mov_b32 v6, 0
    v_cmp_eq_u32 vcc, 0, v1
    s_and_saveexec_b64 s[38:39], vcc
    s_cmp_lg_u32 s61, 0
    s_cbranch_scc1 HS2_f
    buffer_store_dword v5, v6, s[8:11], s40 offen sc0 sc1
    s_branch HS2_e
HS2_f:
    buffer_store_dword v5, v6, s[8:11], s40 offen
HS2_e:
    s_mov_b64 exec, s[38:39]
F0_p1_np:
    s_lshl_b32 s20, s4, 6
    s_lshl_b32 s21, s3, 2
    s_add_u32 s20, s20, s21
    s_lshl_b32 s53, s20, 10
    s_add_u32 s20, s53, 0x900000
    s_add_u32 s21, s20, 32768
    s_add_u32 s33, s50, 24576
    buffer_load_dwordx4 v[8:11], v2, s[8:11], s33 offen offset:3072
    s_add_u32 s33, s50, 28672
    buffer_load_dwordx4 v[12:15], v2, s[8:11], s33 offen offset:0
    s_add_u32 s33, s50, 28672
    buffer_load_dwordx4 v[144:147], v2, s[8:11], s33 offen offset:1024
    s_add_u32 s33, s50, 28672
    buffer_load_dwordx4 v[148:151], v2, s[8:11], s33 offen offset:2048
    s_add_u32 s33, s50, 28672
    buffer_load_dwordx4 v[152:155], v2, s[8:11], s33 offen offset:3072
    v_mov_b32 v6, 0
    s_mov_b32 s37, 0
F0_w1_poll:
    buffer_load_dword v5, v6, s[8:11], s41 offen sc0 sc1
    s_waitcnt vmcnt(0)
    v_readfirstlane_b32 s36, v5
    s_add_u32 s37, s37, 1
    s_cmp_ge_u32 s36, 1
    s_cbranch_scc1 F0_w1_go
    s_cmp_gt_u32 s37, 200000
    s_cbranch_scc1 F0_w1_go
    s_sleep 1
    s_branch F0_w1_poll
F0_w1_go:
    buffer_load_dwordx4 v[32:35], v2, s[8:11], s20 offen offset:0 sc1
    buffer_load_dwordx4 v[36:39], v2, s[8:11], s21 offen offset:0 sc1
    buffer_load_dwordx4 v[40:43], v2, s[8:11], s20 offen offset:1024 sc1
    buffer_load_dwordx4 v[44:47], v2, s[8:11], s21 offen offset:1024 sc1
    buffer_load_dwordx4 v[48:51], v2, s[8:11], s20 offen offset:2048 sc1
    buffer_load_dwordx4 v[52:55], v2, s[8:11], s21 offen offset:2048 sc1
    buffer_load_dwordx4 v[56:59], v2, s[8:11], s20 offen offset:3072 sc1
    buffer_load_dwordx4 v[60:63], v2, s[8:11], s21 offen offset:3072 sc1
    s_waitcnt vmcnt(6)
    v_mfma_f32_32x32x16_bf16 v[64:79], a[0:3], v[32:35], 0
    v_mfma_f32_32x32x16_bf16 v[80:95], a[0:3], v[36:39], 0
    v_mfma_f32_32x32x16_bf16 v[96:111], a[4:7], v[32:35], 0
    v_mfma_f32_32x32x16_bf16 v[112:127], a[4:7], v[36:39], 0
    s_waitcnt vmcnt(4)
    v_mfma_f32_32x32x16_bf16 v[64:79], a[8:11], v[40:43], v[64:79]
    v_mfma_f32_32x32x16_bf16 v[80:95], a[8:11], v[44:47], v[80:95]
    v_mfma_f32_32x32x16_bf16 v[96:111], a[12:15], v[40:43], v[96:111]
    v_mfma_f32_32x32x16_bf16 v[112:127], a[12:15], v[44:47], v[112:127]
    s_waitcnt vmcnt(2)
    v_mfma_f32_32x32x16_bf16 v[64:79], a[16:19], v[48:51], v[64:79]
    v_mfma_f32_32x32x16_bf16 v[80:95], a[16:19], v[52:55], v[80:95]
    v_mfma_f32_32x32x16_bf16 v[96:111], a[20:23], v[48:51], v[96:111]
    v_mfma_f32_32x32x16_bf16 v[112:127], a[20:23], v[52:55], v[112:127]
    s_waitcnt vmcnt(0)
    v_mfma_f32_32x32x16_bf16 v[64:79], a[24:27], v[56:59], v[64:79]
    v_mfma_f32_32x32x16_bf16 v[80:95], a[24:27], v[60:63], v[80:95]
    v_mfma_f32_32x32x16_bf16 v[96:111], a[28:31], v[56:59], v[96:111]
    v_mfma_f32_32x32x16_bf16 v[112:127], a[28:31], v[60:63], v[112:127]
    s_add_u32 s33, s50, 12288
    buffer_load_dwordx4 a[0:3], v2, s[8:11], s33 offen offset:3072
    s_add_u32 s33, s50, 16384
    buffer_load_dwordx4 a[4:7], v2, s[8:11], s33 offen offset:0
    s_add_u32 s33, s50, 16384
    buffer_load_dwordx4 a[8:11], v2, s[8:11], s33 offen offset:1024
    s_add_u32 s33, s50, 16384
    buffer_load_dwordx4 a[12:15], v2, s[8:11], s33 offen offset:2048
    s_add_u32 s33, s50, 16384
    buffer_load_dwordx4 a[16:19], v2, s[8:11], s33 offen offset:3072
    s_add_u32 s33, s50, 20480
    buffer_load_dwordx4 a[20:23], v2, s[8:11], s33 offen offset:0
    s_add_u32 s33, s50, 20480
    buffer_load_dwordx4 a[24:27], v2, s[8:11], s33 offen offset:1024
    s_add_u32 s33, s50, 20480
    buffer_load_dwordx4 a[28:31], v2, s[8:11], s33 offen offset:2048
    s_lshl_b32 s32, s3, 11
    v_add_u32 v5, s32, v2
    v_add_u32 v6, 0x10000, v5
    s_lshl_b32 s32, s3, 14
    v_add_u32 v7, s32, v2
    s_nop 11
    ds_write_b128 v5, v[64:67] offset:0
    ds_write_b128 v5, v[68:71] offset:1024
    ds_write_b128 v5, v[72:75] offset:16384
    ds_write_b128 v5, v[76:79] offset:17408
    ds_write_b128 v5, v[80:83] offset:32768
    ds_write_b128 v5, v[84:87] offset:33792
    ds_write_b128 v5, v[88:91] offset:49152
    ds_write_b128 v5, v[92:95] offset:50176
    ds_write_b128 v6, v[96:99] offset:0
    ds_write_b128 v6, v[100:103] offset:1024
    ds_write_b128 v6, v[104:107] offset:16384
    ds_write_b128 v6, v[108:111] offset:17408
    ds_write_b128 v6, v[112:115] offset:32768
    ds_write_b128 v6, v[116:119] offset:33792
    ds_write_b128 v6, v[120:123] offset:49152
    ds_write_b128 v6, v[124:127] offset:50176
    s_waitcnt lgkmcnt(0)
    s_barrier
    ds_read_b128 v[64:67], v7 offset:0
    ds_read_b128 v[68:71], v7 offset:1024
    ds_read_b128 v[72:75], v7 offset:2048
    ds_read_b128 v[76:79], v7 offset:3072
    ds_read_b128 v[80:83], v7 offset:4096
    ds_read_b128 v[84:87], v7 offset:5120
    ds_read_b128 v[88:91], v7 offset:6144
    ds_read_b128 v[92:95], v7 offset:7168
    ds_read_b128 v[96:99], v7 offset:8192
    ds_read_b128 v[100:103], v7 offset:9216
    ds_read_b128 v[104:107], v7 offset:10240
    ds_read_b128 v[108:111], v7 offset:11264
    ds_read_b128 v[112:115], v7 offset:12288
    ds_read_b128 v[116:119], v7 offset:13312
    ds_read_b128 v[120:123], v7 offset:14336
    ds_read_b128 v[124:127], v7 offset:15360
    s_waitcnt lgkmcnt(12)
    v_add_f32 v128, v64, v72
    v_add_f32 v129, v65, v73
    v_add_f32 v130, v66, v74
    v_add_f32 v131, v67, v75
    v_add_f32 v132, v68, v76
    v_add_f32 v133, v69, v77
    v_add_f32 v134, v70, v78
    v_add_f32 v135, v71, v79
    s_waitcnt lgkmcnt(8)
    v_add_f32 v80, v80, v88
    v_add_f32 v128, v128, v80
    v_add_f32 v81, v81, v89
    v_add_f32 v129, v129, v81
    v_add_f32 v82, v82, v90
    v_add_f32 v130, v130, v82
    v_add_f32 v83, v83, v91
    v_add_f32 v131, v131, v83
    v_add_f32 v84, v84, v92
    v_add_f32 v132, v132, v84
    v_add_f32 v85, v85, v93
    v_add_f32 v133, v133, v85
    v_add_f32 v86, v86, v94
    v_add_f32 v134, v134, v86
    v_add_f32 v87, v87, v95
    v_add_f32 v135, v135, v87
    s_waitcnt lgkmcnt(4)
    v_add_f32 v96, v96, v104
    v_add_f32 v128, v128, v96
    v_add_f32 v97, v97, v105
    v_add_f32 v129, v129, v97
    v_add_f32 v98, v98, v106
    v_add_f32 v130, v130, v98
    v_add_f32 v99, v99, v107
    v_add_f32 v131, v131, v99
    v_add_f32 v100, v100, v108
    v_add_f32 v132, v132, v100
    v_add_f32 v101, v101, v109
    v_add_f32 v133, v133, v101
    v_add_f32 v102, v102, v110
    v_add_f32 v134, v134, v102
    v_add_f32 v103, v103, v111
    v_add_f32 v135, v135, v103
    s_waitcnt lgkmcnt(0)
    v_add_f32 v112, v112, v120
    v_add_f32 v128, v128, v112
    v_add_f32 v113, v113, v121
    v_add_f32 v129, v129, v113
    v_add_f32 v114, v114, v122
    v_add_f32 v130, v130, v114
    v_add_f32 v115, v115, v123
    v_add_f32 v131, v131, v115
    v_add_f32 v116, v116, v124
    v_add_f32 v132, v132, v116
    v_add_f32 v117, v117, v125
    v_add_f32 v133, v133, v117
    v_add_f32 v118, v118, v126
    v_add_f32 v134, v134, v118
    v_add_f32 v119, v119, v127
    v_add_f32 v135, v135, v119
    v_accvgpr_read_b32 v136, a32
    v_accvgpr_read_b32 v137, a33
    v_accvgpr_read_b32 v138, a34
    v_accvgpr_read_b32 v139, a35
    v_lshlrev_b32 v140, 16, v136
    v_and_b32 v141, 0xffff0000, v136
    v_add_f32 v128, v128, v140
    v_add_f32 v129, v129, v141
    v_lshlrev_b32 v140, 16, v137
    v_and_b32 v141, 0xffff0000, v137
    v_add_f32 v130, v130, v140
    v_add_f32 v131, v131, v141
    v_lshlrev_b32 v140, 16, v138
    v_and_b32 v141, 0xffff0000, v138
    v_add_f32 v132, v132, v140
    v_add_f32 v133, v133, v141
    v_lshlrev_b32 v140, 16, v139
    v_and_b32 v141, 0xffff0000, v139
    v_add_f32 v134, v134, v140
    v_add_f32 v135, v135, v141
    v_cvt_pk_bf16_f32 v136, v128, v129
    v_cvt_pk_bf16_f32 v137, v130, v131
    v_cvt_pk_bf16_f32 v138, v132, v133
    v_cvt_pk_bf16_f32 v139, v134, v135
    s_add_u32 s23, s42, 0xb00000
    s_cmp_lg_u32 s61, 0
    s_cbranch_scc1 HS3_f
    buffer_store_dwordx4 v[136:139], v2, s[8:11], s23 offen sc0 sc1
    s_branch HS3_e
HS3_f:
    buffer_store_dwordx4 v[136:139], v2, s[8:11], s23 offen
HS3_e:
    v_accvgpr_write_b32 a32, v136
    v_accvgpr_write_b32 a33, v137
    v_accvgpr_write_b32 a34, v138
    v_accvgpr_write_b32 a35, v139
    s_waitcnt vmcnt(0)
    s_barrier
    s_cmp_lg_u32 s3, 0
    s_cbranch_scc1 F0_p2_np
    v_mov_b32 v5, 2
    v_mov_b32 v6, 0
    v_cmp_eq_u32 vcc, 0, v1
    s_and_saveexec_b64 s[38:39], vcc
    s_cmp_lg_u32 s61, 0
    s_cbranch_scc1 HS4_f
    buffer_store_dword v5, v6, s[8:11], s40 offen sc0 sc1
    s_branch HS4_e
HS4_f:
    buffer_store_dword v5, v6, s[8:11], s40 offen
HS4_e:
    s_mov_b64 exec, s[38:39]
F0_p2_np:
    s_add_u32 s20, s53, 0xb00000
    s_add_u32 s21, s20, 32768
    v_mov_b32 v6, 0
    s_mov_b32 s37, 0
F0_w2_poll:
    buffer_load_dword v5, v6, s[8:11], s41 offen sc0 sc1
    s_waitcnt vmcnt(0)
    v_readfirstlane_b32 s36, v5
    s_add_u32 s37, s37, 1
    s_cmp_ge_u32 s36, 2
    s_cbranch_scc1 F0_w2_go
    s_cmp_gt_u32 s37, 200000
    s_cbranch_scc1 F0_w2_go
    s_sleep 1
    s_branch F0_w2_poll
F0_w2_go:
    buffer_load_dwordx4 v[32:35], v2, s[8:11], s20 offen offset:0 sc1
    buffer_load_dwordx4 v[36:39], v2, s[8:11], s20 offen offset:1024 sc1
    buffer_load_dwordx4 v[40:43], v2, s[8:11], s20 offen offset:2048 sc1
    buffer_load_dwordx4 v[44:47], v2, s[8:11], s20 offen offset:3072 sc1
    buffer_load_dwordx4 v[48:51], v2, s[8:11], s21 offen offset:0 sc1
    buffer_load_dwordx4 v[52:55], v2, s[8:11], s21 offen offset:1024 sc1
    buffer_load_dwordx4 v[56:59], v2, s[8:11], s21 offen offset:2048 sc1
    buffer_load_dwordx4 v[60:63], v2, s[8:11], s21 offen offset:3072 sc1
    v_lshlrev_b32 v7, 4, v4
    s_lshl_b32 s27, s51, 7
    s_add_u32 s27, s27, 0x488800
    buffer_load_dwordx4 v[88:91], v7, s[8:11], s27 offen offset:0
    buffer_load_dwordx4 v[92:95], v7, s[8:11], s27 offen offset:32
    buffer_load_dwordx4 v[96:99], v7, s[8:11], s27 offen offset:64
    buffer_load_dwordx4 v[100:103], v7, s[8:11], s27 offen offset:96
    s_lshl_b32 s21, s3, 12
    v_add_u32 v5, s21, v2
    s_mov_b32 s28, 0x3f803f80
    v_mov_b32 v80, 0
    v_mov_b32 v81, 0
    v_mov_b32 v82, 0
    v_mov_b32 v83, 0
    v_mov_b32 v84, 0
    v_mov_b32 v85, 0
    v_mov_b32 v86, 0
    v_mov_b32 v87, 0
    s_waitcnt vmcnt(8)
    ds_write_b128 v5, v[32:35] offset:0
    ds_write_b128 v5, v[36:39] offset:1024
    ds_write_b128 v5, v[40:43] offset:2048
    ds_write_b128 v5, v[44:47] offset:3072
    v_dot2_f32_bf16 v80, v32, s28, v80
    v_dot2_f32_bf16 v81, v32, v32, v81
    v_dot2_f32_bf16 v84, v33, s28, v84
    v_dot2_f32_bf16 v85, v33, v33, v85
    v_dot2_f32_bf16 v80, v34, s28, v80
    v_dot2_f32_bf16 v81, v34, v34, v81
    v_dot2_f32_bf16 v84, v35, s28, v84
    v_dot2_f32_bf16 v85, v35, v35, v85
    v_dot2_f32_bf16 v80, v36, s28, v80
    v_dot2_f32_bf16 v81, v36, v36, v81
    v_dot2_f32_bf16 v84, v37, s28, v84
    v_dot2_f32_bf16 v85, v37, v37, v85
    v_dot2_f32_bf16 v80, v38, s28, v80
    v_dot2_f32_bf16 v81, v38, v38, v81
    v_dot2_f32_bf16 v84, v39, s28, v84
    v_dot2_f32_bf16 v85, v39, v39, v85
    v_dot2_f32_bf16 v80, v40, s28, v80
    v_dot2_f32_bf16 v81, v40, v40, v81
    v_dot2_f32_bf16 v84, v41, s28, v84
    v_dot2_f32_bf16 v85, v41, v41, v85
    v_dot2_f32_bf16 v80, v42, s28, v80
    v_dot2_f32_bf16 v81, v42, v42, v81
    v_dot2_f32_bf16 v84, v43, s28, v84
    v_dot2_f32_bf16 v85, v43, v43, v85
    v_dot2_f32_bf16 v80, v44, s28, v80
    v_dot2_f32_bf16 v81, v44, v44, v81
    v_dot2_f32_bf16 v84, v45, s28, v84
    v_dot2_f32_bf16 v85, v45, v45, v85
    v_dot2_f32_bf16 v80, v46, s28, v80
    v_dot2_f32_bf16 v81, v46, v46, v81
    v_dot2_f32_bf16 v84, v47, s28, v84
    v_dot2_f32_bf16 v85, v47, v47, v85
    s_waitcnt vmcnt(4)
    ds_write_b128 v5, v[48:51] offset:32768
    ds_write_b128 v5, v[52:55] offset:33792
    ds_write_b128 v5, v[56:59] offset:34816
    ds_write_b128 v5, v[60:63] offset:35840
    v_dot2_f32_bf16 v82, v48, s28, v82
    v_dot2_f32_bf16 v83, v48, v48, v83
    v_dot2_f32_bf16 v86, v49, s28, v86
    v_dot2_f32_bf16 v87, v49, v49, v87
    v_dot2_f32_bf16 v82, v50, s28, v82
    v_dot2_f32_bf16 v83, v50, v50, v83
    v_dot2_f32_bf16 v86, v51, s28, v86
    v_dot2_f32_bf16 v87, v51, v51, v87
    v_dot2_f32_bf16 v82, v52, s28, v82
    v_dot2_f32_bf16 v83, v52, v52, v83
    v_dot2_f32_bf16 v86, v53, s28, v86
    v_dot2_f32_bf16 v87, v53, v53, v87
    v_dot2_f32_bf16 v82, v54, s28, v82
    v_dot2_f32_bf16 v83, v54, v54, v83
    v_dot2_f32_bf16 v86, v55, s28, v86
    v_dot2_f32_bf16 v87, v55, v55, v87
    v_dot2_f32_bf16 v82, v56, s28, v82
    v_dot2_f32_bf16 v83, v56, v56, v83
    v_dot2_f32_bf16 v86, v57, s28, v86
    v_dot2_f32_bf16 v87, v57, v57, v87
    v_dot2_f32_bf16 v82, v58, s28, v82
    v_dot2_f32_bf16 v83, v58, v58, v83
    v_dot2_f32_bf16 v86, v59, s28, v86
    v_dot2_f32_bf16 v87, v59, v59, v87
    v_dot2_f32_bf16 v82, v60, s28, v82
    v_dot2_f32_bf16 v83, v60, v60, v83
    v_dot2_f32_bf16 v86, v61, s28, v86
    v_dot2_f32_bf16 v87, v61, v61, v87
    v_dot2_f32_bf16 v82, v62, s28, v82
    v_dot2_f32_bf16 v83, v62, v62, v83
    v_dot2_f32_bf16 v86, v63, s28, v86
    v_dot2_f32_bf16 v87, v63, v63, v87
    s_lshl_b32 s21, s3, 10
    s_add_u32 s21, s21, 65536
    v_add_u32 v5, s21, v2
    s_nop 1
    v_add_f32 v80, v80, v84
    v_add_f32 v81, v81, v85
    v_add_f32 v82, v82, v86
    v_add_f32 v83, v83, v87
    ds_write_b128 v5, v[80:83]
    s_waitcnt lgkmcnt(0)
    s_barrier
    s_lshl_b32 s32, s5, 1
    s_mul_i32 s54, s32, 112
    s_mul_i32 s33, s3, 14
    s_add_u32 s54, s54, s33
    s_lshl_b32 s54, s54, 10
    s_add_u32 s54, s54, 0x2c0000
    s_add_u32 s55, s54, 114688
    s_cmp_eq_u32 s3, 7
    s_cbranch_scc1 F0_cskip
    ds_read_b128 v[32:35], v2 offset:0
    ds_read_b128 v[36:39], v2 offset:32768
    ds_read_b128 v[40:43], v2 offset:1024
    ds_read_b128 v[44:47], v2 offset:33792
    ds_read_b128 v[48:51], v2 offset:2048
    ds_read_b128 v[52:55], v2 offset:34816
    ds_read_b128 v[56:59], v2 offset:3072
    ds_read_b128 v[60:63], v2 offset:35840
    ds_read_b128 v[64:67], v2 offset:4096
    ds_read_b128 v[68:71], v2 offset:36864
    ds_read_b128 v[72:75], v2 offset:5120
    ds_read_b128 v[76:79], v2 offset:37888
    s_waitcnt lgkmcnt(10)
    v_mfma_f32_32x32x16_bf16 v[104:119], a[36:39], v[32:35], 0
    v_mfma_f32_32x32x16_bf16 v[120:135], a[36:39], v[36:39], 0
    ds_read_b128 v[32:35], v2 offset:6144
    ds_read_b128 v[36:39], v2 offset:38912
    s_waitcnt lgkmcnt(10)
    v_mfma_f32_32x32x16_bf16 v[104:119], a[40:43], v[40:43], v[104:119]
    v_mfma_f32_32x32x16_bf16 v[120:135], a[40:43], v[44:47], v[120:135]
    buffer_load_dwordx4 a[36:39], v2, s[8:11], s54 offen offset:0
    ds_read_b128 v[40:43], v2 offset:7168
    ds_read_b128 v[44:47], v2 offset:39936
    s_waitcnt lgkmcnt(10)
    v_mfma_f32_32x32x16_bf16 v[104:119], a[44:47], v[48:51], v[104:119]
    v_mfma_f32_32x32x16_bf16 v[120:135], a[44:47], v[52:55], v[120:135]
    buffer_load_dwordx4 a[40:43], v2, s[8:11], s55 offen offset:0
    ds_read_b128 v[48:51], v2 offset:8192
    ds_read_b128 v[52:55], v2 offset:40960
    s_waitcnt lgkmcnt(10)
    v_mfma_f32_32x32x16_bf16 v[104:119], a[48:51], v[56:59], v[104:119]
    v_mfma_f32_32x32x16_bf16 v[120:135], a[48:51], v[60:63], v[120:135]
    buffer_load_dwordx4 a[44:47], v2, s[8:11], s54 offen offset:1024
    ds_read_b128 v[56:59], v2 offset:9216
    ds_read_b128 v[60:63], v2 offset:41984
    s_waitcnt lgkmcnt(10)
    v_mfma_f32_32x32x16_bf16 v[104:119], a[52:55], v[64:67], v[104:119]
    v_mfma_f32_32x32x16_bf16 v[120:135], a[52:55], v[68:71], v[120:135]
    buffer_load_dwordx4 a[48:51], v2, s[8:11], s55 offen offset:1024
    ds_read_b128 v[64:67], v2 offset:10240
    ds_read_b128 v[68:71], v2 offset:43008
    s_waitcnt lgkmcnt(10)
    v_mfma_f32_32x32x16_bf16 v[104:119], a[56:59], v[72:75], v[104:119]
    v_mfma_f32_32x32x16_bf16 v[120:135], a[56:59], v[76:79], v[120:135]
    buffer_load_dwordx4 a[52:55], v2, s[8:11], s54 offen offset:2048
    ds_read_b128 v[72:75], v2 offset:11264
    ds_read_b128 v[76:79], v2 offset:44032
    s_waitcnt lgkmcnt(10)
    v_mfma_f32_32x32x16_bf16 v[104:119], a[60:63], v[32:35], v[104:119]
    v_mfma_f32_32x32x16_bf16 v[120:135], a[60:63], v[36:39], v[120:135]
    buffer_load_dwordx4 a[56:59], v2, s[8:11], s55 offen offset:2048
    ds_read_b128 v[32:35], v2 offset:12288
    ds_read_b128 v[36:39], v2 offset:45056
    s_waitcnt lgkmcnt(10)
    v_mfma_f32_32x32x16_bf16 v[104:119], a[64:67], v[40:43], v[104:119]
    v_mfma_f32_32x32x16_bf16 v[120:135], a[64:67], v[44:47], v[120:135]
    buffer_load_dwordx4 a[60:63], v2, s[8:11], s54 offen offset:3072
    ds_read_b128 v[40:43], v2 offset:13312
    ds_read_b128 v[44:47], v2 offset:46080
    s_waitcnt lgkmcnt(10)
    v_mfma_f32_32x32x16_bf16 v[104:119], a[68:71], v[48:51], v[104:119]
    v_mfma_f32_32x32x16_bf16 v[120:135], a[68:71], v[52:55], v[120:135]
    buffer_load_dwordx4 a[64:67], v2, s[8:11], s55 offen offset:3072
    ds_read_b128 v[48:51], v2 offset:14336
    ds_read_b128 v[52:55], v2 offset:47104
    s_waitcnt lgkmcnt(10)
    v_mfma_f32_32x32x16_bf16 v[104:119], a[72:75], v[56:59], v[104:119]
    v_mfma_f32_32x32x16_bf16 v[120:135], a[72:75], v[60:63], v[120:135]
    s_add_u32 s33, s54, 4096
    buffer_load_dwordx4 a[68:71], v2, s[8:11], s33 offen offset:0
    ds_read_b128 v[56:59], v2 offset:15360
    ds_read_b128 v[60:63], v2 offset:48128
    s_waitcnt lgkmcnt(10)
    v_mfma_f32_32x32x16_bf16 v[104:119], a[76:79], v[64:67], v[104:119]
    v_mfma_f32_32x32x16_bf16 v[120:135], a[76:79], v[68:71], v[120:135]
    s_add_u32 s33, s55, 4096
    buffer_load_dwordx4 a[72:75], v2, s[8:11], s33 offen offset:0
    ds_read_b128 v[64:67], v2 offset:16384
    ds_read_b128 v[68:71], v2 offset:49152
    s_waitcnt lgkmcnt(10)
    v_mfma_f32_32x32x16_bf16 v[104:119], a[80:83], v[72:75], v[104:119]
    v_mfma_f32_32x32x16_bf16 v[120:135], a[80:83], v[76:79], v[120:135]
    s_add_u32 s33, s54, 4096
    buffer_load_dwordx4 a[76:79], v2, s[8:11], s33 offen offset:1024
    ds_read_b128 v[72:75], v2 offset:17408
    ds_read_b128 v[76:79], v2 offset:50176
    s_waitcnt lgkmcnt(10)
    v_mfma_f32_32x32x16_bf16 v[104:119], a[84:87], v[32:35], v[104:119]
    v_mfma_f32_32x32x16_bf16 v[120:135], a[84:87], v[36:39], v[120:135]
    s_add_u32 s33, s55, 4096
    buffer_load_dwordx4 a[80:83], v2, s[8:11], s33 offen offset:1024
    ds_read_b128 v[32:35], v2 offset:18432
    ds_read_b128 v[36:39], v2 offset:51200
    s_waitcnt lgkmcnt(10)
    v_mfma_f32_32x32x16_bf16 v[104:119], a[88:91], v[40:43], v[104:119]
    v_mfma_f32_32x32x16_bf16 v[120:135], a[88:91], v[44:47], v[120:135]
    s_add_u32 s33, s54, 4096
    buffer_load_dwordx4 a[84:87], v2, s[8:11], s33 offen offset:2048
    ds_read_b128 v[40:43], v2 offset:19456
    ds_read_b128 v[44:47], v2 offset:52224
    s_waitcnt lgkmcnt(10)
    v_mfma_f32_32x32x16_bf16 v[104:119], a[92:95], v[48:51], v[104:119]
    v_mfma_f32_32x32x16_bf16 v[120:135], a[92:95], v[52:55], v[120:135]
    s_add_u32 s33, s55, 4096
    buffer_load_dwordx4 a[88:91], v2, s[8:11], s33 offen offset:2048
    ds_read_b128 v[48:51], v2 offset:20480
    ds_read_b128 v[52:55], v2 offset:53248
    s_waitcnt lgkmcnt(10)
    v_mfma_f32_32x32x16_bf16 v[104:119], a[0:3], v[56:59], v[104:119]
    v_mfma_f32_32x32x16_bf16 v[120:135], a[0:3], v[60:63], v[120:135]
    s_add_u32 s33, s54, 4096
    buffer_load_dwordx4 a[92:95], v2, s[8:11], s33 offen offset:3072
    ds_read_b128 v[56:59], v2 offset:21504
    ds_read_b128 v[60:63], v2 offset:54272
    s_waitcnt lgkmcnt(10)
    v_mfma_f32_32x32x16_bf16 v[104:119], a[4:7], v[64:67], v[104:119]
    v_mfma_f32_32x32x16_bf16 v[120:135], a[4:7], v[68:71], v[120:135]
    s_add_u32 s33, s55, 4096
    buffer_load_dwordx4 a[0:3], v2, s[8:11], s33 offen offset:3072
    ds_read_b128 v[64:67], v2 offset:22528
    ds_read_b128 v[68:71], v2 offset:55296
    s_waitcnt lgkmcnt(10)
    v_mfma_f32_32x32x16_bf16 v[104:119], a[8:11], v[72:75], v[104:119]
    v_mfma_f32_32x32x16_bf16 v[120:135], a[8:11], v[76:79], v[120:135]
    s_add_u32 s33, s54, 8192
    buffer_load_dwordx4 a[4:7], v2, s[8:11], s33 offen offset:0
    ds_read_b128 v[72:75], v2 offset:23552
    ds_read_b128 v[76:79], v2 offset:56320
    s_waitcnt lgkmcnt(10)
    v_mfma_f32_32x32x16_bf16 v[104:119], a[12:15], v[32:35], v[104:119]
    v_mfma_f32_32x32x16_bf16 v[120:135], a[12:15], v[36:39], v[120:135]
    s_add_u32 s33, s55, 8192
    buffer_load_dwordx4 a[8:11], v2, s[8:11], s33 offen offset:0
    ds_read_b128 v[32:35], v2 offset:24576
    ds_read_b128 v[36:39], v2 offset:57344
    s_waitcnt lgkmcnt(10)
    v_mfma_f32_32x32x16_bf16 v[104:119], a[16:19], v[40:43], v[104:119]
    v_mfma_f32_32x32x16_bf16 v[120:135], a[16:19], v[44:47], v[120:135]
    s_add_u32 s33, s54, 8192
    buffer_load_dwordx4 a[12:15], v2, s[8:11], s33 offen offset:1024
    ds_read_b128 v[40:43], v2 offset:25600
    ds_read_b128 v[44:47], v2 offset:58368
    s_waitcnt lgkmcnt(10)
    v_mfma_f32_32x32x16_bf16 v[104:119], a[20:23], v[48:51], v[104:119]
    v_mfma_f32_32x32x16_bf16 v[120:135], a[20:23], v[52:55], v[120:135]
    s_add_u32 s33, s55, 8192
    buffer_load_dwordx4 a[16:19], v2, s[8:11], s33 offen offset:1024
    ds_read_b128 v[48:51], v2 offset:26624
    ds_read_b128 v[52:55], v2 offset:59392
    s_waitcnt lgkmcnt(10)
    v_mfma_f32_32x32x16_bf16 v[104:119], a[24:27], v[56:59], v[104:119]
    v_mfma_f32_32x32x16_bf16 v[120:135], a[24:27], v[60:63], v[120:135]
    s_add_u32 s33, s54, 8192
    buffer_load_dwordx4 a[20:23], v2, s[8:11], s33 offen offset:2048
    ds_read_b128 v[56:59], v2 offset:27648
    ds_read_b128 v[60:63], v2 offset:60416
    s_waitcnt lgkmcnt(10)
    v_mfma_f32_32x32x16_bf16 v[104:119], a[28:31], v[64:67], v[104:119]
    v_mfma_f32_32x32x16_bf16 v[120:135], a[28:31], v[68:71], v[120:135]
    s_add_u32 s33, s55, 8192
    buffer_load_dwordx4 a[24:27], v2, s[8:11], s33 offen offset:2048
    ds_read_b128 v[64:67], v2 offset:28672
    ds_read_b128 v[68:71], v2 offset:61440
    s_waitcnt lgkmcnt(10)
    v_mfma_f32_32x32x16_bf16 v[104:119], v[16:19], v[72:75], v[104:119]
    v_mfma_f32_32x32x16_bf16 v[120:135], v[16:19], v[76:79], v[120:135]
    s_add_u32 s33, s54, 8192
    buffer_load_dwordx4 a[28:31], v2, s[8:11], s33 offen offset:3072
    ds_read_b128 v[72:75], v2 offset:29696
    ds_read_b128 v[76:79], v2 offset:62464
    s_waitcnt lgkmcnt(10)
    v_mfma_f32_32x32x16_bf16 v[104:119], v[20:23], v[32:35], v[104:119]
    v_mfma_f32_32x32x16_bf16 v[120:135], v[20:23], v[36:39], v[120:135]
    ds_read_b128 v[32:35], v2 offset:30720
    ds_read_b128 v[36:39], v2 offset:63488
    s_waitcnt lgkmcnt(10)
    v_mfma_f32_32x32x16_bf16 v[104:119], v[24:27], v[40:43], v[104:119]
    v_mfma_f32_32x32x16_bf16 v[120:135], v[24:27], v[44:47], v[120:135]
    ds_read_b128 v[40:43], v2 offset:31744
    ds_read_b128 v[44:47], v2 offset:64512
    s_waitcnt lgkmcnt(10)
    v_mfma_f32_32x32x16_bf16 v[104:119], v[28:31], v[48:51], v[104:119]
    v_mfma_f32_32x32x16_bf16 v[120:135], v[28:31], v[52:55], v[120:135]
    s_waitcnt lgkmcnt(8)
    v_mfma_f32_32x32x16_bf16 v[104:119], v[8:11], v[56:59], v[104:119]
    v_mfma_f32_32x32x16_bf16 v[120:135], v[8:11], v[60:63], v[120:135]
    s_waitcnt lgkmcnt(6)
    v_mfma_f32_32x32x16_bf16 v[104:119], v[12:15], v[64:67], v[104:119]
    v_mfma_f32_32x32x16_bf16 v[120:135], v[12:15], v[68:71], v[120:135]
    s_waitcnt lgkmcnt(4)
    v_mfma_f32_32x32x16_bf16 v[104:119], v[144:147], v[72:75], v[104:119]
    v_mfma_f32_32x32x16_bf16 v[120:135], v[144:147], v[76:79], v[120:135]
    s_waitcnt lgkmcnt(2)
    v_mfma_f32_32x32x16_bf16 v[104:119], v[148:151], v[32:35], v[104:119]
    v_mfma_f32_32x32x16_bf16 v[120:135], v[148:151], v[36:39], v[120:135]
    s_waitcnt lgkmcnt(0)
    v_mfma_f32_32x32x16_bf16 v[104:119], v[152:155], v[40:43], v[104:119]
    v_mfma_f32_32x32x16_bf16 v[120:135], v[152:155], v[44:47], v[120:135]
    s_branch F0_cepi
F0_cskip:
    buffer_load_dwordx4 a[36:39], v2, s[8:11], s54 offen offset:0
    buffer_load_dwordx4 a[40:43], v2, s[8:11], s55 offen offset:0
    buffer_load_dwordx4 a[44:47], v2, s[8:11], s54 offen offset:1024
    buffer_load_dwordx4 a[48:51], v2, s[8:11], s55 offen offset:1024
    buffer_load_dwordx4 a[52:55], v2, s[8:11], s54 offen offset:2048
    buffer_load_dwordx4 a[56:59], v2, s[8:11], s55 offen offset:2048
    buffer_load_dwordx4 a[60:63], v2, s[8:11], s54 offen offset:3072
    buffer_load_dwordx4 a[64:67], v2, s[8:11], s55 offen offset:3072
    s_add_u32 s33, s54, 4096
    buffer_load_dwordx4 a[68:71], v2, s[8:11], s33 offen offset:0
    s_add_u32 s33, s55, 4096
    buffer_load_dwordx4 a[72:75], v2, s[8:11], s33 offen offset:0
    s_add_u32 s33, s54, 4096
    buffer_load_dwordx4 a[76:79], v2, s[8:11], s33 offen offset:1024
    s_add_u32 s33, s55, 4096
    buffer_load_dwordx4 a[80:83], v2, s[8:11], s33 offen offset:1024
    s_add_u32 s33, s54, 4096
    buffer_load_dwordx4 a[84:87], v2, s[8:11], s33 offen offset:2048
    s_add_u32 s33, s55, 4096
    buffer_load_dwordx4 a[88:91], v2, s[8:11], s33 offen offset:2048
    s_add_u32 s33, s54, 4096
    buffer_load_dwordx4 a[92:95], v2, s[8:11], s33 offen offset:3072
    s_add_u32 s33, s55, 4096
    buffer_load_dwordx4 a[0:3], v2, s[8:11], s33 offen offset:3072
    s_add_u32 s33, s54, 8192
    buffer_load_dwordx4 a[4:7], v2, s[8:11], s33 offen offset:0
    s_add_u32 s33, s55, 8192
    buffer_load_dwordx4 a[8:11], v2, s[8:11], s33 offen offset:0
    s_add_u32 s33, s54, 8192
    buffer_load_dwordx4 a[12:15], v2, s[8:11], s33 offen offset:1024
    s_add_u32 s33, s55, 8192
    buffer_load_dwordx4 a[16:19], v2, s[8:11], s33 offen offset:1024
    s_add_u32 s33, s54, 8192
    buffer_load_dwordx4 a[20:23], v2, s[8:11], s33 offen offset:2048
    s_add_u32 s33, s55, 8192
    buffer_load_dwordx4 a[24:27], v2, s[8:11], s33 offen offset:2048
    s_add_u32 s33, s54, 8192
    buffer_load_dwordx4 a[28:31], v2, s[8:11], s33 offen offset:3072
F0_cepi:
    s_cmp_eq_u32 s3, 7
    s_cbranch_scc1 F0_cdone
    v_add_u32 v5, 65536, v2
    ds_read_b128 v[32:35], v5 offset:0
    ds_read_b128 v[36:39], v5 offset:1024
    ds_read_b128 v[40:43], v5 offset:2048
    ds_read_b128 v[44:47], v5 offset:3072
    ds_read_b128 v[48:51], v5 offset:4096
    ds_read_b128 v[52:55], v5 offset:5120
    ds_read_b128 v[56:59], v5 offset:6144
    ds_read_b128 v[60:63], v5 offset:7168
    s_waitcnt vmcnt(23) lgkmcnt(0)
    v_add_f32 v32, v32, v36
    v_add_f32 v33, v33, v37
    v_add_f32 v34, v34, v38
    v_add_f32 v35, v35, v39
    v_add_f32 v32, v32, v40
    v_add_f32 v33, v33, v41
    v_add_f32 v34, v34, v42
    v_add_f32 v35, v35, v43
    v_add_f32 v32, v32, v44
    v_add_f32 v33, v33, v45
    v_add_f32 v34, v34, v46
    v_add_f32 v35, v35, v47
    v_add_f32 v32, v32, v48
    v_add_f32 v33, v33, v49
    v_add_f32 v34, v34, v50
    v_add_f32 v35, v35, v51
    v_add_f32 v32, v32, v52
    v_add_f32 v33, v33, v53
    v_add_f32 v34, v34, v54
    v_add_f32 v35, v35, v55
    v_add_f32 v32, v32, v56
    v_add_f32 v33, v33, v57
    v_add_f32 v34, v34, v58
    v_add_f32 v35, v35, v59
    v_add_f32 v32, v32, v60
    v_add_f32 v33, v33, v61
    v_add_f32 v34, v34, v62
    v_add_f32 v35, v35, v63
    v_mov_b32 v36, v32
    s_nop 1
    v_permlane32_swap_b32 v32, v36
    s_nop 0
    v_add_f32 v32, v32, v36
    v_mov_b32 v36, v33
    s_nop 1
    v_permlane32_swap_b32 v33, v36
    s_nop 0
    v_add_f32 v33, v33, v36
    v_mov_b32 v36, v34
    s_nop 1
    v_permlane32_swap_b32 v34, v36
    s_nop 0
    v_add_f32 v34, v34, v36
    v_mov_b32 v36, v35
    s_nop 1
    v_permlane32_swap_b32 v35, v36
    s_nop 0
    v_add_f32 v35, v35, v36
    v_mul_f32 v32, 0x3b000000, v32
    v_mul_f32 v33, 0x3b000000, v33
    v_fma_f32 v33, -v32, v32, v33
    v_max_f32 v33, 0, v33
    v_add_f32 v33, 0x3727c5ac, v33
    v_rsq_f32 v8, v33
    s_nop 0
    v_mul_f32 v9, v32, v8
    v_sub_f32 v9, 0, v9
    v_mul_f32 v34, 0x3b000000, v34
    v_mul_f32 v35, 0x3b000000, v35
    v_fma_f32 v35, -v34, v34, v35
    v_max_f32 v35, 0, v35
    v_add_f32 v35, 0x3727c5ac, v35
    v_rsq_f32 v10, v35
    s_nop 0
    v_mul_f32 v11, v34, v10
    v_sub_f32 v11, 0, v11
    v_mul_f32 v40, v9, v88
    v_fma_f32 v104, v104, v8, v40
    v_mul_f32 v41, v9, v89
    v_fma_f32 v105, v105, v8, v41
    v_mul_f32 v42, v9, v90
    v_fma_f32 v106, v106, v8, v42
    v_mul_f32 v43, v9, v91
    v_fma_f32 v107, v107, v8, v43
    v_mul_f32 v44, v9, v92
    v_fma_f32 v108, v108, v8, v44
    v_mul_f32 v45, v9, v93
    v_fma_f32 v109, v109, v8, v45
    v_mul_f32 v46, v9, v94
    v_fma_f32 v110, v110, v8, v46
    v_mul_f32 v47, v9, v95
    v_fma_f32 v111, v111, v8, v47
    v_mul_f32 v48, v9, v96
    v_fma_f32 v112, v112, v8, v48
    v_mul_f32 v49, v9, v97
    v_fma_f32 v113, v113, v8, v49
    v_mul_f32 v50, v9, v98
    v_fma_f32 v114, v114, v8, v50
    v_mul_f32 v51, v9, v99
    v_fma_f32 v115, v115, v8, v51
    v_mul_f32 v52, v9, v100
    v_fma_f32 v116, v116, v8, v52
    v_mul_f32 v53, v9, v101
    v_fma_f32 v117, v117, v8, v53
    v_mul_f32 v54, v9, v102
    v_fma_f32 v118, v118, v8, v54
    v_mul_f32 v55, v9, v103
    v_fma_f32 v119, v119, v8, v55
    v_cvt_pk_bf16_f32 v16, v104, v105
    v_cvt_pk_bf16_f32 v17, v106, v107
    v_cvt_pk_bf16_f32 v18, v108, v109
    v_cvt_pk_bf16_f32 v19, v110, v111
    v_cvt_pk_bf16_f32 v20, v112, v113
    v_cvt_pk_bf16_f32 v21, v114, v115
    v_cvt_pk_bf16_f32 v22, v116, v117
    v_cvt_pk_bf16_f32 v23, v118, v119
    v_pk_max_i16 v16, v16, 0
    v_pk_max_i16 v17, v17, 0
    v_pk_max_i16 v18, v18, 0
    v_pk_max_i16 v19, v19, 0
    v_pk_max_i16 v20, v20, 0
    v_pk_max_i16 v21, v21, 0
    v_pk_max_i16 v22, v22, 0
    v_pk_max_i16 v23, v23, 0
    v_mul_f32 v40, v11, v88
    v_fma_f32 v120, v120, v10, v40
    v_mul_f32 v41, v11, v89
    v_fma_f32 v121, v121, v10, v41
    v_mul_f32 v42, v11, v90
    v_fma_f32 v122, v122, v10, v42
    v_mul_f32 v43, v11, v91
    v_fma_f32 v123, v123, v10, v43
    v_mul_f32 v44, v11, v92
    v_fma_f32 v124, v124, v10, v44
    v_mul_f32 v45, v11, v93
    v_fma_f32 v125, v125, v10, v45
    v_mul_f32 v46, v11, v94
    v_fma_f32 v126, v126, v10, v46
    v_mul_f32 v47, v11, v95
    v_fma_f32 v127, v127, v10, v47
    v_mul_f32 v48, v11, v96
    v_fma_f32 v128, v128, v10, v48
    v_mul_f32 v49, v11, v97
    v_fma_f32 v129, v129, v10, v49
    v_mul_f32 v50, v11, v98
    v_fma_f32 v130, v130, v10, v50
    v_mul_f32 v51, v11, v99
    v_fma_f32 v131, v131, v10, v51
    v_mul_f32 v52, v11, v100
    v_fma_f32 v132, v132, v10, v52
    v_mul_f32 v53, v11, v101
    v_fma_f32 v133, v133, v10, v53
    v_mul_f32 v54, v11, v102
    v_fma_f32 v134, v134, v10, v54
    v_mul_f32 v55, v11, v103
    v_fma_f32 v135, v135, v10, v55
    v_cvt_pk_bf16_f32 v24, v120, v121
    v_cvt_pk_bf16_f32 v25, v122, v123
    v_cvt_pk_bf16_f32 v26, v124, v125
    v_cvt_pk_bf16_f32 v27, v126, v127
    v_cvt_pk_bf16_f32 v28, v128, v129
    v_cvt_pk_bf16_f32 v29, v130, v131
    v_cvt_pk_bf16_f32 v30, v132, v133
    v_cvt_pk_bf16_f32 v31, v134, v135
    v_pk_max_i16 v24, v24, 0
    v_pk_max_i16 v25, v25, 0
    v_pk_max_i16 v26, v26, 0
    v_pk_max_i16 v27, v27, 0
    v_pk_max_i16 v28, v28, 0
    v_pk_max_i16 v29, v29, 0
    v_pk_max_i16 v30, v30, 0
    v_pk_max_i16 v31, v31, 0
    s_lshl_b32 s26, s4, 1
    s_mul_i32 s26, s26, 112
    s_lshl_b32 s27, s51, 1
    s_add_u32 s26, s26, s27
    s_lshl_b32 s26, s26, 10
    s_add_u32 s26, s26, 0x1000000
    s_add_u32 s27, s26, 114688
    s_cmp_lg_u32 s61, 0
    s_cbranch_scc1 HS5_f
    buffer_store_dwordx4 v[16:19], v2, s[8:11], s26 offen sc0 sc1
    buffer_store_dwordx4 v[20:23], v2, s[8:11], s26 offen offset:1024 sc0 sc1
    buffer_store_dwordx4 v[24:27], v2, s[8:11], s27 offen sc0 sc1
    buffer_store_dwordx4 v[28:31], v2, s[8:11], s27 offen offset:1024 sc0 sc1
    s_branch HS5_e
HS5_f:
    buffer_store_dwordx4 v[16:19], v2, s[8:11], s26 offen
    buffer_store_dwordx4 v[20:23], v2, s[8:11], s26 offen offset:1024
    buffer_store_dwordx4 v[24:27], v2, s[8:11], s27 offen
    buffer_store_dwordx4 v[28:31], v2, s[8:11], s27 offen offset:1024
HS5_e:
F0_cdone:
    s_waitcnt vmcnt(0)
    s_barrier
    s_cmp_lg_u32 s3, 0
    s_cbranch_scc1 F0_p3_np
    v_mov_b32 v5, 3
    v_mov_b32 v6, 0
    v_cmp_eq_u32 vcc, 0, v1
    s_and_saveexec_b64 s[38:39], vcc
    s_cmp_lg_u32 s61, 0
    s_cbranch_scc1 HS6_f
    buffer_store_dword v5, v6, s[8:11], s40 offen sc0 sc1
    s_branch HS6_e
HS6_f:
    buffer_store_dword v5, v6, s[8:11], s40 offen
HS6_e:
    s_mov_b64 exec, s[38:39]
F0_p3_np:
    s_lshl_b32 s20, s4, 1
    s_mul_i32 s20, s20, 112
    s_mul_i32 s21, s3, 14
    s_add_u32 s20, s20, s21
    s_lshl_b32 s20, s20, 10
    s_add_u32 s20, s20, 0x1000000
    s_add_u32 s21, s20, 114688
    v_mov_b32 v6, 0
    s_mov_b32 s37, 0
F0_w3_poll:
    buffer_load_dword v5, v6, s[8:11], s41 offen sc0 sc1
    s_waitcnt vmcnt(0)
    v_readfirstlane_b32 s36, v5
    s_add_u32 s37, s37, 1
    s_cmp_ge_u32 s36, 3
    s_cbranch_scc1 F0_w3_go
    s_cmp_gt_u32 s37, 200000
    s_cbranch_scc1 F0_w3_go
    s_sleep 1
    s_branch F0_w3_poll
F0_w3_go:
    buffer_load_dwordx4 v[8:11], v2, s[8:11], s20 offen offset:0 sc1
    buffer_load_dwordx4 v[12:15], v2, s[8:11], s21 offen offset:0 sc1
    buffer_load_dwordx4 v[16:19], v2, s[8:11], s20 offen offset:1024 sc1
    buffer_load_dwordx4 v[20:23], v2, s[8:11], s21 offen offset:1024 sc1
    buffer_load_dwordx4 v[24:27], v2, s[8:11], s20 offen offset:2048 sc1
    buffer_load_dwordx4 v[28:31], v2, s[8:11], s21 offen offset:2048 sc1
    buffer_load_dwordx4 v[32:35], v2, s[8:11], s20 offen offset:3072 sc1
    buffer_load_dwordx4 v[36:39], v2, s[8:11], s21 offen offset:3072 sc1
    s_add_u32 s33, s20, 4096
    buffer_load_dwordx4 v[40:43], v2, s[8:11], s33 offen offset:0 sc1
    s_add_u32 s33, s21, 4096
    buffer_load_dwordx4 v[44:47], v2, s[8:11], s33 offen offset:0 sc1
    s_add_u32 s33, s20, 4096
    buffer_load_dwordx4 v[48:51], v2, s[8:11], s33 offen offset:1024 sc1
    s_add_u32 s33, s21, 4096
    buffer_load_dwordx4 v[52:55], v2, s[8:11], s33 offen offset:1024 sc1
    s_add_u32 s33, s20, 4096
    buffer_load_dwordx4 v[56:59], v2, s[8:11], s33 offen offset:2048 sc1
    s_add_u32 s33, s21, 4096
    buffer_load_dwordx4 v[60:63], v2, s[8:11], s33 offen offset:2048 sc1
    s_add_u32 s33, s20, 4096
    buffer_load_dwordx4 v[64:67], v2, s[8:11], s33 offen offset:3072 sc1
    s_add_u32 s33, s21, 4096
    buffer_load_dwordx4 v[68:71], v2, s[8:11], s33 offen offset:3072 sc1
    s_add_u32 s48, s48, 0xfff80000
    s_add_u32 s49, s48, 32768
    s_lshl_b32 s56, s3, 12
    s_add_u32 s56, s56, 0x480000
    v_lshlrev_b32 v156, 4, v4
    v_lshlrev_b32 v157, 2, v3
    s_lshl_b32 s57, s46, 7
    s_lshl_b32 s33, s47, 6
    s_add_u32 s57, s57, s33
    s_add_u32 s57, s57, 0x488000
    s_mov_b32 s58, 0x48a400
    s_add_u32 s33, s55, 8192
    buffer_load_dwordx4 v[136:139], v2, s[8:11], s33 offen offset:3072
    s_add_u32 s33, s54, 12288
    buffer_load_dwordx4 v[140:143], v2, s[8:11], s33 offen offset:0
    s_add_u32 s33, s55, 12288
    buffer_load_dwordx4 v[144:147], v2, s[8:11], s33 offen offset:0
    s_add_u32 s33, s54, 12288
    buffer_load_dwordx4 v[148:151], v2, s[8:11], s33 offen offset:1024
    s_add_u32 s33, s55, 12288
    buffer_load_dwordx4 v[152:155], v2, s[8:11], s33 offen offset:1024
    s_waitcnt vmcnt(19)
    v_mfma_f32_32x32x16_bf16 v[72:87], a[36:39], v[8:11], 0
    v_mfma_f32_32x32x16_bf16 v[88:103], a[36:39], v[12:15], 0
    v_mfma_f32_32x32x16_bf16 v[104:119], a[40:43], v[8:11], 0
    v_mfma_f32_32x32x16_bf16 v[120:135], a[40:43], v[12:15], 0
    s_add_u32 s33, s20, 8192
    buffer_load_dwordx4 v[8:11], v2, s[8:11], s33 offen offset:0 sc1
    s_add_u32 s33, s21, 8192
    buffer_load_dwordx4 v[12:15], v2, s[8:11], s33 offen offset:0 sc1
    s_waitcnt vmcnt(19)
    v_mfma_f32_32x32x16_bf16 v[72:87], a[44:47], v[16:19], v[72:87]
    v_mfma_f32_32x32x16_bf16 v[88:103], a[44:47], v[20:23], v[88:103]
    v_mfma_f32_32x32x16_bf16 v[104:119], a[48:51], v[16:19], v[104:119]
    v_mfma_f32_32x32x16_bf16 v[120:135], a[48:51], v[20:23], v[120:135]
    s_add_u32 s33, s20, 8192
    buffer_load_dwordx4 v[16:19], v2, s[8:11], s33 offen offset:1024 sc1
    s_add_u32 s33, s21, 8192
    buffer_load_dwordx4 v[20:23], v2, s[8:11], s33 offen offset:1024 sc1
    s_waitcnt vmcnt(19)
    v_mfma_f32_32x32x16_bf16 v[72:87], a[52:55], v[24:27], v[72:87]
    v_mfma_f32_32x32x16_bf16 v[88:103], a[52:55], v[28:31], v[88:103]
    v_mfma_f32_32x32x16_bf16 v[104:119], a[56:59], v[24:27], v[104:119]
    v_mfma_f32_32x32x16_bf16 v[120:135], a[56:59], v[28:31], v[120:135]
    s_add_u32 s33, s20, 8192
    buffer_load_dwordx4 v[24:27], v2, s[8:11], s33 offen offset:2048 sc1
    s_add_u32 s33, s21, 8192
    buffer_load_dwordx4 v[28:31], v2, s[8:11], s33 offen offset:2048 sc1
    s_waitcnt vmcnt(19)
    v_mfma_f32_32x32x16_bf16 v[72:87], a[60:63], v[32:35], v[72:87]
    v_mfma_f32_32x32x16_bf16 v[88:103], a[60:63], v[36:39], v[88:103]
    v_mfma_f32_32x32x16_bf16 v[104:119], a[64:67], v[32:35], v[104:119]
    v_mfma_f32_32x32x16_bf16 v[120:135], a[64:67], v[36:39], v[120:135]
    s_add_u32 s33, s20, 8192
    buffer_load_dwordx4 v[32:35], v2, s[8:11], s33 offen offset:3072 sc1
    s_add_u32 s33, s21, 8192
    buffer_load_dwordx4 v[36:39], v2, s[8:11], s33 offen offset:3072 sc1
    s_waitcnt vmcnt(19)
    v_mfma_f32_32x32x16_bf16 v[72:87], a[68:71], v[40:43], v[72:87]
    v_mfma_f32_32x32x16_bf16 v[88:103], a[68:71], v[44:47], v[88:103]
    v_mfma_f32_32x32x16_bf16 v[104:119], a[72:75], v[40:43], v[104:119]
    v_mfma_f32_32x32x16_bf16 v[120:135], a[72:75], v[44:47], v[120:135]
    s_add_u32 s33, s20, 12288
    buffer_load_dwordx4 v[40:43], v2, s[8:11], s33 offen offset:0 sc1
    s_add_u32 s33, s21, 12288
    buffer_load_dwordx4 v[44:47], v2, s[8:11], s33 offen offset:0 sc1
    s_waitcnt vmcnt(19)
    v_mfma_f32_32x32x16_bf16 v[72:87], a[76:79], v[48:51], v[72:87]
    v_mfma_f32_32x32x16_bf16 v[88:103], a[76:79], v[52:55], v[88:103]
    v_mfma_f32_32x32x16_bf16 v[104:119], a[80:83], v[48:51], v[104:119]
    v_mfma_f32_32x32x16_bf16 v[120:135], a[80:83], v[52:55], v[120:135]
    s_add_u32 s33, s20, 12288
    buffer_load_dwordx4 v[48:51], v2, s[8:11], s33 offen offset:1024 sc1
    s_add_u32 s33, s21, 12288
    buffer_load_dwordx4 v[52:55], v2, s[8:11], s33 offen offset:1024 sc1
    s_waitcnt vmcnt(19)
    v_mfma_f32_32x32x16_bf16 v[72:87], a[84:87], v[56:59], v[72:87]
    v_mfma_f32_32x32x16_bf16 v[88:103], a[84:87], v[60:63], v[88:103]
    v_mfma_f32_32x32x16_bf16 v[104:119], a[88:91], v[56:59], v[104:119]
    v_mfma_f32_32x32x16_bf16 v[120:135], a[88:91], v[60:63], v[120:135]
    buffer_load_dwordx4 a[36:39], v2, s[8:11], s48 offen offset:0
    buffer_load_dwordx4 a[40:43], v2, s[8:11], s49 offen offset:0
    buffer_load_dwordx4 a[44:47], v2, s[8:11], s48 offen offset:1024
    s_waitcnt vmcnt(20)
    v_mfma_f32_32x32x16_bf16 v[72:87], a[92:95], v[64:67], v[72:87]
    v_mfma_f32_32x32x16_bf16 v[88:103], a[92:95], v[68:71], v[88:103]
    v_mfma_f32_32x32x16_bf16 v[104:119], a[0:3], v[64:67], v[104:119]
    v_mfma_f32_32x32x16_bf16 v[120:135], a[0:3], v[68:71], v[120:135]
    buffer_load_dwordx4 a[48:51], v2, s[8:11], s49 offen offset:1024
    buffer_load_dwordx4 a[52:55], v2, s[8:11], s48 offen offset:2048
    buffer_load_dwordx4 a[56:59], v2, s[8:11], s49 offen offset:2048
    s_waitcnt vmcnt(16)
    v_mfma_f32_32x32x16_bf16 v[72:87], a[4:7], v[8:11], v[72:87]
    v_mfma_f32_32x32x16_bf16 v[88:103], a[4:7], v[12:15], v[88:103]
    v_mfma_f32_32x32x16_bf16 v[104:119], a[8:11], v[8:11], v[104:119]
    v_mfma_f32_32x32x16_bf16 v[120:135], a[8:11], v[12:15], v[120:135]
    buffer_load_dwordx4 a[60:63], v2, s[8:11], s48 offen offset:3072
    buffer_load_dwordx4 a[64:67], v2, s[8:11], s49 offen offset:3072
    buffer_load_dwordx4 a[68:71], v2, s[8:11], s56 offen offset:0
    s_waitcnt vmcnt(17)
    v_mfma_f32_32x32x16_bf16 v[72:87], a[12:15], v[16:19], v[72:87]
    v_mfma_f32_32x32x16_bf16 v[88:103], a[12:15], v[20:23], v[88:103]
    v_mfma_f32_32x32x16_bf16 v[104:119], a[16:19], v[16:19], v[104:119]
    v_mfma_f32_32x32x16_bf16 v[120:135], a[16:19], v[20:23], v[120:135]
    buffer_load_dwordx4 a[72:75], v2, s[8:11], s56 offen offset:1024
    buffer_load_dwordx4 a[76:79], v2, s[8:11], s56 offen offset:2048
    buffer_load_dwordx4 a[80:83], v2, s[8:11], s56 offen offset:3072
    s_waitcnt vmcnt(18)
    v_mfma_f32_32x32x16_bf16 v[72:87], a[20:23], v[24:27], v[72:87]
    v_mfma_f32_32x32x16_bf16 v[88:103], a[20:23], v[28:31], v[88:103]
    v_mfma_f32_32x32x16_bf16 v[104:119], a[24:27], v[24:27], v[104:119]
    v_mfma_f32_32x32x16_bf16 v[120:135], a[24:27], v[28:31], v[120:135]
    buffer_load_dwordx4 a[84:87], v156, s[8:11], s57 offen offset:0
    buffer_load_dwordx4 a[88:91], v156, s[8:11], s57 offen offset:32
    buffer_load_dwordx4 a[92:95], v156, s[8:11], s58 offen offset:0
    s_waitcnt vmcnt(19)
    v_mfma_f32_32x32x16_bf16 v[72:87], a[28:31], v[32:35], v[72:87]
    v_mfma_f32_32x32x16_bf16 v[88:103], a[28:31], v[36:39], v[88:103]
    v_mfma_f32_32x32x16_bf16 v[104:119], v[136:139], v[32:35], v[104:119]
    v_mfma_f32_32x32x16_bf16 v[120:135], v[136:139], v[36:39], v[120:135]
    buffer_load_dwordx4 a[0:3], v156, s[8:11], s58 offen offset:32
    buffer_load_dword a4, v157, s[8:11], s58 offen
    s_waitcnt vmcnt(19)
    v_mfma_f32_32x32x16_bf16 v[72:87], v[140:143], v[40:43], v[72:87]
    v_mfma_f32_32x32x16_bf16 v[88:103], v[140:143], v[44:47], v[88:103]
    v_mfma_f32_32x32x16_bf16 v[104:119], v[144:147], v[40:43], v[104:119]
    v_mfma_f32_32x32x16_bf16 v[120:135], v[144:147], v[44:47], v[120:135]
    s_waitcnt vmcnt(17)
    v_mfma_f32_32x32x16_bf16 v[72:87], v[148:151], v[48:51], v[72:87]
    v_mfma_f32_32x32x16_bf16 v[88:103], v[148:151], v[52:55], v[88:103]
    v_mfma_f32_32x32x16_bf16 v[104:119], v[152:155], v[48:51], v[104:119]
    v_mfma_f32_32x32x16_bf16 v[120:135], v[152:155], v[52:55], v[120:135]
    s_lshl_b32 s32, s3, 11
    v_add_u32 v5, s32, v2
    v_add_u32 v6, 0x10000, v5
    s_lshl_b32 s32, s3, 14
    v_add_u32 v7, s32, v2
    s_nop 11
    ds_write_b128 v5, v[72:75] offset:0
    ds_write_b128 v5, v[76:79] offset:1024
    ds_write_b128 v5, v[80:83] offset:16384
    ds_write_b128 v5, v[84:87] offset:17408
    ds_write_b128 v5, v[88:91] offset:32768
    ds_write_b128 v5, v[92:95] offset:33792
    ds_write_b128 v5, v[96:99] offset:49152
    ds_write_b128 v5, v[100:103] offset:50176
    ds_write_b128 v6, v[104:107] offset:0
    ds_write_b128 v6, v[108:111] offset:1024
    ds_write_b128 v6, v[112:115] offset:16384
    ds_write_b128 v6, v[116:119] offset:17408
    ds_write_b128 v6, v[120:123] offset:32768
    ds_write_b128 v6, v[124:127] offset:33792
    ds_write_b128 v6, v[128:131] offset:49152
    ds_write_b128 v6, v[132:135] offset:50176
    s_waitcnt lgkmcnt(0)
    s_barrier
    ds_read_b128 v[72:75], v7 offset:0
    ds_read_b128 v[76:79], v7 offset:1024
    ds_read_b128 v[80:83], v7 offset:2048
    ds_read_b128 v[84:87], v7 offset:3072
    ds_read_b128 v[88:91], v7 offset:4096
    ds_read_b128 v[92:95], v7 offset:5120
    ds_read_b128 v[96:99], v7 offset:6144
    ds_read_b128 v[100:103], v7 offset:7168
    ds_read_b128 v[104:107], v7 offset:8192
    ds_read_b128 v[108:111], v7 offset:9216
    ds_read_b128 v[112:115], v7 offset:10240
    ds_read_b128 v[116:119], v7 offset:11264
    ds_read_b128 v[120:123], v7 offset:12288
    ds_read_b128 v[124:127], v7 offset:13312
    ds_read_b128 v[128:131], v7 offset:14336
    ds_read_b128 v[132:135], v7 offset:15360
    s_waitcnt lgkmcnt(12)
    v_add_f32 v8, v72, v80
    v_add_f32 v9, v73, v81
    v_add_f32 v10, v74, v82
    v_add_f32 v11, v75, v83
    v_add_f32 v12, v76, v84
    v_add_f32 v13, v77, v85
    v_add_f32 v14, v78, v86
    v_add_f32 v15, v79, v87
    s_waitcnt lgkmcnt(8)
    v_add_f32 v88, v88, v96
    v_add_f32 v8, v8, v88
    v_add_f32 v89, v89, v97
    v_add_f32 v9, v9, v89
    v_add_f32 v90, v90, v98
    v_add_f32 v10, v10, v90
    v_add_f32 v91, v91, v99
    v_add_f32 v11, v11, v91
    v_add_f32 v92, v92, v100
    v_add_f32 v12, v12, v92
    v_add_f32 v93, v93, v101
    v_add_f32 v13, v13, v93
    v_add_f32 v94, v94, v102
    v_add_f32 v14, v14, v94
    v_add_f32 v95, v95, v103
    v_add_f32 v15, v15, v95
    s_waitcnt lgkmcnt(4)
    v_add_f32 v104, v104, v112
    v_add_f32 v8, v8, v104
    v_add_f32 v105, v105, v113
    v_add_f32 v9, v9, v105
    v_add_f32 v106, v106, v114
    v_add_f32 v10, v10, v106
    v_add_f32 v107, v107, v115
    v_add_f32 v11, v11, v107
    v_add_f32 v108, v108, v116
    v_add_f32 v12, v12, v108
    v_add_f32 v109, v109, v117
    v_add_f32 v13, v13, v109
    v_add_f32 v110, v110, v118
    v_add_f32 v14, v14, v110
    v_add_f32 v111, v111, v119
    v_add_f32 v15, v15, v111
    s_waitcnt lgkmcnt(0)
    v_add_f32 v120, v120, v128
    v_add_f32 v8, v8, v120
    v_add_f32 v121, v121, v129
    v_add_f32 v9, v9, v121
    v_add_f32 v122, v122, v130
    v_add_f32 v10, v10, v122
    v_add_f32 v123, v123, v131
    v_add_f32 v11, v11, v123
    v_add_f32 v124, v124, v132
    v_add_f32 v12, v12, v124
    v_add_f32 v125, v125, v133
    v_add_f32 v13, v13, v125
    v_add_f32 v126, v126, v134
    v_add_f32 v14, v14, v126
    v_add_f32 v127, v127, v135
    v_add_f32 v15, v15, v127
    v_accvgpr_read_b32 v16, a32
    v_accvgpr_read_b32 v17, a33
    v_accvgpr_read_b32 v18, a34
    v_accvgpr_read_b32 v19, a35
    v_lshlrev_b32 v20, 16, v16
    v_and_b32 v21, 0xffff0000, v16
    v_add_f32 v8, v8, v20
    v_add_f32 v9, v9, v21
    v_lshlrev_b32 v20, 16, v17
    v_and_b32 v21, 0xffff0000, v17
    v_add_f32 v10, v10, v20
    v_add_f32 v11, v11, v21
    v_lshlrev_b32 v20, 16, v18
    v_and_b32 v21, 0xffff0000, v18
    v_add_f32 v12, v12, v20
    v_add_f32 v13, v13, v21
    v_lshlrev_b32 v20, 16, v19
    v_and_b32 v21, 0xffff0000, v19
    v_add_f32 v14, v14, v20
    v_add_f32 v15, v15, v21
    v_cvt_pk_bf16_f32 v16, v8, v9
    v_cvt_pk_bf16_f32 v17, v10, v11
    v_cvt_pk_bf16_f32 v18, v12, v13
    v_cvt_pk_bf16_f32 v19, v14, v15
    s_add_u32 s23, s42, 0x2500000
    s_cmp_lg_u32 s61, 0
    s_cbranch_scc1 HS7_f
    buffer_store_dwordx4 v[16:19], v2, s[8:11], s23 offen sc0 sc1
    s_branch HS7_e
HS7_f:
    buffer_store_dwordx4 v[16:19], v2, s[8:11], s23 offen
HS7_e:
    s_waitcnt vmcnt(0)
    s_barrier
    s_cmp_lg_u32 s3, 0
    s_cbranch_scc1 F0_p4_np
    v_mov_b32 v5, 4
    v_mov_b32 v6, 0
    v_cmp_eq_u32 vcc, 0, v1
    s_and_saveexec_b64 s[38:39], vcc
    s_cmp_lg_u32 s61, 0
    s_cbranch_scc1 HS8_f
    buffer_store_dword v5, v6, s[8:11], s40 offen sc0 sc1
    s_branch HS8_e
HS8_f:
    buffer_store_dword v5, v6, s[8:11], s40 offen
HS8_e:
    s_mov_b64 exec, s[38:39]
F0_p4_np:
    s_add_u32 s20, s53, 0x2500000
    s_add_u32 s21, s20, 32768
    s_mov_b32 s28, 0x3f803f80
    v_mov_b32 v6, 0
    s_mov_b32 s37, 0
F0_w4_poll:
    buffer_load_dword v5, v6, s[8:11], s41 offen sc0 sc1
    s_waitcnt vmcnt(0)
    v_readfirstlane_b32 s36, v5
    s_add_u32 s37, s37, 1
    s_cmp_ge_u32 s36, 4
    s_cbranch_scc1 F0_w4_go
    s_cmp_gt_u32 s37, 200000
    s_cbranch_scc1 F0_w4_go
    s_sleep 1
    s_branch F0_w4_poll
F0_w4_go:
    buffer_load_dwordx4 v[8:11], v2, s[8:11], s20 offen offset:0 sc1
    buffer_load_dwordx4 v[12:15], v2, s[8:11], s21 offen offset:0 sc1
    buffer_load_dwordx4 v[16:19], v2, s[8:11], s20 offen offset:1024 sc1
    buffer_load_dwordx4 v[20:23], v2, s[8:11], s21 offen offset:1024 sc1
    buffer_load_dwordx4 v[24:27], v2, s[8:11], s20 offen offset:2048 sc1
    buffer_load_dwordx4 v[28:31], v2, s[8:11], s21 offen offset:2048 sc1
    buffer_load_dwordx4 v[32:35], v2, s[8:11], s20 offen offset:3072 sc1
    buffer_load_dwordx4 v[36:39], v2, s[8:11], s21 offen offset:3072 sc1
    v_mov_b32 v40, 0
    v_mov_b32 v41, 0
    v_mov_b32 v42, 0
    v_mov_b32 v43, 0
    v_mov_b32 v44, 0
    v_mov_b32 v45, 0
    v_mov_b32 v46, 0
    v_mov_b32 v47, 0
    s_waitcnt vmcnt(6)
    v_mfma_f32_32x32x16_bf16 v[64:79], a[36:39], v[8:11], 0
    v_dot2_f32_bf16 v40, v8, s28, v40
    v_dot2_f32_bf16 v44, v9, s28, v44
    v_dot2_f32_bf16 v40, v10, s28, v40
    v_dot2_f32_bf16 v44, v11, s28, v44
    v_mfma_f32_32x32x16_bf16 v[80:95], a[36:39], v[12:15], 0
    v_dot2_f32_bf16 v42, v12, s28, v42
    v_dot2_f32_bf16 v46, v13, s28, v46
    v_dot2_f32_bf16 v42, v14, s28, v42
    v_dot2_f32_bf16 v46, v15, s28, v46
    v_mfma_f32_32x32x16_bf16 v[96:111], a[40:43], v[8:11], 0
    v_dot2_f32_bf16 v41, v8, v8, v41
    v_dot2_f32_bf16 v45, v9, v9, v45
    v_dot2_f32_bf16 v41, v10, v10, v41
    v_dot2_f32_bf16 v45, v11, v11, v45
    v_mfma_f32_32x32x16_bf16 v[112:127], a[40:43], v[12:15], 0
    v_dot2_f32_bf16 v43, v12, v12, v43
    v_dot2_f32_bf16 v47, v13, v13, v47
    v_dot2_f32_bf16 v43, v14, v14, v43
    v_dot2_f32_bf16 v47, v15, v15, v47
    s_waitcnt vmcnt(4)
    v_mfma_f32_32x32x16_bf16 v[64:79], a[44:47], v[16:19], v[64:79]
    v_dot2_f32_bf16 v40, v16, s28, v40
    v_dot2_f32_bf16 v44, v17, s28, v44
    v_dot2_f32_bf16 v40, v18, s28, v40
    v_dot2_f32_bf16 v44, v19, s28, v44
    v_mfma_f32_32x32x16_bf16 v[80:95], a[44:47], v[20:23], v[80:95]
    v_dot2_f32_bf16 v42, v20, s28, v42
    v_dot2_f32_bf16 v46, v21, s28, v46
    v_dot2_f32_bf16 v42, v22, s28, v42
    v_dot2_f32_bf16 v46, v23, s28, v46
    v_mfma_f32_32x32x16_bf16 v[96:111], a[48:51], v[16:19], v[96:111]
    v_dot2_f32_bf16 v41, v16, v16, v41
    v_dot2_f32_bf16 v45, v17, v17, v45
    v_dot2_f32_bf16 v41, v18, v18, v41
    v_dot2_f32_bf16 v45, v19, v19, v45
    v_mfma_f32_32x32x16_bf16 v[112:127], a[48:51], v[20:23], v[112:127]
    v_dot2_f32_bf16 v43, v20, v20, v43
    v_dot2_f32_bf16 v47, v21, v21, v47
    v_dot2_f32_bf16 v43, v22, v22, v43
    v_dot2_f32_bf16 v47, v23, v23, v47
    s_waitcnt vmcnt(2)
    v_mfma_f32_32x32x16_bf16 v[64:79], a[52:55], v[24:27], v[64:79]
    v_dot2_f32_bf16 v40, v24, s28, v40
    v_dot2_f32_bf16 v44, v25, s28, v44
    v_dot2_f32_bf16 v40, v26, s28, v40
    v_dot2_f32_bf16 v44, v27, s28, v44
    v_mfma_f32_32x32x16_bf16 v[80:95], a[52:55], v[28:31], v[80:95]
    v_dot2_f32_bf16 v42, v28, s28, v42
    v_dot2_f32_bf16 v46, v29, s28, v46
    v_dot2_f32_bf16 v42, v30, s28, v42
    v_dot2_f32_bf16 v46, v31, s28, v46
    v_mfma_f32_32x32x16_bf16 v[96:111], a[56:59], v[24:27], v[96:111]
    v_dot2_f32_bf16 v41, v24, v24, v41
    v_dot2_f32_bf16 v45, v25, v25, v45
    v_dot2_f32_bf16 v41, v26, v26, v41
    v_dot2_f32_bf16 v45, v27, v27, v45
    v_mfma_f32_32x32x16_bf16 v[112:127], a[56:59], v[28:31], v[112:127]
    v_dot2_f32_bf16 v43, v28, v28, v43
    v_dot2_f32_bf16 v47, v29, v29, v47
    v_dot2_f32_bf16 v43, v30, v30, v43
    v_dot2_f32_bf16 v47, v31, v31, v47
    s_waitcnt vmcnt(0)
    v_mfma_f32_32x32x16_bf16 v[64:79], a[60:63], v[32:35], v[64:79]
    v_dot2_f32_bf16 v40, v32, s28, v40
    v_dot2_f32_bf16 v44, v33, s28, v44
    v_dot2_f32_bf16 v40, v34, s28, v40
    v_dot2_f32_bf16 v44, v35, s28, v44
    v_mfma_f32_32x32x16_bf16 v[80:95], a[60:63], v[36:39], v[80:95]
    v_dot2_f32_bf16 v42, v36, s28, v42
    v_dot2_f32_bf16 v46, v37, s28, v46
    v_dot2_f32_bf16 v42, v38, s28, v42
    v_dot2_f32_bf16 v46, v39, s28, v46
    v_mfma_f32_32x32x16_bf16 v[96:111], a[64:67], v[32:35], v[96:111]
    v_dot2_f32_bf16 v41, v32, v32, v41
    v_dot2_f32_bf16 v45, v33, v33, v45
    v_dot2_f32_bf16 v41, v34, v34, v41
    v_dot2_f32_bf16 v45, v35, v35, v45
    v_mfma_f32_32x32x16_bf16 v[112:127], a[64:67], v[36:39], v[112:127]
    v_dot2_f32_bf16 v43, v36, v36, v43
    v_dot2_f32_bf16 v47, v37, v37, v47
    v_dot2_f32_bf16 v43, v38, v38, v43
    v_dot2_f32_bf16 v47, v39, v39, v47
    s_lshl_b32 s32, s3, 11
    s_add_u32 s32, s32, 139264
    v_add_u32 v7, s32, v2
    s_cmp_ge_u32 s5, 6
    s_cbranch_scc1 F0_kvdone
    s_cmp_lg_u32 s5, 0
    s_cbranch_scc1 F0_kvt1
    v_mfma_f32_32x32x16_bf16 v[128:143], a[68:71], v[8:11], 0
    v_mfma_f32_32x32x16_bf16 v[128:143], a[72:75], v[16:19], v[128:143]
    v_mfma_f32_32x32x16_bf16 v[128:143], a[76:79], v[24:27], v[128:143]
    v_mfma_f32_32x32x16_bf16 v[128:143], a[80:83], v[32:35], v[128:143]
    s_nop 15
    ds_write_b128 v7, v[128:131]
    ds_write_b128 v7, v[132:135] offset:1024
    s_branch F0_kvdone
F0_kvt1:
    s_cmp_lg_u32 s5, 1
    s_cbranch_scc1 F0_kvt2
    v_mfma_f32_32x32x16_bf16 v[128:143], a[68:71], v[12:15], 0
    v_mfma_f32_32x32x16_bf16 v[128:143], a[72:75], v[20:23], v[128:143]
    v_mfma_f32_32x32x16_bf16 v[128:143], a[76:79], v[28:31], v[128:143]
    v_mfma_f32_32x32x16_bf16 v[128:143], a[80:83], v[36:39], v[128:143]
    s_nop 15
    ds_write_b128 v7, v[128:131]
    ds_write_b128 v7, v[132:135] offset:1024
    s_branch F0_kvdone
F0_kvt2:
    s_cmp_lg_u32 s5, 2
    s_cbranch_scc1 F0_kvt3
    v_mfma_f32_32x32x16_bf16 v[128:143], v[8:11], a[68:71], 0
    v_mfma_f32_32x32x16_bf16 v[128:143], v[16:19], a[72:75], v[128:143]
    v_mfma_f32_32x32x16_bf16 v[128:143], v[24:27], a[76:79], v[128:143]
    v_mfma_f32_32x32x16_bf16 v[128:143], v[32:35], a[80:83], v[128:143]
    s_nop 15
    ds_write_b128 v7, v[128:131]
    ds_write_b128 v7, v[132:135] offset:1024
    s_branch F0_kvdone
F0_kvt3:
    s_cmp_lg_u32 s5, 3
    s_cbranch_scc1 F0_kvt4
    v_mfma_f32_32x32x16_bf16 v[128:143], v[8:11], a[68:71], 0
    v_mfma_f32_32x32x16_bf16 v[128:143], v[16:19], a[72:75], v[128:143]
    v_mfma_f32_32x32x16_bf16 v[128:143], v[24:27], a[76:79], v[128:143]
    v_mfma_f32_32x32x16_bf16 v[128:143], v[32:35], a[80:83], v[128:143]
    s_nop 15
    ds_write_b128 v7, v[136:139]
    ds_write_b128 v7, v[140:143] offset:1024
    s_branch F0_kvdone
F0_kvt4:
    s_cmp_lg_u32 s5, 4
    s_cbranch_scc1 F0_kvt5
    v_mfma_f32_32x32x16_bf16 v[128:143], v[12:15], a[68:71], 0
    v_mfma_f32_32x32x16_bf16 v[128:143], v[20:23], a[72:75], v[128:143]
    v_mfma_f32_32x32x16_bf16 v[128:143], v[28:31], a[76:79], v[128:143]
    v_mfma_f32_32x32x16_bf16 v[128:143], v[36:39], a[80:83], v[128:143]
    s_nop 15
    ds_write_b128 v7, v[128:131]
    ds_write_b128 v7, v[132:135] offset:1024
    s_branch F0_kvdone
F0_kvt5:
    v_mfma_f32_32x32x16_bf16 v[128:143], v[12:15], a[68:71], 0
    v_mfma_f32_32x32x16_bf16 v[128:143], v[20:23], a[72:75], v[128:143]
    v_mfma_f32_32x32x16_bf16 v[128:143], v[28:31], a[76:79], v[128:143]
    v_mfma_f32_32x32x16_bf16 v[128:143], v[36:39], a[80:83], v[128:143]
    s_nop 15
    ds_write_b128 v7, v[136:139]
    ds_write_b128 v7, v[140:143] offset:1024
F0_kvdone:
    s_lshl_b32 s32, s3, 10
    s_add_u32 s32, s32, 131072
    v_add_u32 v7, s32, v2
    v_add_f32 v40, v40, v44
    v_add_f32 v41, v41, v45
    v_add_f32 v42, v42, v46
    v_add_f32 v43, v43, v47
    ds_write_b128 v7, v[40:43]
    s_lshl_b32 s32, s3, 11
    v_add_u32 v5, s32, v2
    v_add_u32 v6, 0x10000, v5
    s_lshl_b32 s32, s3, 14
    v_add_u32 v7, s32, v2
    s_nop 11
    ds_write_b128 v5, v[64:67] offset:0
    ds_write_b128 v5, v[68:71] offset:1024
    ds_write_b128 v5, v[72:75] offset:16384
    ds_write_b128 v5, v[76:79] offset:17408
    ds_write_b128 v5, v[80:83] offset:32768
    ds_write_b128 v5, v[84:87] offset:33792
    ds_write_b128 v5, v[88:91] offset:49152
    ds_write_b128 v5, v[92:95] offset:50176
    ds_write_b128 v6, v[96:99] offset:0
    ds_write_b128 v6, v[100:103] offset:1024
    ds_write_b128 v6, v[104:107] offset:16384
    ds_write_b128 v6, v[108:111] offset:17408
    ds_write_b128 v6, v[112:115] offset:32768
    ds_write_b128 v6, v[116:119] offset:33792
    ds_write_b128 v6, v[120:123] offset:49152
    ds_write_b128 v6, v[124:127] offset:50176
    s_waitcnt lgkmcnt(0)
    s_barrier
    ds_read_b128 v[64:67], v7 offset:0
    ds_read_b128 v[68:71], v7 offset:1024
    ds_read_b128 v[72:75], v7 offset:2048
    ds_read_b128 v[76:79], v7 offset:3072
    ds_read_b128 v[80:83], v7 offset:4096
    ds_read_b128 v[84:87], v7 offset:5120
    ds_read_b128 v[88:91], v7 offset:6144
    ds_read_b128 v[92:95], v7 offset:7168
    ds_read_b128 v[96:99], v7 offset:8192
    ds_read_b128 v[100:103], v7 offset:9216
    ds_read_b128 v[104:107], v7 offset:10240
    ds_read_b128 v[108:111], v7 offset:11264
    ds_read_b128 v[112:115], v7 offset:12288
    ds_read_b128 v[116:119], v7 offset:13312
    ds_read_b128 v[120:123], v7 offset:14336
    ds_read_b128 v[124:127], v7 offset:15360
    s_waitcnt lgkmcnt(12)
    v_add_f32 v8, v64, v72
    v_add_f32 v9, v65, v73
    v_add_f32 v10, v66, v74
    v_add_f32 v11, v67, v75
    v_add_f32 v12, v68, v76
    v_add_f32 v13, v69, v77
    v_add_f32 v14, v70, v78
    v_add_f32 v15, v71, v79
    s_waitcnt lgkmcnt(8)
    v_add_f32 v80, v80, v88
    v_add_f32 v8, v8, v80
    v_add_f32 v81, v81, v89
    v_add_f32 v9, v9, v81
    v_add_f32 v82, v82, v90
    v_add_f32 v10, v10, v82
    v_add_f32 v83, v83, v91
    v_add_f32 v11, v11, v83
    v_add_f32 v84, v84, v92
    v_add_f32 v12, v12, v84
    v_add_f32 v85, v85, v93
    v_add_f32 v13, v13, v85
    v_add_f32 v86, v86, v94
    v_add_f32 v14, v14, v86
    v_add_f32 v87, v87, v95
    v_add_f32 v15, v15, v87
    s_waitcnt lgkmcnt(4)
    v_add_f32 v96, v96, v104
    v_add_f32 v8, v8, v96
    v_add_f32 v97, v97, v105
    v_add_f32 v9, v9, v97
    v_add_f32 v98, v98, v106
    v_add_f32 v10, v10, v98
    v_add_f32 v99, v99, v107
    v_add_f32 v11, v11, v99
    v_add_f32 v100, v100, v108
    v_add_f32 v12, v12, v100
    v_add_f32 v101, v101, v109
    v_add_f32 v13, v13, v101
    v_add_f32 v102, v102, v110
    v_add_f32 v14, v14, v102
    v_add_f32 v103, v103, v111
    v_add_f32 v15, v15, v103
    s_waitcnt lgkmcnt(0)
    v_add_f32 v112, v112, v120
    v_add_f32 v8, v8, v112
    v_add_f32 v113, v113, v121
    v_add_f32 v9, v9, v113
    v_add_f32 v114, v114, v122
    v_add_f32 v10, v10, v114
    v_add_f32 v115, v115, v123
    v_add_f32 v11, v11, v115
    v_add_f32 v116, v116, v124
    v_add_f32 v12, v12, v116
    v_add_f32 v117, v117, v125
    v_add_f32 v13, v13, v117
    v_add_f32 v118, v118, v126
    v_add_f32 v14, v14, v118
    v_add_f32 v119, v119, v127
    v_add_f32 v15, v15, v119
    s_lshl_b32 s32, s43, 3
    s_add_u32 s32, s32, 131072
    v_add_u32 v7, s32, v2
    ds_read_b64 v[40:41], v7 offset:0
    ds_read_b64 v[42:43], v7 offset:1024
    ds_read_b64 v[44:45], v7 offset:2048
    ds_read_b64 v[46:47], v7 offset:3072
    ds_read_b64 v[48:49], v7 offset:4096
    ds_read_b64 v[50:51], v7 offset:5120
    ds_read_b64 v[52:53], v7 offset:6144
    ds_read_b64 v[54:55], v7 offset:7168
    s_waitcnt lgkmcnt(0)
    v_add_f32 v40, v40, v42
    v_add_f32 v41, v41, v43
    v_add_f32 v40, v40, v44
    v_add_f32 v41, v41, v45
    v_add_f32 v40, v40, v46
    v_add_f32 v41, v41, v47
    v_add_f32 v40, v40, v48
    v_add_f32 v41, v41, v49
    v_add_f32 v40, v40, v50
    v_add_f32 v41, v41, v51
    v_add_f32 v40, v40, v52
    v_add_f32 v41, v41, v53
    v_add_f32 v40, v40, v54
    v_add_f32 v41, v41, v55
    v_mov_b32 v42, v40
    s_nop 1
    v_permlane32_swap_b32 v40, v42
    s_nop 0
    v_add_f32 v40, v40, v42
    v_mov_b32 v42, v41
    s_nop 1
    v_permlane32_swap_b32 v41, v42
    s_nop 0
    v_add_f32 v41, v41, v42
    v_mul_f32 v40, 0x3b000000, v40
    v_mul_f32 v41, 0x3b000000, v41
    v_fma_f32 v41, -v40, v40, v41
    v_max_f32 v41, 0, v41
    v_add_f32 v41, 0x3727c5ac, v41
    v_rsq_f32 v41, v41
    s_nop 0
    v_mul_f32 v42, v40, v41
    v_sub_f32 v42, 0, v42
    v_mul_f32 v43, 0x3eb8aa3b, v41
    v_mul_f32 v44, 0x3eb8aa3b, v42
    v_accvgpr_read_b32 v16, a84
    v_accvgpr_read_b32 v17, a85
    v_accvgpr_read_b32 v18, a86
    v_accvgpr_read_b32 v19, a87
    v_accvgpr_read_b32 v20, a88
    v_accvgpr_read_b32 v21, a89
    v_accvgpr_read_b32 v22, a90
    v_accvgpr_read_b32 v23, a91
    v_mul_f32 v16, v44, v16
    v_fma_f32 v8, v8, v43, v16
    v_mul_f32 v17, v44, v17
    v_fma_f32 v9, v9, v43, v17
    v_mul_f32 v18, v44, v18
    v_fma_f32 v10, v10, v43, v18
    v_mul_f32 v19, v44, v19
    v_fma_f32 v11, v11, v43, v19
    v_mul_f32 v20, v44, v20
    v_fma_f32 v12, v12, v43, v20
    v_mul_f32 v21, v44, v21
    v_fma_f32 v13, v13, v43, v21
    v_mul_f32 v22, v44, v22
    v_fma_f32 v14, v14, v43, v22
    v_mul_f32 v23, v44, v23
    v_fma_f32 v15, v15, v43, v23
    v_cvt_pk_bf16_f32 v24, v8, v9
    v_cvt_pk_bf16_f32 v25, v10, v11
    v_cvt_pk_bf16_f32 v26, v12, v13
    v_cvt_pk_bf16_f32 v27, v14, v15
    s_add_u32 s23, s42, 0x2700000
    buffer_store_dwordx4 v[24:27], v2, s[8:11], s23 offen
    s_cmp_ge_u32 s5, 6
    s_cbranch_scc1 f1_kernel_end
    s_lshr_b32 s32, s5, 2
    s_cmp_eq_u32 s5, 1
    s_cselect_b32 s32, 1, s32
    s_lshl_b32 s32, s32, 1
    s_cmp_lg_u32 s3, s32
    s_cbranch_scc1 f1_kernel_end
    v_add_u32 v7, 139264, v2
    ds_read_b128 v[64:67], v7 offset:0
    ds_read_b128 v[68:71], v7 offset:1024
    ds_read_b128 v[72:75], v7 offset:2048
    ds_read_b128 v[76:79], v7 offset:3072
    ds_read_b128 v[80:83], v7 offset:4096
    ds_read_b128 v[84:87], v7 offset:5120
    ds_read_b128 v[88:91], v7 offset:6144
    ds_read_b128 v[92:95], v7 offset:7168
    ds_read_b128 v[96:99], v7 offset:8192
    ds_read_b128 v[100:103], v7 offset:9216
    ds_read_b128 v[104:107], v7 offset:10240
    ds_read_b128 v[108:111], v7 offset:11264
    ds_read_b128 v[112:115], v7 offset:12288
    ds_read_b128 v[116:119], v7 offset:13312
    ds_read_b128 v[120:123], v7 offset:14336
    ds_read_b128 v[124:127], v7 offset:15360
    s_mul_i32 s33, s45, 2176
    s_add_u32 s33, s33, 0x3800000
    s_waitcnt lgkmcnt(0)
    v_add_f32 v64, v64, v72
    v_add_f32 v65, v65, v73
    v_add_f32 v66, v66, v74
    v_add_f32 v67, v67, v75
    v_add_f32 v68, v68, v76
    v_add_f32 v69, v69, v77
    v_add_f32 v70, v70, v78
    v_add_f32 v71, v71, v79
    v_add_f32 v64, v64, v80
    v_add_f32 v65, v65, v81
    v_add_f32 v66, v66, v82
    v_add_f32 v67, v67, v83
    v_add_f32 v68, v68, v84
    v_add_f32 v69, v69, v85
    v_add_f32 v70, v70, v86
    v_add_f32 v71, v71, v87
    v_add_f32 v64, v64, v88
    v_add_f32 v65, v65, v89
    v_add_f32 v66, v66, v90
    v_add_f32 v67, v67, v91
    v_add_f32 v68, v68, v92
    v_add_f32 v69, v69, v93
    v_add_f32 v70, v70, v94
    v_add_f32 v71, v71, v95
    v_add_f32 v64, v64, v96
    v_add_f32 v65, v65, v97
    v_add_f32 v66, v66, v98
    v_add_f32 v67, v67, v99
    v_add_f32 v68, v68, v100
    v_add_f32 v69, v69, v101
    v_add_f32 v70, v70, v102
    v_add_f32 v71, v71, v103
    v_add_f32 v64, v64, v104
    v_add_f32 v65, v65, v105
    v_add_f32 v66, v66, v106
    v_add_f32 v67, v67, v107
    v_add_f32 v68, v68, v108
    v_add_f32 v69, v69, v109
    v_add_f32 v70, v70, v110
    v_add_f32 v71, v71, v111
    v_add_f32 v64, v64, v112
    v_add_f32 v65, v65, v113
    v_add_f32 v66, v66, v114
    v_add_f32 v67, v67, v115
    v_add_f32 v68, v68, v116
    v_add_f32 v69, v69, v117
    v_add_f32 v70, v70, v118
    v_add_f32 v71, v71, v119
    v_add_f32 v64, v64, v120
    v_add_f32 v65, v65, v121
    v_add_f32 v66, v66, v122
    v_add_f32 v67, v67, v123
    v_add_f32 v68, v68, v124
    v_add_f32 v69, v69, v125
    v_add_f32 v70, v70, v126
    v_add_f32 v71, v71, v127
    s_cmp_ge_u32 s5, 2
    s_cbranch_scc1 F0_finV
    v_mov_b32 v45, 0
    v_accvgpr_read_b32 v16, a92
    v_accvgpr_read_b32 v17, a93
    v_accvgpr_read_b32 v18, a94
    v_accvgpr_read_b32 v19, a95
    v_accvgpr_read_b32 v20, a0
    v_accvgpr_read_b32 v21, a1
    v_accvgpr_read_b32 v22, a2
    v_accvgpr_read_b32 v23, a3
    v_mul_f32 v16, v42, v16
    v_fma_f32 v64, v64, v41, v16
    v_fma_f32 v45, v64, v64, v45
    v_mul_f32 v17, v42, v17
    v_fma_f32 v65, v65, v41, v17
    v_fma_f32 v45, v65, v65, v45
    v_mul_f32 v18, v42, v18
    v_fma_f32 v66, v66, v41, v18
    v_fma_f32 v45, v66, v66, v45
    v_mul_f32 v19, v42, v19
    v_fma_f32 v67, v67, v41, v19
    v_fma_f32 v45, v67, v67, v45
    v_mul_f32 v20, v42, v20
    v_fma_f32 v68, v68, v41, v20
    v_fma_f32 v45, v68, v68, v45
    v_mul_f32 v21, v42, v21
    v_fma_f32 v69, v69, v41, v21
    v_fma_f32 v45, v69, v69, v45
    v_mul_f32 v22, v42, v22
    v_fma_f32 v70, v70, v41, v22
    v_fma_f32 v45, v70, v70, v45
    v_mul_f32 v23, v42, v23
    v_fma_f32 v71, v71, v41, v23
    v_fma_f32 v45, v71, v71, v45
    v_cvt_pk_bf16_f32 v28, v64, v65
    v_cvt_pk_bf16_f32 v29, v66, v67
    v_cvt_pk_bf16_f32 v30, v68, v69
    v_cvt_pk_bf16_f32 v31, v70, v71
    buffer_store_dwordx4 v[28:31], v2, s[8:11], s33 offen
    v_mov_b32 v46, v45
    s_nop 1
    v_permlane32_swap_b32 v45, v46
    s_nop 0
    v_add_f32 v45, v45, v46
    s_lshl_b32 s32, s45, 7
    s_add_u32 s32, s32, 0x3880000
    v_lshlrev_b32 v46, 2, v3
    v_cmp_gt_u32 vcc, 32, v1
    s_and_saveexec_b64 s[38:39], vcc
    buffer_store_dword v45, v46, s[8:11], s32 offen
    s_branch f1_kernel_end
F0_finV:
    v_lshlrev_b32 v7, 2, v3
    v_add_u32 v7, 155648, v7
    ds_write_b32 v7, v41
    ds_write_b32 v7, v42 offset:128
    s_and_b32 s32, s5, 1
    s_lshl_b32 s32, s32, 6
    s_add_u32 s32, s32, 155648
    v_lshlrev_b32 v7, 4, v4
    v_add_u32 v7, s32, v7
    v_accvgpr_read_b32 v47, a4
    s_waitcnt lgkmcnt(0)
    ds_read_b128 v[16:19], v7 offset:0
    ds_read_b128 v[24:27], v7 offset:128
    ds_read_b128 v[20:23], v7 offset:32
    ds_read_b128 v[28:31], v7 offset:160
    s_waitcnt lgkmcnt(0)
    v_mul_f32 v24, v47, v24
    v_fma_f32 v64, v64, v16, v24
    v_mul_f32 v25, v47, v25
    v_fma_f32 v65, v65, v17, v25
    v_mul_f32 v26, v47, v26
    v_fma_f32 v66, v66, v18, v26
    v_mul_f32 v27, v47, v27
    v_fma_f32 v67, v67, v19, v27
    v_mul_f32 v28, v47, v28
    v_fma_f32 v68, v68, v20, v28
    v_mul_f32 v29, v47, v29
    v_fma_f32 v69, v69, v21, v29
    v_mul_f32 v30, v47, v30
    v_fma_f32 v70, v70, v22, v30
    v_mul_f32 v31, v47, v31
    v_fma_f32 v71, v71, v23, v31
    v_cvt_pk_bf16_f32 v32, v64, v65
    v_cvt_pk_bf16_f32 v33, v66, v67
    v_cvt_pk_bf16_f32 v34, v68, v69
    v_cvt_pk_bf16_f32 v35, v70, v71
    v_cmp_eq_u32 s[38:39], 0, v3
    v_mov_b32 v45, 0x3f803f80
    v_mov_b32 v46, 0
    v_cndmask_b32 v45, v46, v45, s[38:39]
    v_cmp_le_u32 vcc, 16, v3
    v_xor_b32 v7, 16, v3
    v_lshlrev_b32 v7, 4, v7
    v_cndmask_b32 v32, v45, v32, vcc
    v_cndmask_b32 v33, v45, v33, vcc
    v_cndmask_b32 v34, v45, v34, vcc
    v_cndmask_b32 v35, v45, v35, vcc
    v_mul_u32_u24 v46, 288, v4
    v_add_u32 v7, v7, v46
    s_and_b32 s32, s5, 1
    s_mul_i32 s32, s32, 576
    s_add_u32 s33, s33, s32
    v_cmp_gt_u32 s[38:39], 2, v3
    s_or_b64 vcc, vcc, s[38:39]
    s_and_saveexec_b64 s[38:39], vcc
    buffer_store_dwordx4 v[32:35], v7, s[8:11], s33 offen offset:1024
f1_kernel_end:
f1_kernel_endx:
    s_endpgm
.globl f2_kernel
.p2align 8
.type f2_kernel,@function
f2_kernel:
    s_cmp_ge_u32 s2, 256
    s_cbranch_scc1 f2_kernel_endx
    s_load_dwordx2 s[6:7], s[0:1], 80
    s_load_dwordx2 s[12:13], s[0:1], 64
    v_and_b32 v1, 63, v0
    v_lshrrev_b32 v2, 6, v0
    v_and_b32 v3, 31, v1
    v_readfirstlane_b32 s3, v2
    v_lshrrev_b32 v4, 5, v1
    v_lshlrev_b32 v2, 4, v1
    s_and_b32 s4, s2, 31
    s_lshr_b32 s5, s2, 5
    s_waitcnt lgkmcnt(0)
    s_mov_b32 s8, s6
    s_mov_b32 s9, s7
    s_mov_b32 s10, 0x4400000
    s_mov_b32 s11, 0x00020000
    s_mov_b32 s16, s12
    s_mov_b32 s17, s13
    s_mov_b32 s18, 0x200000
    s_mov_b32 s19, 0x00020000
    s_and_b32 s20, s3, 3
    s_lshr_b32 s30, s3, 2
    s_and_b32 s21, s20, 1
    s_lshl_b32 s21, s21, 1
    s_lshl_b32 s22, s5, 2
    s_add_u32 s21, s21, s22
    s_lshr_b32 s22, s20, 1
    s_lshl_b32 s23, s4, 1
    s_add_u32 s22, s22, s23
    s_lshl_b32 s22, s22, 5
    s_add_u32 s22, s22, s21
    s_add_u32 s23, s22, s30
    s_xor_b32 s24, s30, 1
    s_add_u32 s24, s22, s24
    s_lshl_b32 s22, s23, 10
    s_lshl_b32 s24, s24, 10
    s_add_u32 s23, s22, 0x2700000
    s_add_u32 s24, s24, 0x2700000
    buffer_load_dwordx4 v[8:11], v2, s[8:11], s23 offen
    buffer_load_dwordx4 v[12:15], v2, s[8:11], s24 offen
    s_lshl_b32 s23, s3, 10
    s_add_u32 s23, s23, 0x3880000
    buffer_load_dwordx4 v[112:115], v2, s[8:11], s23 offen
    s_lshr_b32 s24, s3, 1
    s_lshl_b32 s24, s24, 10
    s_and_b32 s25, s3, 1
    s_mul_i32 s25, s25, 69632
    s_add_u32 s34, s24, s25
    s_add_u32 s35, s34, 0x3800000
    s_mov_b32 m0, s34
    s_add_u32 s34, s34, 4096
    buffer_load_dwordx4 v2, s[8:11], s35 offen lds
    s_add_u32 s35, s35, 4096
    s_mov_b32 m0, s34
    s_add_u32 s34, s34, 4096
    buffer_load_dwordx4 v2, s[8:11], s35 offen lds
    s_add_u32 s35, s35, 4096
    s_mov_b32 m0, s34
    s_add_u32 s34, s34, 4096
    buffer_load_dwordx4 v2, s[8:11], s35 offen lds
    s_add_u32 s35, s35, 4096
    s_mov_b32 m0, s34
    s_add_u32 s34, s34, 4096
    buffer_load_dwordx4 v2, s[8:11], s35 offen lds
    s_add_u32 s35, s35, 4096
    s_mov_b32 m0, s34
    s_add_u32 s34, s34, 4096
    buffer_load_dwordx4 v2, s[8:11], s35 offen lds
    s_add_u32 s35, s35, 4096
    s_mov_b32 m0, s34
    s_add_u32 s34, s34, 4096
    buffer_load_dwordx4 v2, s[8:11], s35 offen lds
    s_add_u32 s35, s35, 4096
    s_lshl_b32 s40, s4, 8
    s_add_u32 s40, s40, 0x490000
    s_lshl_b32 s41, s3, 2
    s_add_u32 s41, s41, s40
    s_lshl_b32 s32, s5, 2
    s_add_u32 s40, s40, s32
    s_lshr_b32 s32, s3, 1
    s_and_b32 s43, s32, 1
    s_lshr_b32 s44, s3, 2
    s_lshl_b32 s45, s4, 1
    s_add_u32 s45, s45, s43
    s_lshl_b32 s46, s5, 1
    s_add_u32 s46, s46, s44
    s_lshl_b32 s42, s45, 5
    s_lshl_b32 s32, s46, 1
    s_add_u32 s42, s42, s32
    s_and_b32 s47, s3, 1
    s_add_u32 s42, s42, s47
    s_lshl_b32 s42, s42, 10
    s_getreg_b32 s61, hwreg(HW_REG_XCC_ID)
    s_and_b32 s61, s61, 15
    s_add_u32 s61, s61, 1
    v_min_u32 v6, 17, v3
    v_mov_b32 v5, 16
    v_cmp_eq_u32 vcc, 20, v3
    s_mul_i32 s25, s30, 69632
    s_nop 0
    v_cndmask_b32 v6, v6, v5, vcc
    v_lshlrev_b32 v6, 4, v6
    v_mul_u32_u24 v5, 288, v4
    v_add3_u32 v158, v6, v5, 64
    v_add_u32 v158, 960, v158
    v_add_u32 v156, s25, v2
    v_add_u32 v157, s25, v158
    s_waitcnt vmcnt(6)
    v_mov_b32 v5, 0
    v_mov_b32 v6, 0
    v_dot2_f32_bf16 v5, v8, v8, v5
    v_dot2_f32_bf16 v6, v12, v12, v6
    v_dot2_f32_bf16 v5, v9, v9, v5
    v_dot2_f32_bf16 v6, v13, v13, v6
    v_dot2_f32_bf16 v5, v10, v10, v5
    v_dot2_f32_bf16 v6, v14, v14, v6
    v_dot2_f32_bf16 v5, v11, v11, v5
    v_dot2_f32_bf16 v6, v15, v15, v6
    s_nop 2
    v_mov_b32 v154, v5
    s_nop 1
    v_permlane32_swap_b32 v5, v154
    s_nop 0
    v_add_f32 v5, v5, v154
    v_mov_b32 v154, v6
    s_nop 1
    v_permlane32_swap_b32 v6, v154
    s_nop 0
    v_add_f32 v6, v6, v154
    v_max_f32 v5, v5, v6
    v_max3_f32 v7, v112, v113, v114
    v_max_f32 v7, v7, v115
    ds_swizzle_b32 v6, v5 offset:0x41f
    ds_swizzle_b32 v154, v7 offset:0x41f
    s_waitcnt lgkmcnt(0)
    v_max_f32 v5, v5, v6
    v_max_f32 v7, v7, v154
    ds_swizzle_b32 v6, v5 offset:0x81f
    ds_swizzle_b32 v154, v7 offset:0x81f
    s_waitcnt lgkmcnt(0)
    v_max_f32 v5, v5, v6
    v_max_f32 v7, v7, v154
    ds_swizzle_b32 v6, v5 offset:0x101f
    ds_swizzle_b32 v154, v7 offset:0x101f
    s_waitcnt lgkmcnt(0)
    v_max_f32 v5, v5, v6
    v_max_f32 v7, v7, v154
    ds_swizzle_b32 v6, v5 offset:0x201f
    ds_swizzle_b32 v154, v7 offset:0x201f
    s_waitcnt lgkmcnt(0)
    v_max_f32 v5, v5, v6
    v_max_f32 v7, v7, v154
    ds_swizzle_b32 v6, v5 offset:0x401f
    ds_swizzle_b32 v154, v7 offset:0x401f
    s_waitcnt lgkmcnt(0)
    v_max_f32 v5, v5, v6
    v_max_f32 v7, v7, v154
    v_mov_b32 v154, v7
    s_nop 1
    v_permlane32_swap_b32 v7, v154
    s_nop 0
    v_max_f32 v7, v7, v154
    v_readfirstlane_b32 s63, v5
    s_lshl_b32 s23, s3, 2
    s_add_u32 s23, s23, 157696
    v_mov_b32 v6, s23
    ds_write_b32 v6, v7
    v_mov_b32 v32, 0
    v_mov_b32 v48, 0
    v_mov_b32 v112, 0
    v_mov_b32 v33, 0
    v_mov_b32 v49, 0
    v_mov_b32 v113, 0
    v_mov_b32 v34, 0
    v_mov_b32 v50, 0
    v_mov_b32 v114, 0
    v_mov_b32 v35, 0
    v_mov_b32 v51, 0
    v_mov_b32 v115, 0
    v_mov_b32 v36, 0
    v_mov_b32 v52, 0
    v_mov_b32 v116, 0
    v_mov_b32 v37, 0
    v_mov_b32 v53, 0
    v_mov_b32 v117, 0
    v_mov_b32 v38, 0
    v_mov_b32 v54, 0
    v_mov_b32 v118, 0
    v_mov_b32 v39, 0
    v_mov_b32 v55, 0
    v_mov_b32 v119, 0
    v_mov_b32 v40, 0
    v_mov_b32 v56, 0
    v_mov_b32 v120, 0
    v_mov_b32 v41, 0
    v_mov_b32 v57, 0
    v_mov_b32 v121, 0
    v_mov_b32 v42, 0
    v_mov_b32 v58, 0
    v_mov_b32 v122, 0
    v_mov_b32 v43, 0
    v_mov_b32 v59, 0
    v_mov_b32 v123, 0
    v_mov_b32 v44, 0
    v_mov_b32 v60, 0
    v_mov_b32 v124, 0
    v_mov_b32 v45, 0
    v_mov_b32 v61, 0
    v_mov_b32 v125, 0
    v_mov_b32 v46, 0
    v_mov_b32 v62, 0
    v_mov_b32 v126, 0
    v_mov_b32 v47, 0
    v_mov_b32 v63, 0
    v_mov_b32 v127, 0
    v_mov_b32 v104, 0
    v_mov_b32 v144, 0
    v_mov_b32 v105, 0
    v_mov_b32 v145, 0
    v_mov_b32 v106, 0
    v_mov_b32 v146, 0
    v_mov_b32 v107, 0
    v_mov_b32 v147, 0
    v_mov_b32 v108, 0
    v_mov_b32 v148, 0
    v_mov_b32 v109, 0
    v_mov_b32 v149, 0
    v_mov_b32 v110, 0
    v_mov_b32 v150, 0
    v_mov_b32 v111, 0
    v_mov_b32 v151, 0
    s_lshl_b32 s32, s5, 1
    s_lshl_b32 s48, s32, 5
    s_lshl_b32 s33, s3, 2
    s_add_u32 s48, s48, s33
    s_lshl_b32 s48, s48, 10
    s_add_u32 s48, s48, 0x80000
    s_add_u32 s49, s48, 32768
    s_min_u32 s32, s3, 6
    s_mul_i32 s51, s5, 7
    s_add_u32 s51, s51, s32
    s_lshl_b32 s50, s51, 15
    s_add_u32 s50, s50, 0x100000
    s_add_u32 s52, s42, 0x2500000
    s_waitcnt vmcnt(0) lgkmcnt(0)
    s_barrier
    ds_read_b128 v[128:131], v156
    ds_read_b128 v[132:135], v156 offset:2176
    ds_read_b128 v[136:139], v157
    ds_read_b128 v[140:143], v157 offset:576
    s_cmp_lt_u32 s3, 4
    s_cbranch_scc1 F1_noprio
    s_setprio 1
F1_noprio:
    s_waitcnt lgkmcnt(3)
    v_mfma_f32_32x32x16_bf16 v[64:79], v[128:131], v[8:11], 0
    s_nop 9
    s_mov_b32 s29, 0
    v_mfma_f32_32x32x16_bf16 v[80:95], v[128:131], v[12:15], 0
    v_exp_f32 v112, v64
    v_exp_f32 v113, v65
    v_cvt_pk_bf16_f32 v110, v124, v125
    v_exp_f32 v114, v66
    v_exp_f32 v115, v67
    v_cvt_pk_bf16_f32 v111, v126, v127
    s_mov_b32 m0, s34
    s_add_u32 s34, s34, 4096
    buffer_load_dwordx4 v2, s[8:11], s35 offen lds
    s_add_u32 s35, s35, 4096
    v_exp_f32 v116, v68
    v_exp_f32 v117, v69
    v_cvt_pk_bf16_f32 v96, v112, v113
    v_exp_f32 v118, v70
    v_exp_f32 v119, v71
    v_cvt_pk_bf16_f32 v97, v114, v115
    v_mfma_f32_32x32x16_bf16 v[48:63], v[144:147], v[104:107], v[48:63]
    v_exp_f32 v120, v72
    v_exp_f32 v121, v73
    v_cvt_pk_bf16_f32 v98, v116, v117
    s_mov_b32 m0, s34
    s_add_u32 s34, s34, 4096
    buffer_load_dwordx4 v2, s[8:11], s35 offen lds
    s_add_u32 s35, s35, 4096
    v_exp_f32 v122, v74
    v_exp_f32 v123, v75
    v_cvt_pk_bf16_f32 v99, v118, v119
    s_mov_b32 m0, s34
    s_add_u32 s34, s34, 4096
    buffer_load_dwordx4 v2, s[8:11], s35 offen lds
    s_add_u32 s35, s35, 4096
    v_exp_f32 v124, v76
    v_exp_f32 v125, v77
    v_cvt_pk_bf16_f32 v100, v120, v121
    v_mfma_f32_32x32x16_bf16 v[48:63], v[148:151], v[108:111], v[48:63]
    v_exp_f32 v126, v78
    v_exp_f32 v127, v79
    v_cvt_pk_bf16_f32 v101, v122, v123
    s_waitcnt lgkmcnt(0)
    v_mfma_f32_32x32x16_bf16 v[64:79], v[132:135], v[8:11], 0
    ds_read_b128 v[128:131], v156 offset:4352
    ds_read_b128 v[144:147], v157 offset:2176
    ds_read_b128 v[148:151], v157 offset:2752
    v_exp_f32 v112, v80
    v_exp_f32 v113, v81
    v_cvt_pk_bf16_f32 v102, v124, v125
    v_exp_f32 v114, v82
    v_exp_f32 v115, v83
    v_cvt_pk_bf16_f32 v103, v126, v127
    s_mov_b32 m0, s34
    s_add_u32 s34, s34, 4096
    buffer_load_dwordx4 v2, s[8:11], s35 offen lds
    s_add_u32 s35, s35, 4096
    v_exp_f32 v116, v84
    v_exp_f32 v117, v85
    v_cvt_pk_bf16_f32 v104, v112, v113
    v_exp_f32 v118, v86
    v_exp_f32 v119, v87
    v_cvt_pk_bf16_f32 v105, v114, v115
    v_mfma_f32_32x32x16_bf16 v[32:47], v[136:139], v[96:99], v[32:47]
    v_exp_f32 v120, v88
    v_exp_f32 v121, v89
    v_cvt_pk_bf16_f32 v106, v116, v117
    s_mov_b32 m0, s34
    s_add_u32 s34, s34, 4096
    buffer_load_dwordx4 v2, s[8:11], s35 offen lds
    s_add_u32 s35, s35, 4096
    v_exp_f32 v122, v90
    v_exp_f32 v123, v91
    v_cvt_pk_bf16_f32 v107, v118, v119
    s_mov_b32 m0, s34
    s_add_u32 s34, s34, 4096
    buffer_load_dwordx4 v2, s[8:11], s35 offen lds
    s_add_u32 s35, s35, 4096
    v_exp_f32 v124, v92
    v_exp_f32 v125, v93
    v_cvt_pk_bf16_f32 v108, v120, v121
    v_mfma_f32_32x32x16_bf16 v[32:47], v[140:143], v[100:103], v[32:47]
    v_exp_f32 v126, v94
    v_exp_f32 v127, v95
    v_cvt_pk_bf16_f32 v109, v122, v123
    v_mfma_f32_32x32x16_bf16 v[80:95], v[132:135], v[12:15], 0
    v_exp_f32 v112, v64
    v_exp_f32 v113, v65
    v_cvt_pk_bf16_f32 v110, v124, v125
    v_exp_f32 v114, v66
    v_exp_f32 v115, v67
    v_cvt_pk_bf16_f32 v111, v126, v127
    s_mov_b32 m0, s34
    s_add_u32 s34, s34, 4096
    buffer_load_dwordx4 v2, s[8:11], s35 offen lds
    s_add_u32 s35, s35, 4096
    v_exp_f32 v116, v68
    v_exp_f32 v117, v69
    v_cvt_pk_bf16_f32 v96, v112, v113
    v_exp_f32 v118, v70
    v_exp_f32 v119, v71
    v_cvt_pk_bf16_f32 v97, v114, v115
    v_mfma_f32_32x32x16_bf16 v[48:63], v[136:139], v[104:107], v[48:63]
    v_exp_f32 v120, v72
    v_exp_f32 v121, v73
    v_cvt_pk_bf16_f32 v98, v116, v117
    s_mov_b32 m0, s34
    s_add_u32 s34, s34, 4096
    buffer_load_dwordx4 v2, s[8:11], s35 offen lds
    s_add_u32 s35, s35, 4096
    v_exp_f32 v122, v74
    v_exp_f32 v123, v75
    v_cvt_pk_bf16_f32 v99, v118, v119
    s_mov_b32 m0, s34
    s_add_u32 s34, s34, 4096
    buffer_load_dwordx4 v2, s[8:11], s35 offen lds
    s_add_u32 s35, s35, 4096
    v_exp_f32 v124, v76
    v_exp_f32 v125, v77
    v_cvt_pk_bf16_f32 v100, v120, v121
    v_mfma_f32_32x32x16_bf16 v[48:63], v[140:143], v[108:111], v[48:63]
    v_exp_f32 v126, v78
    v_exp_f32 v127, v79
    v_cvt_pk_bf16_f32 v101, v122, v123
    s_waitcnt lgkmcnt(0)
    v_mfma_f32_32x32x16_bf16 v[64:79], v[128:131], v[8:11], 0
    ds_read_b128 v[132:135], v156 offset:6528
    ds_read_b128 v[136:139], v157 offset:4352
    ds_read_b128 v[140:143], v157 offset:4928
    v_exp_f32 v112, v80
    v_exp_f32 v113, v81
    v_cvt_pk_bf16_f32 v102, v124, v125
    v_exp_f32 v114, v82
    v_exp_f32 v115, v83
    v_cvt_pk_bf16_f32 v103, v126, v127
    s_mov_b32 m0, s34
    s_add_u32 s34, s34, 4096
    buffer_load_dwordx4 v2, s[8:11], s35 offen lds
    s_add_u32 s35, s35, 4096
    v_exp_f32 v116, v84
    v_exp_f32 v117, v85
    v_cvt_pk_bf16_f32 v104, v112, v113
    v_exp_f32 v118, v86
    v_exp_f32 v119, v87
    v_cvt_pk_bf16_f32 v105, v114, v115
    v_mfma_f32_32x32x16_bf16 v[32:47], v[144:147], v[96:99], v[32:47]
    v_exp_f32 v120, v88
    v_exp_f32 v121, v89
    v_cvt_pk_bf16_f32 v106, v116, v117
    s_mov_b32 m0, s34
    s_add_u32 s34, s34, 4096
    buffer_load_dwordx4 v2, s[8:11], s35 offen lds
    s_add_u32 s35, s35, 4096
    v_exp_f32 v122, v90
    v_exp_f32 v123, v91
    v_cvt_pk_bf16_f32 v107, v118, v119
    v_exp_f32 v124, v92
    v_exp_f32 v125, v93
    v_cvt_pk_bf16_f32 v108, v120, v121
    v_mfma_f32_32x32x16_bf16 v[32:47], v[148:151], v[100:103], v[32:47]
    v_exp_f32 v126, v94
    v_exp_f32 v127, v95
    v_cvt_pk_bf16_f32 v109, v122, v123
    v_mfma_f32_32x32x16_bf16 v[80:95], v[128:131], v[12:15], 0
    v_exp_f32 v112, v64
    v_exp_f32 v113, v65
    v_cvt_pk_bf16_f32 v110, v124, v125
    v_exp_f32 v114, v66
    v_exp_f32 v115, v67
    v_cvt_pk_bf16_f32 v111, v126, v127
    v_exp_f32 v116, v68
    v_exp_f32 v117, v69
    v_cvt_pk_bf16_f32 v96, v112, v113
    v_exp_f32 v118, v70
    v_exp_f32 v119, v71
    v_cvt_pk_bf16_f32 v97, v114, v115
    v_mfma_f32_32x32x16_bf16 v[48:63], v[144:147], v[104:107], v[48:63]
    v_exp_f32 v120, v72
    v_exp_f32 v121, v73
    v_cvt_pk_bf16_f32 v98, v116, v117
    v_exp_f32 v122, v74
    v_exp_f32 v123, v75
    v_cvt_pk_bf16_f32 v99, v118, v119
    v_exp_f32 v124, v76
    v_exp_f32 v125, v77
    v_cvt_pk_bf16_f32 v100, v120, v121
    v_mfma_f32_32x32x16_bf16 v[48:63], v[148:151], v[108:111], v[48:63]
    v_exp_f32 v126, v78
    v_exp_f32 v127, v79
    v_cvt_pk_bf16_f32 v101, v122, v123
    s_waitcnt lgkmcnt(0)
    v_mfma_f32_32x32x16_bf16 v[64:79], v[132:135], v[8:11], 0
    ds_read_b128 v[128:131], v156 offset:8704
    ds_read_b128 v[144:147], v157 offset:6528
    ds_read_b128 v[148:151], v157 offset:7104
    v_exp_f32 v112, v80
    v_exp_f32 v113, v81
    v_cvt_pk_bf16_f32 v102, v124, v125
    v_exp_f32 v114, v82
    v_exp_f32 v115, v83
    v_cvt_pk_bf16_f32 v103, v126, v127
    v_exp_f32 v116, v84
    v_exp_f32 v117, v85
    v_cvt_pk_bf16_f32 v104, v112, v113
    v_exp_f32 v118, v86
    v_exp_f32 v119, v87
    v_cvt_pk_bf16_f32 v105, v114, v115
    v_mfma_f32_32x32x16_bf16 v[32:47], v[136:139], v[96:99], v[32:47]
    v_exp_f32 v120, v88
    v_exp_f32 v121, v89
    v_cvt_pk_bf16_f32 v106, v116, v117
    v_exp_f32 v122, v90
    v_exp_f32 v123, v91
    v_cvt_pk_bf16_f32 v107, v118, v119
    v_exp_f32 v124, v92
    v_exp_f32 v125, v93
    v_cvt_pk_bf16_f32 v108, v120, v121
    v_mfma_f32_32x32x16_bf16 v[32:47], v[140:143], v[100:103], v[32:47]
    v_exp_f32 v126, v94
    v_exp_f32 v127, v95
    v_cvt_pk_bf16_f32 v109, v122, v123
    v_mfma_f32_32x32x16_bf16 v[80:95], v[132:135], v[12:15], 0
    v_exp_f32 v112, v64
    v_exp_f32 v113, v65
    v_cvt_pk_bf16_f32 v110, v124, v125
    v_exp_f32 v114, v66
    v_exp_f32 v115, v67
    v_cvt_pk_bf16_f32 v111, v126, v127
    v_exp_f32 v116, v68
    v_exp_f32 v117, v69
    v_cvt_pk_bf16_f32 v96, v112, v113
    v_exp_f32 v118, v70
    v_exp_f32 v119, v71
    v_cvt_pk_bf16_f32 v97, v114, v115
    v_mfma_f32_32x32x16_bf16 v[48:63], v[136:139], v[104:107], v[48:63]
    v_exp_f32 v120, v72
    v_exp_f32 v121, v73
    v_cvt_pk_bf16_f32 v98, v116, v117
    v_exp_f32 v122, v74
    v_exp_f32 v123, v75
    v_cvt_pk_bf16_f32 v99, v118, v119
    v_exp_f32 v124, v76
    v_exp_f32 v125, v77
    v_cvt_pk_bf16_f32 v100, v120, v121
    v_mfma_f32_32x32x16_bf16 v[48:63], v[140:143], v[108:111], v[48:63]
    v_exp_f32 v126, v78
    v_exp_f32 v127, v79
    v_cvt_pk_bf16_f32 v101, v122, v123
    s_waitcnt lgkmcnt(0)
    v_mfma_f32_32x32x16_bf16 v[64:79], v[128:131], v[8:11], 0
    ds_read_b128 v[132:135], v156 offset:10880
    ds_read_b128 v[136:139], v157 offset:8704
    ds_read_b128 v[140:143], v157 offset:9280
    v_exp_f32 v112, v80
    v_exp_f32 v113, v81
    v_cvt_pk_bf16_f32 v102, v124, v125
    v_exp_f32 v114, v82
    v_exp_f32 v115, v83
    v_cvt_pk_bf16_f32 v103, v126, v127
    v_exp_f32 v116, v84
    v_exp_f32 v117, v85
    v_cvt_pk_bf16_f32 v104, v112, v113
    v_exp_f32 v118, v86
    v_exp_f32 v119, v87
    v_cvt_pk_bf16_f32 v105, v114, v115
    v_mfma_f32_32x32x16_bf16 v[32:47], v[144:147], v[96:99], v[32:47]
    v_exp_f32 v120, v88
    v_exp_f32 v121, v89
    v_cvt_pk_bf16_f32 v106, v116, v117
    v_exp_f32 v122, v90
    v_exp_f32 v123, v91
    v_cvt_pk_bf16_f32 v107, v118, v119
    v_exp_f32 v124, v92
    v_exp_f32 v125, v93
    v_cvt_pk_bf16_f32 v108, v120, v121
    v_mfma_f32_32x32x16_bf16 v[32:47], v[148:151], v[100:103], v[32:47]
    v_exp_f32 v126, v94
    v_exp_f32 v127, v95
    v_cvt_pk_bf16_f32 v109, v122, v123
    v_add_u32 v156, 8704, v156
    v_add_u32 v157, 8704, v157
    s_add_u32 s29, s29, 1
    s_cmp_lg_u32 s29, 8
    v_mfma_f32_32x32x16_bf16 v[80:95], v[128:131], v[12:15], 0
    v_exp_f32 v112, v64
    v_exp_f32 v113, v65
    v_cvt_pk_bf16_f32 v110, v124, v125
    v_exp_f32 v114, v66
    v_exp_f32 v115, v67
    v_cvt_pk_bf16_f32 v111, v126, v127
    v_exp_f32 v116, v68
    v_exp_f32 v117, v69
    v_cvt_pk_bf16_f32 v96, v112, v113
    v_exp_f32 v118, v70
    v_exp_f32 v119, v71
    v_cvt_pk_bf16_f32 v97, v114, v115
    v_mfma_f32_32x32x16_bf16 v[48:63], v[144:147], v[104:107], v[48:63]
    v_exp_f32 v120, v72
    v_exp_f32 v121, v73
    v_cvt_pk_bf16_f32 v98, v116, v117
    v_exp_f32 v122, v74
    v_exp_f32 v123, v75
    v_cvt_pk_bf16_f32 v99, v118, v119
    v_exp_f32 v124, v76
    v_exp_f32 v125, v77
    v_cvt_pk_bf16_f32 v100, v120, v121
    v_mfma_f32_32x32x16_bf16 v[48:63], v[148:151], v[108:111], v[48:63]
    v_exp_f32 v126, v78
    v_exp_f32 v127, v79
    v_cvt_pk_bf16_f32 v101, v122, v123
    s_waitcnt lgkmcnt(0)
    v_mfma_f32_32x32x16_bf16 v[64:79], v[132:135], v[8:11], 0
    ds_read_b128 v[128:131], v156 offset:4352
    ds_read_b128 v[144:147], v157 offset:2176
    ds_read_b128 v[148:151], v157 offset:2752
    v_exp_f32 v112, v80
    v_exp_f32 v113, v81
    v_cvt_pk_bf16_f32 v102, v124, v125
    v_exp_f32 v114, v82
    v_exp_f32 v115, v83
    v_cvt_pk_bf16_f32 v103, v126, v127
    v_exp_f32 v116, v84
    v_exp_f32 v117, v85
    v_cvt_pk_bf16_f32 v104, v112, v113
    v_exp_f32 v118, v86
    v_exp_f32 v119, v87
    v_cvt_pk_bf16_f32 v105, v114, v115
    v_mfma_f32_32x32x16_bf16 v[32:47], v[136:139], v[96:99], v[32:47]
    v_exp_f32 v120, v88
    v_exp_f32 v121, v89
    v_cvt_pk_bf16_f32 v106, v116, v117
    v_exp_f32 v122, v90
    v_exp_f32 v123, v91
    v_cvt_pk_bf16_f32 v107, v118, v119
    v_exp_f32 v124, v92
    v_exp_f32 v125, v93
    v_cvt_pk_bf16_f32 v108, v120, v121
    v_mfma_f32_32x32x16_bf16 v[32:47], v[140:143], v[100:103], v[32:47]
    v_exp_f32 v126, v94
    v_exp_f32 v127, v95
    v_cvt_pk_bf16_f32 v109, v122, v123
    v_mfma_f32_32x32x16_bf16 v[80:95], v[132:135], v[12:15], 0
    v_exp_f32 v112, v64
    v_exp_f32 v113, v65
    v_cvt_pk_bf16_f32 v110, v124, v125
    v_exp_f32 v114, v66
    v_exp_f32 v115, v67
    v_cvt_pk_bf16_f32 v111, v126, v127
    v_exp_f32 v116, v68
    v_exp_f32 v117, v69
    v_cvt_pk_bf16_f32 v96, v112, v113
    v_exp_f32 v118, v70
    v_exp_f32 v119, v71
    v_cvt_pk_bf16_f32 v97, v114, v115
    v_mfma_f32_32x32x16_bf16 v[48:63], v[136:139], v[104:107], v[48:63]
    v_exp_f32 v120, v72
    v_exp_f32 v121, v73
    v_cvt_pk_bf16_f32 v98, v116, v117
    v_exp_f32 v122, v74
    v_exp_f32 v123, v75
    v_cvt_pk_bf16_f32 v99, v118, v119
    v_exp_f32 v124, v76
    v_exp_f32 v125, v77
    v_cvt_pk_bf16_f32 v100, v120, v121
    v_mfma_f32_32x32x16_bf16 v[48:63], v[140:143], v[108:111], v[48:63]
    v_exp_f32 v126, v78
    v_exp_f32 v127, v79
    v_cvt_pk_bf16_f32 v101, v122, v123
    s_waitcnt lgkmcnt(0)
    v_mfma_f32_32x32x16_bf16 v[64:79], v[128:131], v[8:11], 0
    ds_read_b128 v[132:135], v156 offset:6528
    ds_read_b128 v[136:139], v157 offset:4352
    ds_read_b128 v[140:143], v157 offset:4928
    v_exp_f32 v112, v80
    v_exp_f32 v113, v81
    v_cvt_pk_bf16_f32 v102, v124, v125
    v_exp_f32 v114, v82
    v_exp_f32 v115, v83
    v_cvt_pk_bf16_f32 v103, v126, v127
    v_exp_f32 v116, v84
    v_exp_f32 v117, v85
    v_cvt_pk_bf16_f32 v104, v112, v113
    v_exp_f32 v118, v86
    v_exp_f32 v119, v87
    v_cvt_pk_bf16_f32 v105, v114, v115
    v_mfma_f32_32x32x16_bf16 v[32:47], v[144:147], v[96:99], v[32:47]
    v_exp_f32 v120, v88
    v_exp_f32 v121, v89
    v_cvt_pk_bf16_f32 v106, v116, v117
    v_exp_f32 v122, v90
    v_exp_f32 v123, v91
    v_cvt_pk_bf16_f32 v107, v118, v119
    v_exp_f32 v124, v92
    v_exp_f32 v125, v93
    v_cvt_pk_bf16_f32 v108, v120, v121
    v_mfma_f32_32x32x16_bf16 v[32:47], v[148:151], v[100:103], v[32:47]
    v_exp_f32 v126, v94
    v_exp_f32 v127, v95
    v_cvt_pk_bf16_f32 v109, v122, v123
    v_mfma_f32_32x32x16_bf16 v[80:95], v[128:131], v[12:15], 0
    v_exp_f32 v112, v64
    v_exp_f32 v113, v65
    v_cvt_pk_bf16_f32 v110, v124, v125
    v_exp_f32 v114, v66
    v_exp_f32 v115, v67
    v_cvt_pk_bf16_f32 v111, v126, v127
    v_exp_f32 v116, v68
    v_exp_f32 v117, v69
    v_cvt_pk_bf16_f32 v96, v112, v113
    v_exp_f32 v118, v70
    v_exp_f32 v119, v71
    v_cvt_pk_bf16_f32 v97, v114, v115
    v_mfma_f32_32x32x16_bf16 v[48:63], v[144:147], v[104:107], v[48:63]
    v_exp_f32 v120, v72
    v_exp_f32 v121, v73
    v_cvt_pk_bf16_f32 v98, v116, v117
    v_exp_f32 v122, v74
    v_exp_f32 v123, v75
    v_cvt_pk_bf16_f32 v99, v118, v119
    v_exp_f32 v124, v76
    v_exp_f32 v125, v77
    v_cvt_pk_bf16_f32 v100, v120, v121
    v_mfma_f32_32x32x16_bf16 v[48:63], v[148:151], v[108:111], v[48:63]
    v_exp_f32 v126, v78
    v_exp_f32 v127, v79
    v_cvt_pk_bf16_f32 v101, v122, v123
    s_waitcnt lgkmcnt(0)
    v_mfma_f32_32x32x16_bf16 v[64:79], v[132:135], v[8:11], 0
    ds_read_b128 v[128:131], v156 offset:8704
    ds_read_b128 v[144:147], v157 offset:6528
    ds_read_b128 v[148:151], v157 offset:7104
    v_exp_f32 v112, v80
    v_exp_f32 v113, v81
    v_cvt_pk_bf16_f32 v102, v124, v125
    v_exp_f32 v114, v82
    v_exp_f32 v115, v83
    v_cvt_pk_bf16_f32 v103, v126, v127
    v_exp_f32 v116, v84
    v_exp_f32 v117, v85
    v_cvt_pk_bf16_f32 v104, v112, v113
    v_exp_f32 v118, v86
    v_exp_f32 v119, v87
    v_cvt_pk_bf16_f32 v105, v114, v115
    v_mfma_f32_32x32x16_bf16 v[32:47], v[136:139], v[96:99], v[32:47]
    v_exp_f32 v120, v88
    v_exp_f32 v121, v89
    v_cvt_pk_bf16_f32 v106, v116, v117
    v_exp_f32 v122, v90
    v_exp_f32 v123, v91
    v_cvt_pk_bf16_f32 v107, v118, v119
    v_exp_f32 v124, v92
    v_exp_f32 v125, v93
    v_cvt_pk_bf16_f32 v108, v120, v121
    v_mfma_f32_32x32x16_bf16 v[32:47], v[140:143], v[100:103], v[32:47]
    v_exp_f32 v126, v94
    v_exp_f32 v127, v95
    v_cvt_pk_bf16_f32 v109, v122, v123
    v_mfma_f32_32x32x16_bf16 v[80:95], v[132:135], v[12:15], 0
    v_exp_f32 v112, v64
    v_exp_f32 v113, v65
    v_cvt_pk_bf16_f32 v110, v124, v125
    v_exp_f32 v114, v66
    v_exp_f32 v115, v67
    v_cvt_pk_bf16_f32 v111, v126, v127
    v_exp_f32 v116, v68
    v_exp_f32 v117, v69
    v_cvt_pk_bf16_f32 v96, v112, v113
    v_exp_f32 v118, v70
    v_exp_f32 v119, v71
    v_cvt_pk_bf16_f32 v97, v114, v115
    v_mfma_f32_32x32x16_bf16 v[48:63], v[136:139], v[104:107], v[48:63]
    v_exp_f32 v120, v72
    v_exp_f32 v121, v73
    v_cvt_pk_bf16_f32 v98, v116, v117
    v_exp_f32 v122, v74
    v_exp_f32 v123, v75
    v_cvt_pk_bf16_f32 v99, v118, v119
    v_exp_f32 v124, v76
    v_exp_f32 v125, v77
    v_cvt_pk_bf16_f32 v100, v120, v121
    v_mfma_f32_32x32x16_bf16 v[48:63], v[140:143], v[108:111], v[48:63]
    v_exp_f32 v126, v78
    v_exp_f32 v127, v79
    v_cvt_pk_bf16_f32 v101, v122, v123
    s_waitcnt lgkmcnt(0)
    v_mfma_f32_32x32x16_bf16 v[64:79], v[128:131], v[8:11], 0
    ds_read_b128 v[132:135], v156 offset:10880
    ds_read_b128 v[136:139], v157 offset:8704
    ds_read_b128 v[140:143], v157 offset:9280
    v_exp_f32 v112, v80
    v_exp_f32 v113, v81
    v_cvt_pk_bf16_f32 v102, v124, v125
    v_exp_f32 v114, v82
    v_exp_f32 v115, v83
    v_cvt_pk_bf16_f32 v103, v126, v127
    v_exp_f32 v116, v84
    v_exp_f32 v117, v85
    v_cvt_pk_bf16_f32 v104, v112, v113
    v_exp_f32 v118, v86
    v_exp_f32 v119, v87
    v_cvt_pk_bf16_f32 v105, v114, v115
    v_mfma_f32_32x32x16_bf16 v[32:47], v[144:147], v[96:99], v[32:47]
    v_exp_f32 v120, v88
    v_exp_f32 v121, v89
    v_cvt_pk_bf16_f32 v106, v116, v117
    v_exp_f32 v122, v90
    v_exp_f32 v123, v91
    v_cvt_pk_bf16_f32 v107, v118, v119
    v_exp_f32 v124, v92
    v_exp_f32 v125, v93
    v_cvt_pk_bf16_f32 v108, v120, v121
    v_mfma_f32_32x32x16_bf16 v[32:47], v[148:151], v[100:103], v[32:47]
    v_exp_f32 v126, v94
    v_exp_f32 v127, v95
    v_cvt_pk_bf16_f32 v109, v122, v123
    v_add_u32 v156, 8704, v156
    v_add_u32 v157, 8704, v157
    s_add_u32 s29, s29, 1
    s_cmp_lg_u32 s29, 8
    s_waitcnt vmcnt(0)
    s_barrier
    s_cmp_lg_u32 s3, 0
    s_cbranch_scc1 F1_noxid
    v_mov_b32 v5, s61
    v_mov_b32 v6, 0
    s_mov_b64 exec, 1
    buffer_store_dword v5, v6, s[8:11], s40 offen offset:96 sc0 sc1
    s_mov_b64 exec, -1
F1_noxid:
    v_mfma_f32_32x32x16_bf16 v[80:95], v[128:131], v[12:15], 0
    v_exp_f32 v112, v64
    v_exp_f32 v113, v65
    v_cvt_pk_bf16_f32 v110, v124, v125
    v_exp_f32 v114, v66
    v_exp_f32 v115, v67
    v_cvt_pk_bf16_f32 v111, v126, v127
    v_exp_f32 v116, v68
    v_exp_f32 v117, v69
    v_cvt_pk_bf16_f32 v96, v112, v113
    buffer_load_dwordx4 a[0:3], v2, s[8:11], s48 offen offset:0
    v_exp_f32 v118, v70
    v_exp_f32 v119, v71
    v_cvt_pk_bf16_f32 v97, v114, v115
    v_mfma_f32_32x32x16_bf16 v[48:63], v[144:147], v[104:107], v[48:63]
    v_exp_f32 v120, v72
    v_exp_f32 v121, v73
    v_cvt_pk_bf16_f32 v98, v116, v117
    v_exp_f32 v122, v74
    v_exp_f32 v123, v75
    v_cvt_pk_bf16_f32 v99, v118, v119
    v_exp_f32 v124, v76
    v_exp_f32 v125, v77
    v_cvt_pk_bf16_f32 v100, v120, v121
    v_mfma_f32_32x32x16_bf16 v[48:63], v[148:151], v[108:111], v[48:63]
    buffer_load_dwordx4 a[4:7], v2, s[8:11], s49 offen offset:0
    v_exp_f32 v126, v78
    v_exp_f32 v127, v79
    v_cvt_pk_bf16_f32 v101, v122, v123
    s_waitcnt lgkmcnt(0)
    v_mfma_f32_32x32x16_bf16 v[64:79], v[132:135], v[8:11], 0
    ds_read_b128 v[128:131], v156 offset:4352
    ds_read_b128 v[144:147], v157 offset:2176
    ds_read_b128 v[148:151], v157 offset:2752
    v_exp_f32 v112, v80
    v_exp_f32 v113, v81
    v_cvt_pk_bf16_f32 v102, v124, v125
    v_exp_f32 v114, v82
    v_exp_f32 v115, v83
    v_cvt_pk_bf16_f32 v103, v126, v127
    v_exp_f32 v116, v84
    v_exp_f32 v117, v85
    v_cvt_pk_bf16_f32 v104, v112, v113
    buffer_load_dwordx4 a[8:11], v2, s[8:11], s48 offen offset:1024
    v_exp_f32 v118, v86
    v_exp_f32 v119, v87
    v_cvt_pk_bf16_f32 v105, v114, v115
    v_mfma_f32_32x32x16_bf16 v[32:47], v[136:139], v[96:99], v[32:47]
    v_exp_f32 v120, v88
    v_exp_f32 v121, v89
    v_cvt_pk_bf16_f32 v106, v116, v117
    v_exp_f32 v122, v90
    v_exp_f32 v123, v91
    v_cvt_pk_bf16_f32 v107, v118, v119
    v_exp_f32 v124, v92
    v_exp_f32 v125, v93
    v_cvt_pk_bf16_f32 v108, v120, v121
    v_mfma_f32_32x32x16_bf16 v[32:47], v[140:143], v[100:103], v[32:47]
    buffer_load_dwordx4 a[12:15], v2, s[8:11], s49 offen offset:1024
    v_exp_f32 v126, v94
    v_exp_f32 v127, v95
    v_cvt_pk_bf16_f32 v109, v122, v123
    v_mfma_f32_32x32x16_bf16 v[80:95], v[132:135], v[12:15], 0
    v_exp_f32 v112, v64
    v_exp_f32 v113, v65
    v_cvt_pk_bf16_f32 v110, v124, v125
    v_exp_f32 v114, v66
    v_exp_f32 v115, v67
    v_cvt_pk_bf16_f32 v111, v126, v127
    v_exp_f32 v116, v68
    v_exp_f32 v117, v69
    v_cvt_pk_bf16_f32 v96, v112, v113
    buffer_load_dwordx4 a[16:19], v2, s[8:11], s48 offen offset:2048
    v_exp_f32 v118, v70
    v_exp_f32 v119, v71
    v_cvt_pk_bf16_f32 v97, v114, v115
    v_mfma_f32_32x32x16_bf16 v[48:63], v[136:139], v[104:107], v[48:63]
    v_exp_f32 v120, v72
    v_exp_f32 v121, v73
    v_cvt_pk_bf16_f32 v98, v116, v117
    v_exp_f32 v122, v74
    v_exp_f32 v123, v75
    v_cvt_pk_bf16_f32 v99, v118, v119
    v_exp_f32 v124, v76
    v_exp_f32 v125, v77
    v_cvt_pk_bf16_f32 v100, v120, v121
    v_mfma_f32_32x32x16_bf16 v[48:63], v[140:143], v[108:111], v[48:63]
    buffer_load_dwordx4 a[20:23], v2, s[8:11], s49 offen offset:2048
    v_exp_f32 v126, v78
    v_exp_f32 v127, v79
    v_cvt_pk_bf16_f32 v101, v122, v123
    s_waitcnt lgkmcnt(0)
    v_mfma_f32_32x32x16_bf16 v[64:79], v[128:131], v[8:11], 0
    ds_read_b128 v[132:135], v156 offset:6528
    ds_read_b128 v[136:139], v157 offset:4352
    ds_read_b128 v[140:143], v157 offset:4928
    v_exp_f32 v112, v80
    v_exp_f32 v113, v81
    v_cvt_pk_bf16_f32 v102, v124, v125
    v_exp_f32 v114, v82
    v_exp_f32 v115, v83
    v_cvt_pk_bf16_f32 v103, v126, v127
    v_exp_f32 v116, v84
    v_exp_f32 v117, v85
    v_cvt_pk_bf16_f32 v104, v112, v113
    buffer_load_dwordx4 a[24:27], v2, s[8:11], s48 offen offset:3072
    v_exp_f32 v118, v86
    v_exp_f32 v119, v87
    v_cvt_pk_bf16_f32 v105, v114, v115
    v_mfma_f32_32x32x16_bf16 v[32:47], v[144:147], v[96:99], v[32:47]
    v_exp_f32 v120, v88
    v_exp_f32 v121, v89
    v_cvt_pk_bf16_f32 v106, v116, v117
    v_exp_f32 v122, v90
    v_exp_f32 v123, v91
    v_cvt_pk_bf16_f32 v107, v118, v119
    v_exp_f32 v124, v92
    v_exp_f32 v125, v93
    v_cvt_pk_bf16_f32 v108, v120, v121
    v_mfma_f32_32x32x16_bf16 v[32:47], v[148:151], v[100:103], v[32:47]
    buffer_load_dwordx4 a[28:31], v2, s[8:11], s49 offen offset:3072
    v_exp_f32 v126, v94
    v_exp_f32 v127, v95
    v_cvt_pk_bf16_f32 v109, v122, v123
    v_mfma_f32_32x32x16_bf16 v[80:95], v[128:131], v[12:15], 0
    v_exp_f32 v112, v64
    v_exp_f32 v113, v65
    v_cvt_pk_bf16_f32 v110, v124, v125
    v_exp_f32 v114, v66
    v_exp_f32 v115, v67
    v_cvt_pk_bf16_f32 v111, v126, v127
    v_exp_f32 v116, v68
    v_exp_f32 v117, v69
    v_cvt_pk_bf16_f32 v96, v112, v113
    buffer_load_dwordx4 a[32:35], v2, s[8:11], s52 offen offset:0
    v_exp_f32 v118, v70
    v_exp_f32 v119, v71
    v_cvt_pk_bf16_f32 v97, v114, v115
    v_mfma_f32_32x32x16_bf16 v[48:63], v[144:147], v[104:107], v[48:63]
    v_exp_f32 v120, v72
    v_exp_f32 v121, v73
    v_cvt_pk_bf16_f32 v98, v116, v117
    v_exp_f32 v122, v74
    v_exp_f32 v123, v75
    v_cvt_pk_bf16_f32 v99, v118, v119
    v_exp_f32 v124, v76
    v_exp_f32 v125, v77
    v_cvt_pk_bf16_f32 v100, v120, v121
    v_mfma_f32_32x32x16_bf16 v[48:63], v[148:151], v[108:111], v[48:63]
    buffer_load_dwordx4 a[36:39], v2, s[8:11], s50 offen offset:0
    v_exp_f32 v126, v78
    v_exp_f32 v127, v79
    v_cvt_pk_bf16_f32 v101, v122, v123
    s_waitcnt lgkmcnt(0)
    v_mfma_f32_32x32x16_bf16 v[64:79], v[132:135], v[8:11], 0
    ds_read_b128 v[128:131], v156 offset:8704
    ds_read_b128 v[144:147], v157 offset:6528
    ds_read_b128 v[148:151], v157 offset:7104
    v_exp_f32 v112, v80
    v_exp_f32 v113, v81
    v_cvt_pk_bf16_f32 v102, v124, v125
    v_exp_f32 v114, v82
    v_exp_f32 v115, v83
    v_cvt_pk_bf16_f32 v103, v126, v127
    v_exp_f32 v116, v84
    v_exp_f32 v117, v85
    v_cvt_pk_bf16_f32 v104, v112, v113
    v_exp_f32 v118, v86
    v_exp_f32 v119, v87
    v_cvt_pk_bf16_f32 v105, v114, v115
    v_mfma_f32_32x32x16_bf16 v[32:47], v[136:139], v[96:99], v[32:47]
    v_exp_f32 v120, v88
    v_exp_f32 v121, v89
    v_cvt_pk_bf16_f32 v106, v116, v117
    v_exp_f32 v122, v90
    v_exp_f32 v123, v91
    v_cvt_pk_bf16_f32 v107, v118, v119
    v_exp_f32 v124, v92
    v_exp_f32 v125, v93
    v_cvt_pk_bf16_f32 v108, v120, v121
    v_mfma_f32_32x32x16_bf16 v[32:47], v[140:143], v[100:103], v[32:47]
    v_exp_f32 v126, v94
    v_exp_f32 v127, v95
    v_cvt_pk_bf16_f32 v109, v122, v123
    v_mfma_f32_32x32x16_bf16 v[80:95], v[132:135], v[12:15], 0
    v_exp_f32 v112, v64
    v_exp_f32 v113, v65
    v_cvt_pk_bf16_f32 v110, v124, v125
    v_exp_f32 v114, v66
    v_exp_f32 v115, v67
    v_cvt_pk_bf16_f32 v111, v126, v127
    v_exp_f32 v116, v68
    v_exp_f32 v117, v69
    v_cvt_pk_bf16_f32 v96, v112, v113
    v_exp_f32 v118, v70
    v_exp_f32 v119, v71
    v_cvt_pk_bf16_f32 v97, v114, v115
    v_mfma_f32_32x32x16_bf16 v[48:63], v[136:139], v[104:107], v[48:63]
    v_exp_f32 v120, v72
    v_exp_f32 v121, v73
    v_cvt_pk_bf16_f32 v98, v116, v117
    v_exp_f32 v122, v74
    v_exp_f32 v123, v75
    v_cvt_pk_bf16_f32 v99, v118, v119
    v_exp_f32 v124, v76
    v_exp_f32 v125, v77
    v_cvt_pk_bf16_f32 v100, v120, v121
    v_mfma_f32_32x32x16_bf16 v[48:63], v[140:143], v[108:111], v[48:63]
    v_exp_f32 v126, v78
    v_exp_f32 v127, v79
    v_cvt_pk_bf16_f32 v101, v122, v123
    s_waitcnt lgkmcnt(0)
    v_mfma_f32_32x32x16_bf16 v[64:79], v[128:131], v[8:11], 0
    ds_read_b128 v[132:135], v156 offset:10880
    ds_read_b128 v[136:139], v157 offset:8704
    ds_read_b128 v[140:143], v157 offset:9280
    v_exp_f32 v112, v80
    v_exp_f32 v113, v81
    v_cvt_pk_bf16_f32 v102, v124, v125
    v_exp_f32 v114, v82
    v_exp_f32 v115, v83
    v_cvt_pk_bf16_f32 v103, v126, v127
    v_exp_f32 v116, v84
    v_exp_f32 v117, v85
    v_cvt_pk_bf16_f32 v104, v112, v113
    v_exp_f32 v118, v86
    v_exp_f32 v119, v87
    v_cvt_pk_bf16_f32 v105, v114, v115
    v_mfma_f32_32x32x16_bf16 v[32:47], v[144:147], v[96:99], v[32:47]
    v_exp_f32 v120, v88
    v_exp_f32 v121, v89
    v_cvt_pk_bf16_f32 v106, v116, v117
    v_exp_f32 v122, v90
    v_exp_f32 v123, v91
    v_cvt_pk_bf16_f32 v107, v118, v119
    v_exp_f32 v124, v92
    v_exp_f32 v125, v93
    v_cvt_pk_bf16_f32 v108, v120, v121
    v_mfma_f32_32x32x16_bf16 v[32:47], v[148:151], v[100:103], v[32:47]
    v_exp_f32 v126, v94
    v_exp_f32 v127, v95
    v_cvt_pk_bf16_f32 v109, v122, v123
    v_add_u32 v156, 8704, v156
    v_add_u32 v157, 8704, v157
    s_add_u32 s29, s29, 1
    s_cmp_lg_u32 s29, 8
    v_mfma_f32_32x32x16_bf16 v[80:95], v[128:131], v[12:15], 0
    v_exp_f32 v112, v64
    v_exp_f32 v113, v65
    v_cvt_pk_bf16_f32 v110, v124, v125
    v_exp_f32 v114, v66
    v_exp_f32 v115, v67
    v_cvt_pk_bf16_f32 v111, v126, v127
    v_exp_f32 v116, v68
    v_exp_f32 v117, v69
    v_cvt_pk_bf16_f32 v96, v112, v113
    buffer_load_dwordx4 a[40:43], v2, s[8:11], s50 offen offset:1024
    v_exp_f32 v118, v70
    v_exp_f32 v119, v71
    v_cvt_pk_bf16_f32 v97, v114, v115
    v_mfma_f32_32x32x16_bf16 v[48:63], v[144:147], v[104:107], v[48:63]
    v_exp_f32 v120, v72
    v_exp_f32 v121, v73
    v_cvt_pk_bf16_f32 v98, v116, v117
    v_exp_f32 v122, v74
    v_exp_f32 v123, v75
    v_cvt_pk_bf16_f32 v99, v118, v119
    v_exp_f32 v124, v76
    v_exp_f32 v125, v77
    v_cvt_pk_bf16_f32 v100, v120, v121
    v_mfma_f32_32x32x16_bf16 v[48:63], v[148:151], v[108:111], v[48:63]
    buffer_load_dwordx4 a[44:47], v2, s[8:11], s50 offen offset:2048
    v_exp_f32 v126, v78
    v_exp_f32 v127, v79
    v_cvt_pk_bf16_f32 v101, v122, v123
    s_waitcnt lgkmcnt(0)
    v_mfma_f32_32x32x16_bf16 v[64:79], v[132:135], v[8:11], 0
    ds_read_b128 v[128:131], v156 offset:4352
    ds_read_b128 v[144:147], v157 offset:2176
    ds_read_b128 v[148:151], v157 offset:2752
    v_exp_f32 v112, v80
    v_exp_f32 v113, v81
    v_cvt_pk_bf16_f32 v102, v124, v125
    v_exp_f32 v114, v82
    v_exp_f32 v115, v83
    v_cvt_pk_bf16_f32 v103, v126, v127
    v_exp_f32 v116, v84
    v_exp_f32 v117, v85
    v_cvt_pk_bf16_f32 v104, v112, v113
    buffer_load_dwordx4 a[48:51], v2, s[8:11], s50 offen offset:3072
    v_exp_f32 v118, v86
    v_exp_f32 v119, v87
    v_cvt_pk_bf16_f32 v105, v114, v115
    v_mfma_f32_32x32x16_bf16 v[32:47], v[136:139], v[96:99], v[32:47]
    v_exp_f32 v120, v88
    v_exp_f32 v121, v89
    v_cvt_pk_bf16_f32 v106, v116, v117
    v_exp_f32 v122, v90
    v_exp_f32 v123, v91
    v_cvt_pk_bf16_f32 v107, v118, v119
    v_exp_f32 v124, v92
    v_exp_f32 v125, v93
    v_cvt_pk_bf16_f32 v108, v120, v121
    v_mfma_f32_32x32x16_bf16 v[32:47], v[140:143], v[100:103], v[32:47]
    s_add_u32 s33, s50, 4096
    buffer_load_dwordx4 a[52:55], v2, s[8:11], s33 offen offset:0
    v_exp_f32 v126, v94
    v_exp_f32 v127, v95
    v_cvt_pk_bf16_f32 v109, v122, v123
    v_mfma_f32_32x32x16_bf16 v[80:95], v[132:135], v[12:15], 0
    v_exp_f32 v112, v64
    v_exp_f32 v113, v65
    v_cvt_pk_bf16_f32 v110, v124, v125
    v_exp_f32 v114, v66
    v_exp_f32 v115, v67
    v_cvt_pk_bf16_f32 v111, v126, v127
    v_exp_f32 v116, v68
    v_exp_f32 v117, v69
    v_cvt_pk_bf16_f32 v96, v112, v113
    s_add_u32 s33, s50, 4096
    buffer_load_dwordx4 a[56:59], v2, s[8:11], s33 offen offset:1024
    v_exp_f32 v118, v70
    v_exp_f32 v119, v71
    v_cvt_pk_bf16_f32 v97, v114, v115
    v_mfma_f32_32x32x16_bf16 v[48:63], v[136:139], v[104:107], v[48:63]
    v_exp_f32 v120, v72
    v_exp_f32 v121, v73
    v_cvt_pk_bf16_f32 v98, v116, v117
    v_exp_f32 v122, v74
    v_exp_f32 v123, v75
    v_cvt_pk_bf16_f32 v99, v118, v119
    v_exp_f32 v124, v76
    v_exp_f32 v125, v77
    v_cvt_pk_bf16_f32 v100, v120, v121
    v_mfma_f32_32x32x16_bf16 v[48:63], v[140:143], v[108:111], v[48:63]
    s_add_u32 s33, s50, 4096
    buffer_load_dwordx4 a[60:63], v2, s[8:11], s33 offen offset:2048
    v_exp_f32 v126, v78
    v_exp_f32 v127, v79
    v_cvt_pk_bf16_f32 v101, v122, v123
    s_waitcnt lgkmcnt(0)
    v_mfma_f32_32x32x16_bf16 v[64:79], v[128:131], v[8:11], 0
    ds_read_b128 v[132:135], v156 offset:6528
    ds_read_b128 v[136:139], v157 offset:4352
    ds_read_b128 v[140:143], v157 offset:4928
    v_exp_f32 v112, v80
    v_exp_f32 v113, v81
    v_cvt_pk_bf16_f32 v102, v124, v125
    v_exp_f32 v114, v82
    v_exp_f32 v115, v83
    v_cvt_pk_bf16_f32 v103, v126, v127
    v_exp_f32 v116, v84
    v_exp_f32 v117, v85
    v_cvt_pk_bf16_f32 v104, v112, v113
    s_add_u32 s33, s50, 4096
    buffer_load_dwordx4 a[64:67], v2, s[8:11], s33 offen offset:3072
    v_exp_f32 v118, v86
    v_exp_f32 v119, v87
    v_cvt_pk_bf16_f32 v105, v114, v115
    v_mfma_f32_32x32x16_bf16 v[32:47], v[144:147], v[96:99], v[32:47]
    v_exp_f32 v120, v88
    v_exp_f32 v121, v89
    v_cvt_pk_bf16_f32 v106, v116, v117
    v_exp_f32 v122, v90
    v_exp_f32 v123, v91
    v_cvt_pk_bf16_f32 v107, v118, v119
    v_exp_f32 v124, v92
    v_exp_f32 v125, v93
    v_cvt_pk_bf16_f32 v108, v120, v121
    v_mfma_f32_32x32x16_bf16 v[32:47], v[148:151], v[100:103], v[32:47]
    s_add_u32 s33, s50, 8192
    buffer_load_dwordx4 a[68:71], v2, s[8:11], s33 offen offset:0
    v_exp_f32 v126, v94
    v_exp_f32 v127, v95
    v_cvt_pk_bf16_f32 v109, v122, v123
    v_mfma_f32_32x32x16_bf16 v[80:95], v[128:131], v[12:15], 0
    v_exp_f32 v112, v64
    v_exp_f32 v113, v65
    v_cvt_pk_bf16_f32 v110, v124, v125
    v_exp_f32 v114, v66
    v_exp_f32 v115, v67
    v_cvt_pk_bf16_f32 v111, v126, v127
    v_exp_f32 v116, v68
    v_exp_f32 v117, v69
    v_cvt_pk_bf16_f32 v96, v112, v113
    s_add_u32 s33, s50, 8192
    buffer_load_dwordx4 a[72:75], v2, s[8:11], s33 offen offset:1024
    v_exp_f32 v118, v70
    v_exp_f32 v119, v71
    v_cvt_pk_bf16_f32 v97, v114, v115
    v_mfma_f32_32x32x16_bf16 v[48:63], v[144:147], v[104:107], v[48:63]
    v_exp_f32 v120, v72
    v_exp_f32 v121, v73
    v_cvt_pk_bf16_f32 v98, v116, v117
    v_exp_f32 v122, v74
    v_exp_f32 v123, v75
    v_cvt_pk_bf16_f32 v99, v118, v119
    v_exp_f32 v124, v76
    v_exp_f32 v125, v77
    v_cvt_pk_bf16_f32 v100, v120, v121
    v_mfma_f32_32x32x16_bf16 v[48:63], v[148:151], v[108:111], v[48:63]
    s_add_u32 s33, s50, 8192
    buffer_load_dwordx4 a[76:79], v2, s[8:11], s33 offen offset:2048
    v_exp_f32 v126, v78
    v_exp_f32 v127, v79
    v_cvt_pk_bf16_f32 v101, v122, v123
    s_waitcnt lgkmcnt(0)
    v_mfma_f32_32x32x16_bf16 v[64:79], v[132:135], v[8:11], 0
    ds_read_b128 v[128:131], v156 offset:8704
    ds_read_b128 v[144:147], v157 offset:6528
    ds_read_b128 v[148:151], v157 offset:7104
    v_exp_f32 v112, v80
    v_exp_f32 v113, v81
    v_cvt_pk_bf16_f32 v102, v124, v125
    v_exp_f32 v114, v82
    v_exp_f32 v115, v83
    v_cvt_pk_bf16_f32 v103, v126, v127
    v_exp_f32 v116, v84
    v_exp_f32 v117, v85
    v_cvt_pk_bf16_f32 v104, v112, v113
    v_exp_f32 v118, v86
    v_exp_f32 v119, v87
    v_cvt_pk_bf16_f32 v105, v114, v115
    v_mfma_f32_32x32x16_bf16 v[32:47], v[136:139], v[96:99], v[32:47]
    v_exp_f32 v120, v88
    v_exp_f32 v121, v89
    v_cvt_pk_bf16_f32 v106, v116, v117
    v_exp_f32 v122, v90
    v_exp_f32 v123, v91
    v_cvt_pk_bf16_f32 v107, v118, v119
    v_exp_f32 v124, v92
    v_exp_f32 v125, v93
    v_cvt_pk_bf16_f32 v108, v120, v121
    v_mfma_f32_32x32x16_bf16 v[32:47], v[140:143], v[100:103], v[32:47]
    v_exp_f32 v126, v94
    v_exp_f32 v127, v95
    v_cvt_pk_bf16_f32 v109, v122, v123
    v_mfma_f32_32x32x16_bf16 v[80:95], v[132:135], v[12:15], 0
    v_exp_f32 v112, v64
    v_exp_f32 v113, v65
    v_cvt_pk_bf16_f32 v110, v124, v125
    v_exp_f32 v114, v66
    v_exp_f32 v115, v67
    v_cvt_pk_bf16_f32 v111, v126, v127
    v_exp_f32 v116, v68
    v_exp_f32 v117, v69
    v_cvt_pk_bf16_f32 v96, v112, v113
    v_exp_f32 v118, v70
    v_exp_f32 v119, v71
    v_cvt_pk_bf16_f32 v97, v114, v115
    v_mfma_f32_32x32x16_bf16 v[48:63], v[136:139], v[104:107], v[48:63]
    v_exp_f32 v120, v72
    v_exp_f32 v121, v73
    v_cvt_pk_bf16_f32 v98, v116, v117
    v_exp_f32 v122, v74
    v_exp_f32 v123, v75
    v_cvt_pk_bf16_f32 v99, v118, v119
    v_exp_f32 v124, v76
    v_exp_f32 v125, v77
    v_cvt_pk_bf16_f32 v100, v120, v121
    v_mfma_f32_32x32x16_bf16 v[48:63], v[140:143], v[108:111], v[48:63]
    v_exp_f32 v126, v78
    v_exp_f32 v127, v79
    v_cvt_pk_bf16_f32 v101, v122, v123
    s_waitcnt lgkmcnt(0)
    v_mfma_f32_32x32x16_bf16 v[64:79], v[128:131], v[8:11], 0
    ds_read_b128 v[132:135], v156 offset:10880
    ds_read_b128 v[136:139], v157 offset:8704
    ds_read_b128 v[140:143], v157 offset:9280
    v_exp_f32 v112, v80
    v_exp_f32 v113, v81
    v_cvt_pk_bf16_f32 v102, v124, v125
    v_exp_f32 v114, v82
    v_exp_f32 v115, v83
    v_cvt_pk_bf16_f32 v103, v126, v127
    v_exp_f32 v116, v84
    v_exp_f32 v117, v85
    v_cvt_pk_bf16_f32 v104, v112, v113
    v_exp_f32 v118, v86
    v_exp_f32 v119, v87
    v_cvt_pk_bf16_f32 v105, v114, v115
    v_mfma_f32_32x32x16_bf16 v[32:47], v[144:147], v[96:99], v[32:47]
    v_exp_f32 v120, v88
    v_exp_f32 v121, v89
    v_cvt_pk_bf16_f32 v106, v116, v117
    v_exp_f32 v122, v90
    v_exp_f32 v123, v91
    v_cvt_pk_bf16_f32 v107, v118, v119
    v_exp_f32 v124, v92
    v_exp_f32 v125, v93
    v_cvt_pk_bf16_f32 v108, v120, v121
    v_mfma_f32_32x32x16_bf16 v[32:47], v[148:151], v[100:103], v[32:47]
    v_exp_f32 v126, v94
    v_exp_f32 v127, v95
    v_cvt_pk_bf16_f32 v109, v122, v123
    v_add_u32 v156, 8704, v156
    v_add_u32 v157, 8704, v157
    s_add_u32 s29, s29, 1
    s_cmp_lg_u32 s29, 8
    s_lshr_b32 s56, s4, 3
    s_and_b32 s56, s56, 3
    s_and_b32 s57, s56, 1
    s_lshl_b32 s58, s5, 1
    s_add_u32 s57, s57, s58
    s_mul_i32 s57, s57, 112
    s_mul_i32 s58, s3, 14
    s_add_u32 s57, s57, s58
    s_lshr_b32 s58, s56, 1
    s_mul_i32 s58, s58, 7
    s_add_u32 s57, s57, s58
    s_lshl_b32 s57, s57, 10
    s_add_u32 s57, s57, 0x2c0000
    s_lshl_b32 s58, s56, 12
    s_add_u32 s58, s58, s50
    s_add_u32 s58, s58, 15360
    s_and_b32 s59, s56, 1
    s_lshl_b32 s59, s59, 15
    s_lshr_b32 s60, s56, 1
    s_lshl_b32 s60, s60, 11
    s_add_u32 s59, s59, s60
    s_add_u32 s59, s59, s48
    s_add_u32 s59, s59, 0xfff80000
    v_min_u32 v152, 55, v1
    v_lshlrev_b32 v152, 7, v152
    v_min_u32 v153, 39, v1
    v_lshlrev_b32 v153, 7, v153
    v_and_b32 v5, 7, v1
    v_lshlrev_b32 v5, 2, v5
    s_lshl_b32 s62, s4, 8
    s_add_u32 s62, s62, 0x490000
    v_lshlrev_b32 v6, 10, v3
    s_lshl_b32 s20, s45, 15
    s_lshl_b32 s21, s46, 6
    s_add_u32 s20, s20, s21
    v_mfma_f32_32x32x16_bf16 v[80:95], v[128:131], v[12:15], 0
    v_exp_f32 v112, v64
    v_exp_f32 v113, v65
    v_cvt_pk_bf16_f32 v110, v124, v125
    v_exp_f32 v114, v66
    v_exp_f32 v115, v67
    v_cvt_pk_bf16_f32 v111, v126, v127
    s_add_u32 s33, s50, 8192
    buffer_load_dwordx4 a[80:83], v2, s[8:11], s33 offen offset:3072
    v_exp_f32 v116, v68
    v_exp_f32 v117, v69
    v_cvt_pk_bf16_f32 v96, v112, v113
    v_exp_f32 v118, v70
    v_exp_f32 v119, v71
    v_cvt_pk_bf16_f32 v97, v114, v115
    v_mfma_f32_32x32x16_bf16 v[48:63], v[144:147], v[104:107], v[48:63]
    v_exp_f32 v120, v72
    v_exp_f32 v121, v73
    v_cvt_pk_bf16_f32 v98, v116, v117
    v_exp_f32 v122, v74
    v_exp_f32 v123, v75
    v_cvt_pk_bf16_f32 v99, v118, v119
    s_add_u32 s33, s50, 12288
    buffer_load_dwordx4 a[84:87], v2, s[8:11], s33 offen offset:0
    v_exp_f32 v124, v76
    v_exp_f32 v125, v77
    v_cvt_pk_bf16_f32 v100, v120, v121
    v_mfma_f32_32x32x16_bf16 v[48:63], v[148:151], v[108:111], v[48:63]
    v_exp_f32 v126, v78
    v_exp_f32 v127, v79
    v_cvt_pk_bf16_f32 v101, v122, v123
    s_waitcnt lgkmcnt(0)
    v_mfma_f32_32x32x16_bf16 v[64:79], v[132:135], v[8:11], 0
    ds_read_b128 v[128:131], v156 offset:4352
    ds_read_b128 v[144:147], v157 offset:2176
    ds_read_b128 v[148:151], v157 offset:2752
    v_exp_f32 v112, v80
    v_exp_f32 v113, v81
    v_cvt_pk_bf16_f32 v102, v124, v125
    v_exp_f32 v114, v82
    v_exp_f32 v115, v83
    v_cvt_pk_bf16_f32 v103, v126, v127
    s_add_u32 s33, s50, 12288
    buffer_load_dwordx4 a[88:91], v2, s[8:11], s33 offen offset:1024
    v_exp_f32 v116, v84
    v_exp_f32 v117, v85
    v_cvt_pk_bf16_f32 v104, v112, v113
    v_exp_f32 v118, v86
    v_exp_f32 v119, v87
    v_cvt_pk_bf16_f32 v105, v114, v115
    v_mfma_f32_32x32x16_bf16 v[32:47], v[136:139], v[96:99], v[32:47]
    v_exp_f32 v120, v88
    v_exp_f32 v121, v89
    v_cvt_pk_bf16_f32 v106, v116, v117
    v_exp_f32 v122, v90
    v_exp_f32 v123, v91
    v_cvt_pk_bf16_f32 v107, v118, v119
    s_add_u32 s33, s50, 12288
    buffer_load_dwordx4 a[92:95], v2, s[8:11], s33 offen offset:2048
    v_exp_f32 v124, v92
    v_exp_f32 v125, v93
    v_cvt_pk_bf16_f32 v108, v120, v121
    v_mfma_f32_32x32x16_bf16 v[32:47], v[140:143], v[100:103], v[32:47]
    v_exp_f32 v126, v94
    v_exp_f32 v127, v95
    v_cvt_pk_bf16_f32 v109, v122, v123
    v_mfma_f32_32x32x16_bf16 v[80:95], v[132:135], v[12:15], 0
    v_exp_f32 v112, v64
    v_exp_f32 v113, v65
    v_cvt_pk_bf16_f32 v110, v124, v125
    v_exp_f32 v114, v66
    v_exp_f32 v115, v67
    v_cvt_pk_bf16_f32 v111, v126, v127
    s_add_u32 s33, s50, 20480
    buffer_load_dwordx4 v[16:19], v2, s[8:11], s33 offen offset:3072
    v_exp_f32 v116, v68
    v_exp_f32 v117, v69
    v_cvt_pk_bf16_f32 v96, v112, v113
    v_exp_f32 v118, v70
    v_exp_f32 v119, v71
    v_cvt_pk_bf16_f32 v97, v114, v115
    v_mfma_f32_32x32x16_bf16 v[48:63], v[136:139], v[104:107], v[48:63]
    v_exp_f32 v120, v72
    v_exp_f32 v121, v73
    v_cvt_pk_bf16_f32 v98, v116, v117
    v_exp_f32 v122, v74
    v_exp_f32 v123, v75
    v_cvt_pk_bf16_f32 v99, v118, v119
    s_add_u32 s33, s50, 24576
    buffer_load_dwordx4 v[20:23], v2, s[8:11], s33 offen offset:0
    v_exp_f32 v124, v76
    v_exp_f32 v125, v77
    v_cvt_pk_bf16_f32 v100, v120, v121
    v_mfma_f32_32x32x16_bf16 v[48:63], v[140:143], v[108:111], v[48:63]
    v_exp_f32 v126, v78
    v_exp_f32 v127, v79
    v_cvt_pk_bf16_f32 v101, v122, v123
    s_waitcnt lgkmcnt(0)
    v_mfma_f32_32x32x16_bf16 v[64:79], v[128:131], v[8:11], 0
    ds_read_b128 v[132:135], v156 offset:6528
    ds_read_b128 v[136:139], v157 offset:4352
    ds_read_b128 v[140:143], v157 offset:4928
    v_exp_f32 v112, v80
    v_exp_f32 v113, v81
    v_cvt_pk_bf16_f32 v102, v124, v125
    v_exp_f32 v114, v82
    v_exp_f32 v115, v83
    v_cvt_pk_bf16_f32 v103, v126, v127
    s_add_u32 s33, s50, 24576
    buffer_load_dwordx4 v[24:27], v2, s[8:11], s33 offen offset:1024
    v_exp_f32 v116, v84
    v_exp_f32 v117, v85
    v_cvt_pk_bf16_f32 v104, v112, v113
    v_exp_f32 v118, v86
    v_exp_f32 v119, v87
    v_cvt_pk_bf16_f32 v105, v114, v115
    v_mfma_f32_32x32x16_bf16 v[32:47], v[144:147], v[96:99], v[32:47]
    v_exp_f32 v120, v88
    v_exp_f32 v121, v89
    v_cvt_pk_bf16_f32 v106, v116, v117
    v_exp_f32 v122, v90
    v_exp_f32 v123, v91
    v_cvt_pk_bf16_f32 v107, v118, v119
    s_add_u32 s33, s50, 24576
    buffer_load_dwordx4 v[28:31], v2, s[8:11], s33 offen offset:2048
    v_exp_f32 v124, v92
    v_exp_f32 v125, v93
    v_cvt_pk_bf16_f32 v108, v120, v121
    v_mfma_f32_32x32x16_bf16 v[32:47], v[148:151], v[100:103], v[32:47]
    v_exp_f32 v126, v94
    v_exp_f32 v127, v95
    v_cvt_pk_bf16_f32 v109, v122, v123
    v_mfma_f32_32x32x16_bf16 v[80:95], v[128:131], v[12:15], 0
    v_exp_f32 v112, v64
    v_exp_f32 v113, v65
    v_cvt_pk_bf16_f32 v110, v124, v125
    v_exp_f32 v114, v66
    v_exp_f32 v115, v67
    v_cvt_pk_bf16_f32 v111, v126, v127
    buffer_load_dword v155, v152, s[8:11], s57 offen
    v_exp_f32 v116, v68
    v_exp_f32 v117, v69
    v_cvt_pk_bf16_f32 v96, v112, v113
    v_exp_f32 v118, v70
    v_exp_f32 v119, v71
    v_cvt_pk_bf16_f32 v97, v114, v115
    v_mfma_f32_32x32x16_bf16 v[48:63], v[144:147], v[104:107], v[48:63]
    v_exp_f32 v120, v72
    v_exp_f32 v121, v73
    v_cvt_pk_bf16_f32 v98, v116, v117
    v_exp_f32 v122, v74
    v_exp_f32 v123, v75
    v_cvt_pk_bf16_f32 v99, v118, v119
    buffer_load_dword v155, v153, s[8:11], s58 offen
    v_exp_f32 v124, v76
    v_exp_f32 v125, v77
    v_cvt_pk_bf16_f32 v100, v120, v121
    v_mfma_f32_32x32x16_bf16 v[48:63], v[148:151], v[108:111], v[48:63]
    v_exp_f32 v126, v78
    v_exp_f32 v127, v79
    v_cvt_pk_bf16_f32 v101, v122, v123
    s_waitcnt lgkmcnt(0)
    v_mfma_f32_32x32x16_bf16 v[64:79], v[132:135], v[8:11], 0
    ds_read_b128 v[128:131], v156 offset:8704
    ds_read_b128 v[144:147], v157 offset:6528
    ds_read_b128 v[148:151], v157 offset:7104
    v_exp_f32 v112, v80
    v_exp_f32 v113, v81
    v_cvt_pk_bf16_f32 v102, v124, v125
    v_exp_f32 v114, v82
    v_exp_f32 v115, v83
    v_cvt_pk_bf16_f32 v103, v126, v127
    buffer_load_dword v159, v5, s[8:11], s62 offen offset:96 sc0 sc1
    v_exp_f32 v116, v84
    v_exp_f32 v117, v85
    v_cvt_pk_bf16_f32 v104, v112, v113
    v_exp_f32 v118, v86
    v_exp_f32 v119, v87
    v_cvt_pk_bf16_f32 v105, v114, v115
    v_mfma_f32_32x32x16_bf16 v[32:47], v[136:139], v[96:99], v[32:47]
    v_exp_f32 v120, v88
    v_exp_f32 v121, v89
    v_cvt_pk_bf16_f32 v106, v116, v117
    v_exp_f32 v122, v90
    v_exp_f32 v123, v91
    v_cvt_pk_bf16_f32 v107, v118, v119
    buffer_load_dword v7, v6, s[16:19], s20 offen
    v_exp_f32 v124, v92
    v_exp_f32 v125, v93
    v_cvt_pk_bf16_f32 v108, v120, v121
    v_mfma_f32_32x32x16_bf16 v[32:47], v[140:143], v[100:103], v[32:47]
    v_exp_f32 v126, v94
    v_exp_f32 v127, v95
    v_cvt_pk_bf16_f32 v109, v122, v123
    v_mfma_f32_32x32x16_bf16 v[80:95], v[132:135], v[12:15], 0
    v_exp_f32 v112, v64
    v_exp_f32 v113, v65
    v_cvt_pk_bf16_f32 v110, v124, v125
    v_exp_f32 v114, v66
    v_exp_f32 v115, v67
    v_cvt_pk_bf16_f32 v111, v126, v127
    v_exp_f32 v116, v68
    v_exp_f32 v117, v69
    v_cvt_pk_bf16_f32 v96, v112, v113
    v_exp_f32 v118, v70
    v_exp_f32 v119, v71
    v_cvt_pk_bf16_f32 v97, v114, v115
    v_mfma_f32_32x32x16_bf16 v[48:63], v[136:139], v[104:107], v[48:63]
    v_exp_f32 v120, v72
    v_exp_f32 v121, v73
    v_cvt_pk_bf16_f32 v98, v116, v117
    v_exp_f32 v122, v74
    v_exp_f32 v123, v75
    v_cvt_pk_bf16_f32 v99, v118, v119
    v_exp_f32 v124, v76
    v_exp_f32 v125, v77
    v_cvt_pk_bf16_f32 v100, v120, v121
    v_mfma_f32_32x32x16_bf16 v[48:63], v[140:143], v[108:111], v[48:63]
    v_exp_f32 v126, v78
    v_exp_f32 v127, v79
    v_cvt_pk_bf16_f32 v101, v122, v123
    s_waitcnt lgkmcnt(0)
    v_mfma_f32_32x32x16_bf16 v[64:79], v[128:131], v[8:11], 0
    ds_read_b128 v[132:135], v156 offset:10880
    ds_read_b128 v[136:139], v157 offset:8704
    ds_read_b128 v[140:143], v157 offset:9280
    v_exp_f32 v112, v80
    v_exp_f32 v113, v81
    v_cvt_pk_bf16_f32 v102, v124, v125
    v_exp_f32 v114, v82
    v_exp_f32 v115, v83
    v_cvt_pk_bf16_f32 v103, v126, v127
    v_exp_f32 v116, v84
    v_exp_f32 v117, v85
    v_cvt_pk_bf16_f32 v104, v112, v113
    v_exp_f32 v118, v86
    v_exp_f32 v119, v87
    v_cvt_pk_bf16_f32 v105, v114, v115
    v_mfma_f32_32x32x16_bf16 v[32:47], v[144:147], v[96:99], v[32:47]
    v_exp_f32 v120, v88
    v_exp_f32 v121, v89
    v_cvt_pk_bf16_f32 v106, v116, v117
    v_exp_f32 v122, v90
    v_exp_f32 v123, v91
    v_cvt_pk_bf16_f32 v107, v118, v119
    v_exp_f32 v124, v92
    v_exp_f32 v125, v93
    v_cvt_pk_bf16_f32 v108, v120, v121
    v_mfma_f32_32x32x16_bf16 v[32:47], v[148:151], v[100:103], v[32:47]
    v_exp_f32 v126, v94
    v_exp_f32 v127, v95
    v_cvt_pk_bf16_f32 v109, v122, v123
    v_add_u32 v156, 8704, v156
    v_add_u32 v157, 8704, v157
    s_add_u32 s29, s29, 1
    s_cmp_lg_u32 s29, 8
F1_loop:
    s_cmp_lg_u32 s29, 7
    s_cbranch_scc1 F1_prio2
    s_setprio 0
F1_prio2:
    v_mfma_f32_32x32x16_bf16 v[80:95], v[128:131], v[12:15], 0
    v_exp_f32 v112, v64
    v_exp_f32 v113, v65
    v_cvt_pk_bf16_f32 v110, v124, v125
    v_exp_f32 v114, v66
    v_exp_f32 v115, v67
    v_cvt_pk_bf16_f32 v111, v126, v127
    v_exp_f32 v116, v68
    v_exp_f32 v117, v69
    v_cvt_pk_bf16_f32 v96, v112, v113
    v_exp_f32 v118, v70
    v_exp_f32 v119, v71
    v_cvt_pk_bf16_f32 v97, v114, v115
    v_mfma_f32_32x32x16_bf16 v[48:63], v[144:147], v[104:107], v[48:63]
    v_exp_f32 v120, v72
    v_exp_f32 v121, v73
    v_cvt_pk_bf16_f32 v98, v116, v117
    v_exp_f32 v122, v74
    v_exp_f32 v123, v75
    v_cvt_pk_bf16_f32 v99, v118, v119
    v_exp_f32 v124, v76
    v_exp_f32 v125, v77
    v_cvt_pk_bf16_f32 v100, v120, v121
    v_mfma_f32_32x32x16_bf16 v[48:63], v[148:151], v[108:111], v[48:63]
    v_exp_f32 v126, v78
    v_exp_f32 v127, v79
    v_cvt_pk_bf16_f32 v101, v122, v123
    s_waitcnt lgkmcnt(0)
    v_mfma_f32_32x32x16_bf16 v[64:79], v[132:135], v[8:11], 0
    ds_read_b128 v[128:131], v156 offset:4352
    ds_read_b128 v[144:147], v157 offset:2176
    ds_read_b128 v[148:151], v157 offset:2752
    v_exp_f32 v112, v80
    v_exp_f32 v113, v81
    v_cvt_pk_bf16_f32 v102, v124, v125
    v_exp_f32 v114, v82
    v_exp_f32 v115, v83
    v_cvt_pk_bf16_f32 v103, v126, v127
    v_exp_f32 v116, v84
    v_exp_f32 v117, v85
    v_cvt_pk_bf16_f32 v104, v112, v113
    v_exp_f32 v118, v86
    v_exp_f32 v119, v87
    v_cvt_pk_bf16_f32 v105, v114, v115
    v_mfma_f32_32x32x16_bf16 v[32:47], v[136:139], v[96:99], v[32:47]
    v_exp_f32 v120, v88
    v_exp_f32 v121, v89
    v_cvt_pk_bf16_f32 v106, v116, v117
    v_exp_f32 v122, v90
    v_exp_f32 v123, v91
    v_cvt_pk_bf16_f32 v107, v118, v119
    v_exp_f32 v124, v92
    v_exp_f32 v125, v93
    v_cvt_pk_bf16_f32 v108, v120, v121
    v_mfma_f32_32x32x16_bf16 v[32:47], v[140:143], v[100:103], v[32:47]
    v_exp_f32 v126, v94
    v_exp_f32 v127, v95
    v_cvt_pk_bf16_f32 v109, v122, v123
    v_mfma_f32_32x32x16_bf16 v[80:95], v[132:135], v[12:15], 0
    v_exp_f32 v112, v64
    v_exp_f32 v113, v65
    v_cvt_pk_bf16_f32 v110, v124, v125
    v_exp_f32 v114, v66
    v_exp_f32 v115, v67
    v_cvt_pk_bf16_f32 v111, v126, v127
    v_exp_f32 v116, v68
    v_exp_f32 v117, v69
    v_cvt_pk_bf16_f32 v96, v112, v113
    v_exp_f32 v118, v70
    v_exp_f32 v119, v71
    v_cvt_pk_bf16_f32 v97, v114, v115
    v_mfma_f32_32x32x16_bf16 v[48:63], v[136:139], v[104:107], v[48:63]
    v_exp_f32 v120, v72
    v_exp_f32 v121, v73
    v_cvt_pk_bf16_f32 v98, v116, v117
    v_exp_f32 v122, v74
    v_exp_f32 v123, v75
    v_cvt_pk_bf16_f32 v99, v118, v119
    v_exp_f32 v124, v76
    v_exp_f32 v125, v77
    v_cvt_pk_bf16_f32 v100, v120, v121
    v_mfma_f32_32x32x16_bf16 v[48:63], v[140:143], v[108:111], v[48:63]
    v_exp_f32 v126, v78
    v_exp_f32 v127, v79
    v_cvt_pk_bf16_f32 v101, v122, v123
    s_waitcnt lgkmcnt(0)
    v_mfma_f32_32x32x16_bf16 v[64:79], v[128:131], v[8:11], 0
    ds_read_b128 v[132:135], v156 offset:6528
    ds_read_b128 v[136:139], v157 offset:4352
    ds_read_b128 v[140:143], v157 offset:4928
    v_exp_f32 v112, v80
    v_exp_f32 v113, v81
    v_cvt_pk_bf16_f32 v102, v124, v125
    v_exp_f32 v114, v82
    v_exp_f32 v115, v83
    v_cvt_pk_bf16_f32 v103, v126, v127
    v_exp_f32 v116, v84
    v_exp_f32 v117, v85
    v_cvt_pk_bf16_f32 v104, v112, v113
    v_exp_f32 v118, v86
    v_exp_f32 v119, v87
    v_cvt_pk_bf16_f32 v105, v114, v115
    v_mfma_f32_32x32x16_bf16 v[32:47], v[144:147], v[96:99], v[32:47]
    v_exp_f32 v120, v88
    v_exp_f32 v121, v89
    v_cvt_pk_bf16_f32 v106, v116, v117
    v_exp_f32 v122, v90
    v_exp_f32 v123, v91
    v_cvt_pk_bf16_f32 v107, v118, v119
    v_exp_f32 v124, v92
    v_exp_f32 v125, v93
    v_cvt_pk_bf16_f32 v108, v120, v121
    v_mfma_f32_32x32x16_bf16 v[32:47], v[148:151], v[100:103], v[32:47]
    v_exp_f32 v126, v94
    v_exp_f32 v127, v95
    v_cvt_pk_bf16_f32 v109, v122, v123
    v_mfma_f32_32x32x16_bf16 v[80:95], v[128:131], v[12:15], 0
    v_exp_f32 v112, v64
    v_exp_f32 v113, v65
    v_cvt_pk_bf16_f32 v110, v124, v125
    v_exp_f32 v114, v66
    v_exp_f32 v115, v67
    v_cvt_pk_bf16_f32 v111, v126, v127
    v_exp_f32 v116, v68
    v_exp_f32 v117, v69
    v_cvt_pk_bf16_f32 v96, v112, v113
    v_exp_f32 v118, v70
    v_exp_f32 v119, v71
    v_cvt_pk_bf16_f32 v97, v114, v115
    v_mfma_f32_32x32x16_bf16 v[48:63], v[144:147], v[104:107], v[48:63]
    v_exp_f32 v120, v72
    v_exp_f32 v121, v73
    v_cvt_pk_bf16_f32 v98, v116, v117
    v_exp_f32 v122, v74
    v_exp_f32 v123, v75
    v_cvt_pk_bf16_f32 v99, v118, v119
    v_exp_f32 v124, v76
    v_exp_f32 v125, v77
    v_cvt_pk_bf16_f32 v100, v120, v121
    v_mfma_f32_32x32x16_bf16 v[48:63], v[148:151], v[108:111], v[48:63]
    v_exp_f32 v126, v78
    v_exp_f32 v127, v79
    v_cvt_pk_bf16_f32 v101, v122, v123
    s_waitcnt lgkmcnt(0)
    v_mfma_f32_32x32x16_bf16 v[64:79], v[132:135], v[8:11], 0
    ds_read_b128 v[128:131], v156 offset:8704
    ds_read_b128 v[144:147], v157 offset:6528
    ds_read_b128 v[148:151], v157 offset:7104
    v_exp_f32 v112, v80
    v_exp_f32 v113, v81
    v_cvt_pk_bf16_f32 v102, v124, v125
    v_exp_f32 v114, v82
    v_exp_f32 v115, v83
    v_cvt_pk_bf16_f32 v103, v126, v127
    v_exp_f32 v116, v84
    v_exp_f32 v117, v85
    v_cvt_pk_bf16_f32 v104, v112, v113
    v_exp_f32 v118, v86
    v_exp_f32 v119, v87
    v_cvt_pk_bf16_f32 v105, v114, v115
    v_mfma_f32_32x32x16_bf16 v[32:47], v[136:139], v[96:99], v[32:47]
    v_exp_f32 v120, v88
    v_exp_f32 v121, v89
    v_cvt_pk_bf16_f32 v106, v116, v117
    v_exp_f32 v122, v90
    v_exp_f32 v123, v91
    v_cvt_pk_bf16_f32 v107, v118, v119
    v_exp_f32 v124, v92
    v_exp_f32 v125, v93
    v_cvt_pk_bf16_f32 v108, v120, v121
    v_mfma_f32_32x32x16_bf16 v[32:47], v[140:143], v[100:103], v[32:47]
    v_exp_f32 v126, v94
    v_exp_f32 v127, v95
    v_cvt_pk_bf16_f32 v109, v122, v123
    v_mfma_f32_32x32x16_bf16 v[80:95], v[132:135], v[12:15], 0
    v_exp_f32 v112, v64
    v_exp_f32 v113, v65
    v_cvt_pk_bf16_f32 v110, v124, v125
    v_exp_f32 v114, v66
    v_exp_f32 v115, v67
    v_cvt_pk_bf16_f32 v111, v126, v127
    v_exp_f32 v116, v68
    v_exp_f32 v117, v69
    v_cvt_pk_bf16_f32 v96, v112, v113
    v_exp_f32 v118, v70
    v_exp_f32 v119, v71
    v_cvt_pk_bf16_f32 v97, v114, v115
    v_mfma_f32_32x32x16_bf16 v[48:63], v[136:139], v[104:107], v[48:63]
    v_exp_f32 v120, v72
    v_exp_f32 v121, v73
    v_cvt_pk_bf16_f32 v98, v116, v117
    v_exp_f32 v122, v74
    v_exp_f32 v123, v75
    v_cvt_pk_bf16_f32 v99, v118, v119
    v_exp_f32 v124, v76
    v_exp_f32 v125, v77
    v_cvt_pk_bf16_f32 v100, v120, v121
    v_mfma_f32_32x32x16_bf16 v[48:63], v[140:143], v[108:111], v[48:63]
    v_exp_f32 v126, v78
    v_exp_f32 v127, v79
    v_cvt_pk_bf16_f32 v101, v122, v123
    s_waitcnt lgkmcnt(0)
    v_mfma_f32_32x32x16_bf16 v[64:79], v[128:131], v[8:11], 0
    ds_read_b128 v[132:135], v156 offset:10880
    ds_read_b128 v[136:139], v157 offset:8704
    ds_read_b128 v[140:143], v157 offset:9280
    v_exp_f32 v112, v80
    v_exp_f32 v113, v81
    v_cvt_pk_bf16_f32 v102, v124, v125
    v_exp_f32 v114, v82
    v_exp_f32 v115, v83
    v_cvt_pk_bf16_f32 v103, v126, v127
    v_exp_f32 v116, v84
    v_exp_f32 v117, v85
    v_cvt_pk_bf16_f32 v104, v112, v113
    v_exp_f32 v118, v86
    v_exp_f32 v119, v87
    v_cvt_pk_bf16_f32 v105, v114, v115
    v_mfma_f32_32x32x16_bf16 v[32:47], v[144:147], v[96:99], v[32:47]
    v_exp_f32 v120, v88
    v_exp_f32 v121, v89
    v_cvt_pk_bf16_f32 v106, v116, v117
    v_exp_f32 v122, v90
    v_exp_f32 v123, v91
    v_cvt_pk_bf16_f32 v107, v118, v119
    v_exp_f32 v124, v92
    v_exp_f32 v125, v93
    v_cvt_pk_bf16_f32 v108, v120, v121
    v_mfma_f32_32x32x16_bf16 v[32:47], v[148:151], v[100:103], v[32:47]
    v_exp_f32 v126, v94
    v_exp_f32 v127, v95
    v_cvt_pk_bf16_f32 v109, v122, v123
    v_add_u32 v156, 8704, v156
    v_add_u32 v157, 8704, v157
    s_add_u32 s29, s29, 1
    s_cmp_lg_u32 s29, 8
    s_cbranch_scc1 F1_loop
    s_waitcnt vmcnt(0)
    v_cvt_pk_bf16_f32 v110, v124, v125
    v_cvt_pk_bf16_f32 v111, v126, v127
    s_nop 1
    v_mfma_f32_32x32x16_bf16 v[48:63], v[144:147], v[104:107], v[48:63]
    v_mfma_f32_32x32x16_bf16 v[48:63], v[148:151], v[108:111], v[48:63]
    s_mul_i32 s25, s3, 2304
    s_add_u32 s25, s25, 139264
    v_add_u32 v5, s25, v2
    v_lshlrev_b32 v6, 2, v1
    v_add_u32 v6, s25, v6
    s_xor_b32 s25, s3, 4
    s_mul_i32 s25, s25, 2304
    s_add_u32 s25, s25, 139264
    v_add_u32 v7, s25, v2
    s_waitcnt vmcnt(0)
    s_mov_b32 s37, 0
    v_and_b32 v153, 7, v1
    v_lshlrev_b32 v153, 2, v153
F1_xchk:
    v_cmp_eq_u32 vcc, 0, v159
    s_cmp_eq_u64 vcc, 0
    s_cbranch_scc1 F1_xok
    s_add_u32 s37, s37, 1
    s_cmp_gt_u32 s37, 200000
    s_cbranch_scc1 F1_xok
    s_sleep 1
    buffer_load_dword v159, v153, s[8:11], s62 offen offset:96 sc0 sc1
    s_waitcnt vmcnt(0)
    s_branch F1_xchk
F1_xok:
    v_cmp_ne_u32 vcc, s61, v159
    s_cmp_eq_u64 vcc, 0
    s_cselect_b32 s61, 1, 0
    v_lshlrev_b32 v154, 2, v1
    v_add_u32 v154, s25, v154
    s_waitcnt lgkmcnt(0)
    s_nop 7
    ds_write_b128 v5, v[48:51]
    ds_write_b128 v5, v[52:55] offset:1024
    ds_write_b32 v6, v56 offset:2048
    s_waitcnt lgkmcnt(0)
    s_barrier
    ds_read_b128 v[64:67], v7
    ds_read_b128 v[68:71], v7 offset:1024
    ds_read_b32 v72, v154 offset:2048
    v_mov_b32 v5, 157696
    ds_read_b128 v[80:83], v5
    ds_read_b128 v[84:87], v5 offset:16
    s_waitcnt lgkmcnt(0)
    v_add_f32 v32, v32, v64
    v_add_f32 v33, v33, v65
    v_add_f32 v34, v34, v66
    v_add_f32 v35, v35, v67
    v_add_f32 v36, v36, v68
    v_add_f32 v37, v37, v69
    v_add_f32 v38, v38, v70
    v_add_f32 v39, v39, v71
    v_add_f32 v40, v40, v72
    v_max3_f32 v5, v80, v81, v82
    v_max3_f32 v5, v5, v83, v84
    v_max3_f32 v5, v5, v85, v86
    v_max_f32 v5, v5, v87
    v_mul_f32 v5, s63, v5
    v_mov_b32 v6, 0x45800000
    v_cmp_nle_f32 vcc, v5, v6
    s_cmp_eq_u64 vcc, 0
    s_cbranch_scc1 F1_afin
    v_mov_b32 v156, v2
    v_mov_b32 v6, 0xff800000
    s_mov_b32 s29, 64
F1_fb:
    ds_read_b128 v[128:131], v156
    v_add_u32 v156, 2176, v156
    s_waitcnt lgkmcnt(0)
    v_mfma_f32_32x32x16_bf16 v[64:79], v[128:131], v[8:11], 0
    s_nop 15
    v_max3_f32 v6, v6, v64, v65
    v_max3_f32 v6, v6, v66, v67
    v_max3_f32 v6, v6, v68, v69
    v_max3_f32 v6, v6, v70, v71
    v_max3_f32 v6, v6, v72, v73
    v_max3_f32 v6, v6, v74, v75
    v_max3_f32 v6, v6, v76, v77
    v_max3_f32 v6, v6, v78, v79
    s_sub_u32 s29, s29, 1
    s_cmp_lg_u32 s29, 0
    s_cbranch_scc1 F1_fb
    v_mov_b32 v7, v6
    s_nop 1
    v_permlane32_swap_b32 v6, v7
    s_nop 0
    v_max_f32 v6, v6, v7
    v_sub_f32 v6, 0, v6
    v_mov_b32 v80, v6
    v_mov_b32 v32, 0
    v_mov_b32 v81, v6
    v_mov_b32 v33, 0
    v_mov_b32 v82, v6
    v_mov_b32 v34, 0
    v_mov_b32 v83, v6
    v_mov_b32 v35, 0
    v_mov_b32 v84, v6
    v_mov_b32 v36, 0
    v_mov_b32 v85, v6
    v_mov_b32 v37, 0
    v_mov_b32 v86, v6
    v_mov_b32 v38, 0
    v_mov_b32 v87, v6
    v_mov_b32 v39, 0
    v_mov_b32 v88, v6
    v_mov_b32 v40, 0
    v_mov_b32 v89, v6
    v_mov_b32 v41, 0
    v_mov_b32 v90, v6
    v_mov_b32 v42, 0
    v_mov_b32 v91, v6
    v_mov_b32 v43, 0
    v_mov_b32 v92, v6
    v_mov_b32 v44, 0
    v_mov_b32 v93, v6
    v_mov_b32 v45, 0
    v_mov_b32 v94, v6
    v_mov_b32 v46, 0
    v_mov_b32 v95, v6
    v_mov_b32 v47, 0
    v_mov_b32 v156, v2
    v_mov_b32 v157, v158
    s_mov_b32 s29, 64
F1_fb2:
    ds_read_b128 v[128:131], v156
    ds_read_b128 v[136:139], v157
    ds_read_b128 v[140:143], v157 offset:576
    v_add_u32 v156, 2176, v156
    v_add_u32 v157, 2176, v157
    s_waitcnt lgkmcnt(0)
    v_mfma_f32_32x32x16_bf16 v[64:79], v[128:131], v[8:11], v[80:95]
    s_nop 15
    v_exp_f32 v64, v64
    v_exp_f32 v65, v65
    v_exp_f32 v66, v66
    v_exp_f32 v67, v67
    v_exp_f32 v68, v68
    v_exp_f32 v69, v69
    v_exp_f32 v70, v70
    v_exp_f32 v71, v71
    v_exp_f32 v72, v72
    v_exp_f32 v73, v73
    v_exp_f32 v74, v74
    v_exp_f32 v75, v75
    v_exp_f32 v76, v76
    v_exp_f32 v77, v77
    v_exp_f32 v78, v78
    v_exp_f32 v79, v79
    s_nop 0
    v_cvt_pk_bf16_f32 v96, v64, v65
    v_cvt_pk_bf16_f32 v97, v66, v67
    v_cvt_pk_bf16_f32 v98, v68, v69
    v_cvt_pk_bf16_f32 v99, v70, v71
    v_cvt_pk_bf16_f32 v100, v72, v73
    v_cvt_pk_bf16_f32 v101, v74, v75
    v_cvt_pk_bf16_f32 v102, v76, v77
    v_cvt_pk_bf16_f32 v103, v78, v79
    s_nop 1
    v_mfma_f32_32x32x16_bf16 v[32:47], v[136:139], v[96:99], v[32:47]
    v_mfma_f32_32x32x16_bf16 v[32:47], v[140:143], v[100:103], v[32:47]
    s_nop 15
    s_sub_u32 s29, s29, 1
    s_cmp_lg_u32 s29, 0
    s_cbranch_scc1 F1_fb2
F1_afin:
    v_rcp_f32 v6, v40
    s_nop 0
    v_mul_f32 v32, v32, v6
    v_mul_f32 v33, v33, v6
    v_mul_f32 v34, v34, v6
    v_mul_f32 v35, v35, v6
    v_mul_f32 v36, v36, v6
    v_mul_f32 v37, v37, v6
    v_mul_f32 v38, v38, v6
    v_mul_f32 v39, v39, v6
    v_cvt_pk_bf16_f32 v64, v32, v33
    v_cvt_pk_bf16_f32 v65, v34, v35
    v_cvt_pk_bf16_f32 v66, v36, v37
    v_cvt_pk_bf16_f32 v67, v38, v39
    s_add_u32 s23, s22, 0x900000
    s_cmp_lg_u32 s61, 0
    s_cbranch_scc1 HS9_f
    buffer_store_dwordx4 v[64:67], v2, s[8:11], s23 offen sc0 sc1
    s_branch HS9_e
HS9_f:
    buffer_store_dwordx4 v[64:67], v2, s[8:11], s23 offen
HS9_e:
    s_waitcnt vmcnt(0)
    s_barrier
    s_cmp_lg_u32 s3, 0
    s_cbranch_scc1 F1_p1_np
    v_mov_b32 v5, 5
    v_mov_b32 v6, 0
    v_cmp_eq_u32 vcc, 0, v1
    s_and_saveexec_b64 s[38:39], vcc
    s_cmp_lg_u32 s61, 0
    s_cbranch_scc1 HS10_f
    buffer_store_dword v5, v6, s[8:11], s40 offen sc0 sc1
    s_branch HS10_e
HS10_f:
    buffer_store_dword v5, v6, s[8:11], s40 offen
HS10_e:
    s_mov_b64 exec, s[38:39]
F1_p1_np:
    s_lshl_b32 s20, s4, 6
    s_lshl_b32 s21, s3, 2
    s_add_u32 s20, s20, s21
    s_lshl_b32 s53, s20, 10
    s_add_u32 s20, s53, 0x900000
    s_add_u32 s21, s20, 32768
    s_add_u32 s33, s50, 24576
    buffer_load_dwordx4 v[8:11], v2, s[8:11], s33 offen offset:3072
    s_add_u32 s33, s50, 28672
    buffer_load_dwordx4 v[12:15], v2, s[8:11], s33 offen offset:0
    s_add_u32 s33, s50, 28672
    buffer_load_dwordx4 v[144:147], v2, s[8:11], s33 offen offset:1024
    s_add_u32 s33, s50, 28672
    buffer_load_dwordx4 v[148:151], v2, s[8:11], s33 offen offset:2048
    s_add_u32 s33, s50, 28672
    buffer_load_dwordx4 v[152:155], v2, s[8:11], s33 offen offset:3072
    v_mov_b32 v6, 0
    s_mov_b32 s37, 0
F1_w1_poll:
    buffer_load_dword v5, v6, s[8:11], s41 offen sc0 sc1
    s_waitcnt vmcnt(0)
    v_readfirstlane_b32 s36, v5
    s_add_u32 s37, s37, 1
    s_cmp_ge_u32 s36, 5
    s_cbranch_scc1 F1_w1_go
    s_cmp_gt_u32 s37, 200000
    s_cbranch_scc1 F1_w1_go
    s_sleep 1
    s_branch F1_w1_poll
F1_w1_go:
    buffer_load_dwordx4 v[32:35], v2, s[8:11], s20 offen offset:0 sc1
    buffer_load_dwordx4 v[36:39], v2, s[8:11], s21 offen offset:0 sc1
    buffer_load_dwordx4 v[40:43], v2, s[8:11], s20 offen offset:1024 sc1
    buffer_load_dwordx4 v[44:47], v2, s[8:11], s21 offen offset:1024 sc1
    buffer_load_dwordx4 v[48:51], v2, s[8:11], s20 offen offset:2048 sc1
    buffer_load_dwordx4 v[52:55], v2, s[8:11], s21 offen offset:2048 sc1
    buffer_load_dwordx4 v[56:59], v2, s[8:11], s20 offen offset:3072 sc1
    buffer_load_dwordx4 v[60:63], v2, s[8:11], s21 offen offset:3072 sc1
    s_waitcnt vmcnt(6)
    v_mfma_f32_32x32x16_bf16 v[64:79], a[0:3], v[32:35], 0
    v_mfma_f32_32x32x16_bf16 v[80:95], a[0:3], v[36:39], 0
    v_mfma_f32_32x32x16_bf16 v[96:111], a[4:7], v[32:35], 0
    v_mfma_f32_32x32x16_bf16 v[112:127], a[4:7], v[36:39], 0
    s_waitcnt vmcnt(4)
    v_mfma_f32_32x32x16_bf16 v[64:79], a[8:11], v[40:43], v[64:79]
    v_mfma_f32_32x32x16_bf16 v[80:95], a[8:11], v[44:47], v[80:95]
    v_mfma_f32_32x32x16_bf16 v[96:111], a[12:15], v[40:43], v[96:111]
    v_mfma_f32_32x32x16_bf16 v[112:127], a[12:15], v[44:47], v[112:127]
    s_waitcnt vmcnt(2)
    v_mfma_f32_32x32x16_bf16 v[64:79], a[16:19], v[48:51], v[64:79]
    v_mfma_f32_32x32x16_bf16 v[80:95], a[16:19], v[52:55], v[80:95]
    v_mfma_f32_32x32x16_bf16 v[96:111], a[20:23], v[48:51], v[96:111]
    v_mfma_f32_32x32x16_bf16 v[112:127], a[20:23], v[52:55], v[112:127]
    s_waitcnt vmcnt(0)
    v_mfma_f32_32x32x16_bf16 v[64:79], a[24:27], v[56:59], v[64:79]
    v_mfma_f32_32x32x16_bf16 v[80:95], a[24:27], v[60:63], v[80:95]
    v_mfma_f32_32x32x16_bf16 v[96:111], a[28:31], v[56:59], v[96:111]
    v_mfma_f32_32x32x16_bf16 v[112:127], a[28:31], v[60:63], v[112:127]
    s_add_u32 s33, s50, 12288
    buffer_load_dwordx4 a[0:3], v2, s[8:11], s33 offen offset:3072
    s_add_u32 s33, s50, 16384
    buffer_load_dwordx4 a[4:7], v2, s[8:11], s33 offen offset:0
    s_add_u32 s33, s50, 16384
    buffer_load_dwordx4 a[8:11], v2, s[8:11], s33 offen offset:1024
    s_add_u32 s33, s50, 16384
    buffer_load_dwordx4 a[12:15], v2, s[8:11], s33 offen offset:2048
    s_add_u32 s33, s50, 16384
    buffer_load_dwordx4 a[16:19], v2, s[8:11], s33 offen offset:3072
    s_add_u32 s33, s50, 20480
    buffer_load_dwordx4 a[20:23], v2, s[8:11], s33 offen offset:0
    s_add_u32 s33, s50, 20480
    buffer_load_dwordx4 a[24:27], v2, s[8:11], s33 offen offset:1024
    s_add_u32 s33, s50, 20480
    buffer_load_dwordx4 a[28:31], v2, s[8:11], s33 offen offset:2048
    s_lshl_b32 s32, s3, 11
    v_add_u32 v5, s32, v2
    v_add_u32 v6, 0x10000, v5
    s_lshl_b32 s32, s3, 14
    v_add_u32 v7, s32, v2
    s_nop 11
    ds_write_b128 v5, v[64:67] offset:0
    ds_write_b128 v5, v[68:71] offset:1024
    ds_write_b128 v5, v[72:75] offset:16384
    ds_write_b128 v5, v[76:79] offset:17408
    ds_write_b128 v5, v[80:83] offset:32768
    ds_write_b128 v5, v[84:87] offset:33792
    ds_write_b128 v5, v[88:91] offset:49152
    ds_write_b128 v5, v[92:95] offset:50176
    ds_write_b128 v6, v[96:99] offset:0
    ds_write_b128 v6, v[100:103] offset:1024
    ds_write_b128 v6, v[104:107] offset:16384
    ds_write_b128 v6, v[108:111] offset:17408
    ds_write_b128 v6, v[112:115] offset:32768
    ds_write_b128 v6, v[116:119] offset:33792
    ds_write_b128 v6, v[120:123] offset:49152
    ds_write_b128 v6, v[124:127] offset:50176
    s_waitcnt lgkmcnt(0)
    s_barrier
    ds_read_b128 v[64:67], v7 offset:0
    ds_read_b128 v[68:71], v7 offset:1024
    ds_read_b128 v[72:75], v7 offset:2048
    ds_read_b128 v[76:79], v7 offset:3072
    ds_read_b128 v[80:83], v7 offset:4096
    ds_read_b128 v[84:87], v7 offset:5120
    ds_read_b128 v[88:91], v7 offset:6144
    ds_read_b128 v[92:95], v7 offset:7168
    ds_read_b128 v[96:99], v7 offset:8192
    ds_read_b128 v[100:103], v7 offset:9216
    ds_read_b128 v[104:107], v7 offset:10240
    ds_read_b128 v[108:111], v7 offset:11264
    ds_read_b128 v[112:115], v7 offset:12288
    ds_read_b128 v[116:119], v7 offset:13312
    ds_read_b128 v[120:123], v7 offset:14336
    ds_read_b128 v[124:127], v7 offset:15360
    s_waitcnt lgkmcnt(12)
    v_add_f32 v128, v64, v72
    v_add_f32 v129, v65, v73
    v_add_f32 v130, v66, v74
    v_add_f32 v131, v67, v75
    v_add_f32 v132, v68, v76
    v_add_f32 v133, v69, v77
    v_add_f32 v134, v70, v78
    v_add_f32 v135, v71, v79
    s_waitcnt lgkmcnt(8)
    v_add_f32 v80, v80, v88
    v_add_f32 v128, v128, v80
    v_add_f32 v81, v81, v89
    v_add_f32 v129, v129, v81
    v_add_f32 v82, v82, v90
    v_add_f32 v130, v130, v82
    v_add_f32 v83, v83, v91
    v_add_f32 v131, v131, v83
    v_add_f32 v84, v84, v92
    v_add_f32 v132, v132, v84
    v_add_f32 v85, v85, v93
    v_add_f32 v133, v133, v85
    v_add_f32 v86, v86, v94
    v_add_f32 v134, v134, v86
    v_add_f32 v87, v87, v95
    v_add_f32 v135, v135, v87
    s_waitcnt lgkmcnt(4)
    v_add_f32 v96, v96, v104
    v_add_f32 v128, v128, v96
    v_add_f32 v97, v97, v105
    v_add_f32 v129, v129, v97
    v_add_f32 v98, v98, v106
    v_add_f32 v130, v130, v98
    v_add_f32 v99, v99, v107
    v_add_f32 v131, v131, v99
    v_add_f32 v100, v100, v108
    v_add_f32 v132, v132, v100
    v_add_f32 v101, v101, v109
    v_add_f32 v133, v133, v101
    v_add_f32 v102, v102, v110
    v_add_f32 v134, v134, v102
    v_add_f32 v103, v103, v111
    v_add_f32 v135, v135, v103
    s_waitcnt lgkmcnt(0)
    v_add_f32 v112, v112, v120
    v_add_f32 v128, v128, v112
    v_add_f32 v113, v113, v121
    v_add_f32 v129, v129, v113
    v_add_f32 v114, v114, v122
    v_add_f32 v130, v130, v114
    v_add_f32 v115, v115, v123
    v_add_f32 v131, v131, v115
    v_add_f32 v116, v116, v124
    v_add_f32 v132, v132, v116
    v_add_f32 v117, v117, v125
    v_add_f32 v133, v133, v117
    v_add_f32 v118, v118, v126
    v_add_f32 v134, v134, v118
    v_add_f32 v119, v119, v127
    v_add_f32 v135, v135, v119
    v_accvgpr_read_b32 v136, a32
    v_accvgpr_read_b32 v137, a33
    v_accvgpr_read_b32 v138, a34
    v_accvgpr_read_b32 v139, a35
    v_lshlrev_b32 v140, 16, v136
    v_and_b32 v141, 0xffff0000, v136
    v_add_f32 v128, v128, v140
    v_add_f32 v129, v129, v141
    v_lshlrev_b32 v140, 16, v137
    v_and_b32 v141, 0xffff0000, v137
    v_add_f32 v130, v130, v140
    v_add_f32 v131, v131, v141
    v_lshlrev_b32 v140, 16, v138
    v_and_b32 v141, 0xffff0000, v138
    v_add_f32 v132, v132, v140
    v_add_f32 v133, v133, v141
    v_lshlrev_b32 v140, 16, v139
    v_and_b32 v141, 0xffff0000, v139
    v_add_f32 v134, v134, v140
    v_add_f32 v135, v135, v141
    v_cvt_pk_bf16_f32 v136, v128, v129
    v_cvt_pk_bf16_f32 v137, v130, v131
    v_cvt_pk_bf16_f32 v138, v132, v133
    v_cvt_pk_bf16_f32 v139, v134, v135
    s_add_u32 s23, s42, 0xb00000
    s_cmp_lg_u32 s61, 0
    s_cbranch_scc1 HS11_f
    buffer_store_dwordx4 v[136:139], v2, s[8:11], s23 offen sc0 sc1
    s_branch HS11_e
HS11_f:
    buffer_store_dwordx4 v[136:139], v2, s[8:11], s23 offen
HS11_e:
    v_accvgpr_write_b32 a32, v136
    v_accvgpr_write_b32 a33, v137
    v_accvgpr_write_b32 a34, v138
    v_accvgpr_write_b32 a35, v139
    s_waitcnt vmcnt(0)
    s_barrier
    s_cmp_lg_u32 s3, 0
    s_cbranch_scc1 F1_p2_np
    v_mov_b32 v5, 6
    v_mov_b32 v6, 0
    v_cmp_eq_u32 vcc, 0, v1
    s_and_saveexec_b64 s[38:39], vcc
    s_cmp_lg_u32 s61, 0
    s_cbranch_scc1 HS12_f
    buffer_store_dword v5, v6, s[8:11], s40 offen sc0 sc1
    s_branch HS12_e
HS12_f:
    buffer_store_dword v5, v6, s[8:11], s40 offen
HS12_e:
    s_mov_b64 exec, s[38:39]
F1_p2_np:
    s_add_u32 s20, s53, 0xb00000
    s_add_u32 s21, s20, 32768
    v_mov_b32 v6, 0
    s_mov_b32 s37, 0
F1_w2_poll:
    buffer_load_dword v5, v6, s[8:11], s41 offen sc0 sc1
    s_waitcnt vmcnt(0)
    v_readfirstlane_b32 s36, v5
    s_add_u32 s37, s37, 1
    s_cmp_ge_u32 s36, 6
    s_cbranch_scc1 F1_w2_go
    s_cmp_gt_u32 s37, 200000
    s_cbranch_scc1 F1_w2_go
    s_sleep 1
    s_branch F1_w2_poll
F1_w2_go:
    buffer_load_dwordx4 v[32:35], v2, s[8:11], s20 offen offset:0 sc1
    buffer_load_dwordx4 v[36:39], v2, s[8:11], s20 offen offset:1024 sc1
    buffer_load_dwordx4 v[40:43], v2, s[8:11], s20 offen offset:2048 sc1
    buffer_load_dwordx4 v[44:47], v2, s[8:11], s20 offen offset:3072 sc1
    buffer_load_dwordx4 v[48:51], v2, s[8:11], s21 offen offset:0 sc1
    buffer_load_dwordx4 v[52:55], v2, s[8:11], s21 offen offset:1024 sc1
    buffer_load_dwordx4 v[56:59], v2, s[8:11], s21 offen offset:2048 sc1
    buffer_load_dwordx4 v[60:63], v2, s[8:11], s21 offen offset:3072 sc1
    v_lshlrev_b32 v7, 4, v4
    s_lshl_b32 s27, s51, 7
    s_add_u32 s27, s27, 0x488800
    buffer_load_dwordx4 v[88:91], v7, s[8:11], s27 offen offset:0
    buffer_load_dwordx4 v[92:95], v7, s[8:11], s27 offen offset:32
    buffer_load_dwordx4 v[96:99], v7, s[8:11], s27 offen offset:64
    buffer_load_dwordx4 v[100:103], v7, s[8:11], s27 offen offset:96
    s_lshl_b32 s21, s3, 12
    v_add_u32 v5, s21, v2
    s_mov_b32 s28, 0x3f803f80
    v_mov_b32 v80, 0
    v_mov_b32 v81, 0
    v_mov_b32 v82, 0
    v_mov_b32 v83, 0
    v_mov_b32 v84, 0
    v_mov_b32 v85, 0
    v_mov_b32 v86, 0
    v_mov_b32 v87, 0
    s_waitcnt vmcnt(8)
    ds_write_b128 v5, v[32:35] offset:0
    ds_write_b128 v5, v[36:39] offset:1024
    ds_write_b128 v5, v[40:43] offset:2048
    ds_write_b128 v5, v[44:47] offset:3072
    v_dot2_f32_bf16 v80, v32, s28, v80
    v_dot2_f32_bf16 v81, v32, v32, v81
    v_dot2_f32_bf16 v84, v33, s28, v84
    v_dot2_f32_bf16 v85, v33, v33, v85
    v_dot2_f32_bf16 v80, v34, s28, v80
    v_dot2_f32_bf16 v81, v34, v34, v81
    v_dot2_f32_bf16 v84, v35, s28, v84
    v_dot2_f32_bf16 v85, v35, v35, v85
    v_dot2_f32_bf16 v80, v36, s28, v80
    v_dot2_f32_bf16 v81, v36, v36, v81
    v_dot2_f32_bf16 v84, v37, s28, v84
    v_dot2_f32_bf16 v85, v37, v37, v85
    v_dot2_f32_bf16 v80, v38, s28, v80
    v_dot2_f32_bf16 v81, v38, v38, v81
    v_dot2_f32_bf16 v84, v39, s28, v84
    v_dot2_f32_bf16 v85, v39, v39, v85
    v_dot2_f32_bf16 v80, v40, s28, v80
    v_dot2_f32_bf16 v81, v40, v40, v81
    v_dot2_f32_bf16 v84, v41, s28, v84
    v_dot2_f32_bf16 v85, v41, v41, v85
    v_dot2_f32_bf16 v80, v42, s28, v80
    v_dot2_f32_bf16 v81, v42, v42, v81
    v_dot2_f32_bf16 v84, v43, s28, v84
    v_dot2_f32_bf16 v85, v43, v43, v85
    v_dot2_f32_bf16 v80, v44, s28, v80
    v_dot2_f32_bf16 v81, v44, v44, v81
    v_dot2_f32_bf16 v84, v45, s28, v84
    v_dot2_f32_bf16 v85, v45, v45, v85
    v_dot2_f32_bf16 v80, v46, s28, v80
    v_dot2_f32_bf16 v81, v46, v46, v81
    v_dot2_f32_bf16 v84, v47, s28, v84
    v_dot2_f32_bf16 v85, v47, v47, v85
    s_waitcnt vmcnt(4)
    ds_write_b128 v5, v[48:51] offset:32768
    ds_write_b128 v5, v[52:55] offset:33792
    ds_write_b128 v5, v[56:59] offset:34816
    ds_write_b128 v5, v[60:63] offset:35840
    v_dot2_f32_bf16 v82, v48, s28, v82
    v_dot2_f32_bf16 v83, v48, v48, v83
    v_dot2_f32_bf16 v86, v49, s28, v86
    v_dot2_f32_bf16 v87, v49, v49, v87
    v_dot2_f32_bf16 v82, v50, s28, v82
    v_dot2_f32_bf16 v83, v50, v50, v83
    v_dot2_f32_bf16 v86, v51, s28, v86
    v_dot2_f32_bf16 v87, v51, v51, v87
    v_dot2_f32_bf16 v82, v52, s28, v82
    v_dot2_f32_bf16 v83, v52, v52, v83
    v_dot2_f32_bf16 v86, v53, s28, v86
    v_dot2_f32_bf16 v87, v53, v53, v87
    v_dot2_f32_bf16 v82, v54, s28, v82
    v_dot2_f32_bf16 v83, v54, v54, v83
    v_dot2_f32_bf16 v86, v55, s28, v86
    v_dot2_f32_bf16 v87, v55, v55, v87
    v_dot2_f32_bf16 v82, v56, s28, v82
    v_dot2_f32_bf16 v83, v56, v56, v83
    v_dot2_f32_bf16 v86, v57, s28, v86
    v_dot2_f32_bf16 v87, v57, v57, v87
    v_dot2_f32_bf16 v82, v58, s28, v82
    v_dot2_f32_bf16 v83, v58, v58, v83
    v_dot2_f32_bf16 v86, v59, s28, v86
    v_dot2_f32_bf16 v87, v59, v59, v87
    v_dot2_f32_bf16 v82, v60, s28, v82
    v_dot2_f32_bf16 v83, v60, v60, v83
    v_dot2_f32_bf16 v86, v61, s28, v86
    v_dot2_f32_bf16 v87, v61, v61, v87
    v_dot2_f32_bf16 v82, v62, s28, v82
    v_dot2_f32_bf16 v83, v62, v62, v83
    v_dot2_f32_bf16 v86, v63, s28, v86
    v_dot2_f32_bf16 v87, v63, v63, v87
    s_lshl_b32 s21, s3, 10
    s_add_u32 s21, s21, 65536
    v_add_u32 v5, s21, v2
    s_nop 1
    v_add_f32 v80, v80, v84
    v_add_f32 v81, v81, v85
    v_add_f32 v82, v82, v86
    v_add_f32 v83, v83, v87
    ds_write_b128 v5, v[80:83]
    s_waitcnt lgkmcnt(0)
    s_barrier
    s_lshl_b32 s32, s5, 1
    s_mul_i32 s54, s32, 112
    s_mul_i32 s33, s3, 14
    s_add_u32 s54, s54, s33
    s_lshl_b32 s54, s54, 10
    s_add_u32 s54, s54, 0x2c0000
    s_add_u32 s55, s54, 114688
    s_cmp_eq_u32 s3, 7
    s_cbranch_scc1 F1_cskip
    ds_read_b128 v[32:35], v2 offset:0
    ds_read_b128 v[36:39], v2 offset:32768
    ds_read_b128 v[40:43], v2 offset:1024
    ds_read_b128 v[44:47], v2 offset:33792
    ds_read_b128 v[48:51], v2 offset:2048
    ds_read_b128 v[52:55], v2 offset:34816
    ds_read_b128 v[56:59], v2 offset:3072
    ds_read_b128 v[60:63], v2 offset:35840
    ds_read_b128 v[64:67], v2 offset:4096
    ds_read_b128 v[68:71], v2 offset:36864
    ds_read_b128 v[72:75], v2 offset:5120
    ds_read_b128 v[76:79], v2 offset:37888
    s_waitcnt lgkmcnt(10)
    v_mfma_f32_32x32x16_bf16 v[104:119], a[36:39], v[32:35], 0
    v_mfma_f32_32x32x16_bf16 v[120:135], a[36:39], v[36:39], 0
    ds_read_b128 v[32:35], v2 offset:6144
    ds_read_b128 v[36:39], v2 offset:38912
    s_waitcnt lgkmcnt(10)
    v_mfma_f32_32x32x16_bf16 v[104:119], a[40:43], v[40:43], v[104:119]
    v_mfma_f32_32x32x16_bf16 v[120:135], a[40:43], v[44:47], v[120:135]
    buffer_load_dwordx4 a[36:39], v2, s[8:11], s54 offen offset:0
    ds_read_b128 v[40:43], v2 offset:7168
    ds_read_b128 v[44:47], v2 offset:39936
    s_waitcnt lgkmcnt(10)
    v_mfma_f32_32x32x16_bf16 v[104:119], a[44:47], v[48:51], v[104:119]
    v_mfma_f32_32x32x16_bf16 v[120:135], a[44:47], v[52:55], v[120:135]
    buffer_load_dwordx4 a[40:43], v2, s[8:11], s55 offen offset:0
    ds_read_b128 v[48:51], v2 offset:8192
    ds_read_b128 v[52:55], v2 offset:40960
    s_waitcnt lgkmcnt(10)
    v_mfma_f32_32x32x16_bf16 v[104:119], a[48:51], v[56:59], v[104:119]
    v_mfma_f32_32x32x16_bf16 v[120:135], a[48:51], v[60:63], v[120:135]
    buffer_load_dwordx4 a[44:47], v2, s[8:11], s54 offen offset:1024
    ds_read_b128 v[56:59], v2 offset:9216
    ds_read_b128 v[60:63], v2 offset:41984
    s_waitcnt lgkmcnt(10)
    v_mfma_f32_32x32x16_bf16 v[104:119], a[52:55], v[64:67], v[104:119]
    v_mfma_f32_32x32x16_bf16 v[120:135], a[52:55], v[68:71], v[120:135]
    buffer_load_dwordx4 a[48:51], v2, s[8:11], s55 offen offset:1024
    ds_read_b128 v[64:67], v2 offset:10240
    ds_read_b128 v[68:71], v2 offset:43008
    s_waitcnt lgkmcnt(10)
    v_mfma_f32_32x32x16_bf16 v[104:119], a[56:59], v[72:75], v[104:119]
    v_mfma_f32_32x32x16_bf16 v[120:135], a[56:59], v[76:79], v[120:135]
    buffer_load_dwordx4 a[52:55], v2, s[8:11], s54 offen offset:2048
    ds_read_b128 v[72:75], v2 offset:11264
    ds_read_b128 v[76:79], v2 offset:44032
    s_waitcnt lgkmcnt(10)
    v_mfma_f32_32x32x16_bf16 v[104:119], a[60:63], v[32:35], v[104:119]
    v_mfma_f32_32x32x16_bf16 v[120:135], a[60:63], v[36:39], v[120:135]
    buffer_load_dwordx4 a[56:59], v2, s[8:11], s55 offen offset:2048
    ds_read_b128 v[32:35], v2 offset:12288
    ds_read_b128 v[36:39], v2 offset:45056
    s_waitcnt lgkmcnt(10)
    v_mfma_f32_32x32x16_bf16 v[104:119], a[64:67], v[40:43], v[104:119]
    v_mfma_f32_32x32x16_bf16 v[120:135], a[64:67], v[44:47], v[120:135]
    buffer_load_dwordx4 a[60:63], v2, s[8:11], s54 offen offset:3072
    ds_read_b128 v[40:43], v2 offset:13312
    ds_read_b128 v[44:47], v2 offset:46080
    s_waitcnt lgkmcnt(10)
    v_mfma_f32_32x32x16_bf16 v[104:119], a[68:71], v[48:51], v[104:119]
    v_mfma_f32_32x32x16_bf16 v[120:135], a[68:71], v[52:55], v[120:135]
    buffer_load_dwordx4 a[64:67], v2, s[8:11], s55 offen offset:3072
    ds_read_b128 v[48:51], v2 offset:14336
    ds_read_b128 v[52:55], v2 offset:47104
    s_waitcnt lgkmcnt(10)
    v_mfma_f32_32x32x16_bf16 v[104:119], a[72:75], v[56:59], v[104:119]
    v_mfma_f32_32x32x16_bf16 v[120:135], a[72:75], v[60:63], v[120:135]
    s_add_u32 s33, s54, 4096
    buffer_load_dwordx4 a[68:71], v2, s[8:11], s33 offen offset:0
    ds_read_b128 v[56:59], v2 offset:15360
    ds_read_b128 v[60:63], v2 offset:48128
    s_waitcnt lgkmcnt(10)
    v_mfma_f32_32x32x16_bf16 v[104:119], a[76:79], v[64:67], v[104:119]
    v_mfma_f32_32x32x16_bf16 v[120:135], a[76:79], v[68:71], v[120:135]
    s_add_u32 s33, s55, 4096
    buffer_load_dwordx4 a[72:75], v2, s[8:11], s33 offen offset:0
    ds_read_b128 v[64:67], v2 offset:16384
    ds_read_b128 v[68:71], v2 offset:49152
    s_waitcnt lgkmcnt(10)
    v_mfma_f32_32x32x16_bf16 v[104:119], a[80:83], v[72:75], v[104:119]
    v_mfma_f32_32x32x16_bf16 v[120:135], a[80:83], v[76:79], v[120:135]
    s_add_u32 s33, s54, 4096
    buffer_load_dwordx4 a[76:79], v2, s[8:11], s33 offen offset:1024
    ds_read_b128 v[72:75], v2 offset:17408
    ds_read_b128 v[76:79], v2 offset:50176
    s_waitcnt lgkmcnt(10)
    v_mfma_f32_32x32x16_bf16 v[104:119], a[84:87], v[32:35], v[104:119]
    v_mfma_f32_32x32x16_bf16 v[120:135], a[84:87], v[36:39], v[120:135]
    s_add_u32 s33, s55, 4096
    buffer_load_dwordx4 a[80:83], v2, s[8:11], s33 offen offset:1024
    ds_read_b128 v[32:35], v2 offset:18432
    ds_read_b128 v[36:39], v2 offset:51200
    s_waitcnt lgkmcnt(10)
    v_mfma_f32_32x32x16_bf16 v[104:119], a[88:91], v[40:43], v[104:119]
    v_mfma_f32_32x32x16_bf16 v[120:135], a[88:91], v[44:47], v[120:135]
    s_add_u32 s33, s54, 4096
    buffer_load_dwordx4 a[84:87], v2, s[8:11], s33 offen offset:2048
    ds_read_b128 v[40:43], v2 offset:19456
    ds_read_b128 v[44:47], v2 offset:52224
    s_waitcnt lgkmcnt(10)
    v_mfma_f32_32x32x16_bf16 v[104:119], a[92:95], v[48:51], v[104:119]
    v_mfma_f32_32x32x16_bf16 v[120:135], a[92:95], v[52:55], v[120:135]
    s_add_u32 s33, s55, 4096
    buffer_load_dwordx4 a[88:91], v2, s[8:11], s33 offen offset:2048
    ds_read_b128 v[48:51], v2 offset:20480
    ds_read_b128 v[52:55], v2 offset:53248
    s_waitcnt lgkmcnt(10)
    v_mfma_f32_32x32x16_bf16 v[104:119], a[0:3], v[56:59], v[104:119]
    v_mfma_f32_32x32x16_bf16 v[120:135], a[0:3], v[60:63], v[120:135]
    s_add_u32 s33, s54, 4096
    buffer_load_dwordx4 a[92:95], v2, s[8:11], s33 offen offset:3072
    ds_read_b128 v[56:59], v2 offset:21504
    ds_read_b128 v[60:63], v2 offset:54272
    s_waitcnt lgkmcnt(10)
    v_mfma_f32_32x32x16_bf16 v[104:119], a[4:7], v[64:67], v[104:119]
    v_mfma_f32_32x32x16_bf16 v[120:135], a[4:7], v[68:71], v[120:135]
    s_add_u32 s33, s55, 4096
    buffer_load_dwordx4 a[0:3], v2, s[8:11], s33 offen offset:3072
    ds_read_b128 v[64:67], v2 offset:22528
    ds_read_b128 v[68:71], v2 offset:55296
    s_waitcnt lgkmcnt(10)
    v_mfma_f32_32x32x16_bf16 v[104:119], a[8:11], v[72:75], v[104:119]
    v_mfma_f32_32x32x16_bf16 v[120:135], a[8:11], v[76:79], v[120:135]
    s_add_u32 s33, s54, 8192
    buffer_load_dwordx4 a[4:7], v2, s[8:11], s33 offen offset:0
    ds_read_b128 v[72:75], v2 offset:23552
    ds_read_b128 v[76:79], v2 offset:56320
    s_waitcnt lgkmcnt(10)
    v_mfma_f32_32x32x16_bf16 v[104:119], a[12:15], v[32:35], v[104:119]
    v_mfma_f32_32x32x16_bf16 v[120:135], a[12:15], v[36:39], v[120:135]
    s_add_u32 s33, s55, 8192
    buffer_load_dwordx4 a[8:11], v2, s[8:11], s33 offen offset:0
    ds_read_b128 v[32:35], v2 offset:24576
    ds_read_b128 v[36:39], v2 offset:57344
    s_waitcnt lgkmcnt(10)
    v_mfma_f32_32x32x16_bf16 v[104:119], a[16:19], v[40:43], v[104:119]
    v_mfma_f32_32x32x16_bf16 v[120:135], a[16:19], v[44:47], v[120:135]
    s_add_u32 s33, s54, 8192
    buffer_load_dwordx4 a[12:15], v2, s[8:11], s33 offen offset:1024
    ds_read_b128 v[40:43], v2 offset:25600
    ds_read_b128 v[44:47], v2 offset:58368
    s_waitcnt lgkmcnt(10)
    v_mfma_f32_32x32x16_bf16 v[104:119], a[20:23], v[48:51], v[104:119]
    v_mfma_f32_32x32x16_bf16 v[120:135], a[20:23], v[52:55], v[120:135]
    s_add_u32 s33, s55, 8192
    buffer_load_dwordx4 a[16:19], v2, s[8:11], s33 offen offset:1024
    ds_read_b128 v[48:51], v2 offset:26624
    ds_read_b128 v[52:55], v2 offset:59392
    s_waitcnt lgkmcnt(10)
    v_mfma_f32_32x32x16_bf16 v[104:119], a[24:27], v[56:59], v[104:119]
    v_mfma_f32_32x32x16_bf16 v[120:135], a[24:27], v[60:63], v[120:135]
    s_add_u32 s33, s54, 8192
    buffer_load_dwordx4 a[20:23], v2, s[8:11], s33 offen offset:2048
    ds_read_b128 v[56:59], v2 offset:27648
    ds_read_b128 v[60:63], v2 offset:60416
    s_waitcnt lgkmcnt(10)
    v_mfma_f32_32x32x16_bf16 v[104:119], a[28:31], v[64:67], v[104:119]
    v_mfma_f32_32x32x16_bf16 v[120:135], a[28:31], v[68:71], v[120:135]
    s_add_u32 s33, s55, 8192
    buffer_load_dwordx4 a[24:27], v2, s[8:11], s33 offen offset:2048
    ds_read_b128 v[64:67], v2 offset:28672
    ds_read_b128 v[68:71], v2 offset:61440
    s_waitcnt lgkmcnt(10)
    v_mfma_f32_32x32x16_bf16 v[104:119], v[16:19], v[72:75], v[104:119]
    v_mfma_f32_32x32x16_bf16 v[120:135], v[16:19], v[76:79], v[120:135]
    s_add_u32 s33, s54, 8192
    buffer_load_dwordx4 a[28:31], v2, s[8:11], s33 offen offset:3072
    ds_read_b128 v[72:75], v2 offset:29696
    ds_read_b128 v[76:79], v2 offset:62464
    s_waitcnt lgkmcnt(10)
    v_mfma_f32_32x32x16_bf16 v[104:119], v[20:23], v[32:35], v[104:119]
    v_mfma_f32_32x32x16_bf16 v[120:135], v[20:23], v[36:39], v[120:135]
    ds_read_b128 v[32:35], v2 offset:30720
    ds_read_b128 v[36:39], v2 offset:63488
    s_waitcnt lgkmcnt(10)
    v_mfma_f32_32x32x16_bf16 v[104:119], v[24:27], v[40:43], v[104:119]
    v_mfma_f32_32x32x16_bf16 v[120:135], v[24:27], v[44:47], v[120:135]
    ds_read_b128 v[40:43], v2 offset:31744
    ds_read_b128 v[44:47], v2 offset:64512
    s_waitcnt lgkmcnt(10)
    v_mfma_f32_32x32x16_bf16 v[104:119], v[28:31], v[48:51], v[104:119]
    v_mfma_f32_32x32x16_bf16 v[120:135], v[28:31], v[52:55], v[120:135]
    s_waitcnt lgkmcnt(8)
    v_mfma_f32_32x32x16_bf16 v[104:119], v[8:11], v[56:59], v[104:119]
    v_mfma_f32_32x32x16_bf16 v[120:135], v[8:11], v[60:63], v[120:135]
    s_waitcnt lgkmcnt(6)
    v_mfma_f32_32x32x16_bf16 v[104:119], v[12:15], v[64:67], v[104:119]
    v_mfma_f32_32x32x16_bf16 v[120:135], v[12:15], v[68:71], v[120:135]
    s_waitcnt lgkmcnt(4)
    v_mfma_f32_32x32x16_bf16 v[104:119], v[144:147], v[72:75], v[104:119]
    v_mfma_f32_32x32x16_bf16 v[120:135], v[144:147], v[76:79], v[120:135]
    s_waitcnt lgkmcnt(2)
    v_mfma_f32_32x32x16_bf16 v[104:119], v[148:151], v[32:35], v[104:119]
    v_mfma_f32_32x32x16_bf16 v[120:135], v[148:151], v[36:39], v[120:135]
    s_waitcnt lgkmcnt(0)
    v_mfma_f32_32x32x16_bf16 v[104:119], v[152:155], v[40:43], v[104:119]
    v_mfma_f32_32x32x16_bf16 v[120:135], v[152:155], v[44:47], v[120:135]
    s_branch F1_cepi
F1_cskip:
    buffer_load_dwordx4 a[36:39], v2, s[8:11], s54 offen offset:0
    buffer_load_dwordx4 a[40:43], v2, s[8:11], s55 offen offset:0
    buffer_load_dwordx4 a[44:47], v2, s[8:11], s54 offen offset:1024
    buffer_load_dwordx4 a[48:51], v2, s[8:11], s55 offen offset:1024
    buffer_load_dwordx4 a[52:55], v2, s[8:11], s54 offen offset:2048
    buffer_load_dwordx4 a[56:59], v2, s[8:11], s55 offen offset:2048
    buffer_load_dwordx4 a[60:63], v2, s[8:11], s54 offen offset:3072
    buffer_load_dwordx4 a[64:67], v2, s[8:11], s55 offen offset:3072
    s_add_u32 s33, s54, 4096
    buffer_load_dwordx4 a[68:71], v2, s[8:11], s33 offen offset:0
    s_add_u32 s33, s55, 4096
    buffer_load_dwordx4 a[72:75], v2, s[8:11], s33 offen offset:0
    s_add_u32 s33, s54, 4096
    buffer_load_dwordx4 a[76:79], v2, s[8:11], s33 offen offset:1024
    s_add_u32 s33, s55, 4096
    buffer_load_dwordx4 a[80:83], v2, s[8:11], s33 offen offset:1024
    s_add_u32 s33, s54, 4096
    buffer_load_dwordx4 a[84:87], v2, s[8:11], s33 offen offset:2048
    s_add_u32 s33, s55, 4096
    buffer_load_dwordx4 a[88:91], v2, s[8:11], s33 offen offset:2048
    s_add_u32 s33, s54, 4096
    buffer_load_dwordx4 a[92:95], v2, s[8:11], s33 offen offset:3072
    s_add_u32 s33, s55, 4096
    buffer_load_dwordx4 a[0:3], v2, s[8:11], s33 offen offset:3072
    s_add_u32 s33, s54, 8192
    buffer_load_dwordx4 a[4:7], v2, s[8:11], s33 offen offset:0
    s_add_u32 s33, s55, 8192
    buffer_load_dwordx4 a[8:11], v2, s[8:11], s33 offen offset:0
    s_add_u32 s33, s54, 8192
    buffer_load_dwordx4 a[12:15], v2, s[8:11], s33 offen offset:1024
    s_add_u32 s33, s55, 8192
    buffer_load_dwordx4 a[16:19], v2, s[8:11], s33 offen offset:1024
    s_add_u32 s33, s54, 8192
    buffer_load_dwordx4 a[20:23], v2, s[8:11], s33 offen offset:2048
    s_add_u32 s33, s55, 8192
    buffer_load_dwordx4 a[24:27], v2, s[8:11], s33 offen offset:2048
    s_add_u32 s33, s54, 8192
    buffer_load_dwordx4 a[28:31], v2, s[8:11], s33 offen offset:3072
F1_cepi:
    s_cmp_eq_u32 s3, 7
    s_cbranch_scc1 F1_cdone
    v_add_u32 v5, 65536, v2
    ds_read_b128 v[32:35], v5 offset:0
    ds_read_b128 v[36:39], v5 offset:1024
    ds_read_b128 v[40:43], v5 offset:2048
    ds_read_b128 v[44:47], v5 offset:3072
    ds_read_b128 v[48:51], v5 offset:4096
    ds_read_b128 v[52:55], v5 offset:5120
    ds_read_b128 v[56:59], v5 offset:6144
    ds_read_b128 v[60:63], v5 offset:7168
    s_waitcnt vmcnt(23) lgkmcnt(0)
    v_add_f32 v32, v32, v36
    v_add_f32 v33, v33, v37
    v_add_f32 v34, v34, v38
    v_add_f32 v35, v35, v39
    v_add_f32 v32, v32, v40
    v_add_f32 v33, v33, v41
    v_add_f32 v34, v34, v42
    v_add_f32 v35, v35, v43
    v_add_f32 v32, v32, v44
    v_add_f32 v33, v33, v45
    v_add_f32 v34, v34, v46
    v_add_f32 v35, v35, v47
    v_add_f32 v32, v32, v48
    v_add_f32 v33, v33, v49
    v_add_f32 v34, v34, v50
    v_add_f32 v35, v35, v51
    v_add_f32 v32, v32, v52
    v_add_f32 v33, v33, v53
    v_add_f32 v34, v34, v54
    v_add_f32 v35, v35, v55
    v_add_f32 v32, v32, v56
    v_add_f32 v33, v33, v57
    v_add_f32 v34, v34, v58
    v_add_f32 v35, v35, v59
    v_add_f32 v32, v32, v60
    v_add_f32 v33, v33, v61
    v_add_f32 v34, v34, v62
    v_add_f32 v35, v35, v63
    v_mov_b32 v36, v32
    s_nop 1
    v_permlane32_swap_b32 v32, v36
    s_nop 0
    v_add_f32 v32, v32, v36
    v_mov_b32 v36, v33
    s_nop 1
    v_permlane32_swap_b32 v33, v36
    s_nop 0
    v_add_f32 v33, v33, v36
    v_mov_b32 v36, v34
    s_nop 1
    v_permlane32_swap_b32 v34, v36
    s_nop 0
    v_add_f32 v34, v34, v36
    v_mov_b32 v36, v35
    s_nop 1
    v_permlane32_swap_b32 v35, v36
    s_nop 0
    v_add_f32 v35, v35, v36
    v_mul_f32 v32, 0x3b000000, v32
    v_mul_f32 v33, 0x3b000000, v33
    v_fma_f32 v33, -v32, v32, v33
    v_max_f32 v33, 0, v33
    v_add_f32 v33, 0x3727c5ac, v33
    v_rsq_f32 v8, v33
    s_nop 0
    v_mul_f32 v9, v32, v8
    v_sub_f32 v9, 0, v9
    v_mul_f32 v34, 0x3b000000, v34
    v_mul_f32 v35, 0x3b000000, v35
    v_fma_f32 v35, -v34, v34, v35
    v_max_f32 v35, 0, v35
    v_add_f32 v35, 0x3727c5ac, v35
    v_rsq_f32 v10, v35
    s_nop 0
    v_mul_f32 v11, v34, v10
    v_sub_f32 v11, 0, v11
    v_mul_f32 v40, v9, v88
    v_fma_f32 v104, v104, v8, v40
    v_mul_f32 v41, v9, v89
    v_fma_f32 v105, v105, v8, v41
    v_mul_f32 v42, v9, v90
    v_fma_f32 v106, v106, v8, v42
    v_mul_f32 v43, v9, v91
    v_fma_f32 v107, v107, v8, v43
    v_mul_f32 v44, v9, v92
    v_fma_f32 v108, v108, v8, v44
    v_mul_f32 v45, v9, v93
    v_fma_f32 v109, v109, v8, v45
    v_mul_f32 v46, v9, v94
    v_fma_f32 v110, v110, v8, v46
    v_mul_f32 v47, v9, v95
    v_fma_f32 v111, v111, v8, v47
    v_mul_f32 v48, v9, v96
    v_fma_f32 v112, v112, v8, v48
    v_mul_f32 v49, v9, v97
    v_fma_f32 v113, v113, v8, v49
    v_mul_f32 v50, v9, v98
    v_fma_f32 v114, v114, v8, v50
    v_mul_f32 v51, v9, v99
    v_fma_f32 v115, v115, v8, v51
    v_mul_f32 v52, v9, v100
    v_fma_f32 v116, v116, v8, v52
    v_mul_f32 v53, v9, v101
    v_fma_f32 v117, v117, v8, v53
    v_mul_f32 v54, v9, v102
    v_fma_f32 v118, v118, v8, v54
    v_mul_f32 v55, v9, v103
    v_fma_f32 v119, v119, v8, v55
    v_cvt_pk_bf16_f32 v16, v104, v105
    v_cvt_pk_bf16_f32 v17, v106, v107
    v_cvt_pk_bf16_f32 v18, v108, v109
    v_cvt_pk_bf16_f32 v19, v110, v111
    v_cvt_pk_bf16_f32 v20, v112, v113
    v_cvt_pk_bf16_f32 v21, v114, v115
    v_cvt_pk_bf16_f32 v22, v116, v117
    v_cvt_pk_bf16_f32 v23, v118, v119
    v_pk_max_i16 v16, v16, 0
    v_pk_max_i16 v17, v17, 0
    v_pk_max_i16 v18, v18, 0
    v_pk_max_i16 v19, v19, 0
    v_pk_max_i16 v20, v20, 0
    v_pk_max_i16 v21, v21, 0
    v_pk_max_i16 v22, v22, 0
    v_pk_max_i16 v23, v23, 0
    v_mul_f32 v40, v11, v88
    v_fma_f32 v120, v120, v10, v40
    v_mul_f32 v41, v11, v89
    v_fma_f32 v121, v121, v10, v41
    v_mul_f32 v42, v11, v90
    v_fma_f32 v122, v122, v10, v42
    v_mul_f32 v43, v11, v91
    v_fma_f32 v123, v123, v10, v43
    v_mul_f32 v44, v11, v92
    v_fma_f32 v124, v124, v10, v44
    v_mul_f32 v45, v11, v93
    v_fma_f32 v125, v125, v10, v45
    v_mul_f32 v46, v11, v94
    v_fma_f32 v126, v126, v10, v46
    v_mul_f32 v47, v11, v95
    v_fma_f32 v127, v127, v10, v47
    v_mul_f32 v48, v11, v96
    v_fma_f32 v128, v128, v10, v48
    v_mul_f32 v49, v11, v97
    v_fma_f32 v129, v129, v10, v49
    v_mul_f32 v50, v11, v98
    v_fma_f32 v130, v130, v10, v50
    v_mul_f32 v51, v11, v99
    v_fma_f32 v131, v131, v10, v51
    v_mul_f32 v52, v11, v100
    v_fma_f32 v132, v132, v10, v52
    v_mul_f32 v53, v11, v101
    v_fma_f32 v133, v133, v10, v53
    v_mul_f32 v54, v11, v102
    v_fma_f32 v134, v134, v10, v54
    v_mul_f32 v55, v11, v103
    v_fma_f32 v135, v135, v10, v55
    v_cvt_pk_bf16_f32 v24, v120, v121
    v_cvt_pk_bf16_f32 v25, v122, v123
    v_cvt_pk_bf16_f32 v26, v124, v125
    v_cvt_pk_bf16_f32 v27, v126, v127
    v_cvt_pk_bf16_f32 v28, v128, v129
    v_cvt_pk_bf16_f32 v29, v130, v131
    v_cvt_pk_bf16_f32 v30, v132, v133
    v_cvt_pk_bf16_f32 v31, v134, v135
    v_pk_max_i16 v24, v24, 0
    v_pk_max_i16 v25, v25, 0
    v_pk_max_i16 v26, v26, 0
    v_pk_max_i16 v27, v27, 0
    v_pk_max_i16 v28, v28, 0
    v_pk_max_i16 v29, v29, 0
    v_pk_max_i16 v30, v30, 0
    v_pk_max_i16 v31, v31, 0
    s_lshl_b32 s26, s4, 1
    s_mul_i32 s26, s26, 112
    s_lshl_b32 s27, s51, 1
    s_add_u32 s26, s26, s27
    s_lshl_b32 s26, s26, 10
    s_add_u32 s26, s26, 0x1000000
    s_add_u32 s27, s26, 114688
    s_cmp_lg_u32 s61, 0
    s_cbranch_scc1 HS13_f
    buffer_store_dwordx4 v[16:19], v2, s[8:11], s26 offen sc0 sc1
    buffer_store_dwordx4 v[20:23], v2, s[8:11], s26 offen offset:1024 sc0 sc1
    buffer_store_dwordx4 v[24:27], v2, s[8:11], s27 offen sc0 sc1
    buffer_store_dwordx4 v[28:31], v2, s[8:11], s27 offen offset:1024 sc0 sc1
    s_branch HS13_e
HS13_f:
    buffer_store_dwordx4 v[16:19], v2, s[8:11], s26 offen
    buffer_store_dwordx4 v[20:23], v2, s[8:11], s26 offen offset:1024
    buffer_store_dwordx4 v[24:27], v2, s[8:11], s27 offen
    buffer_store_dwordx4 v[28:31], v2, s[8:11], s27 offen offset:1024
HS13_e:
F1_cdone:
    s_waitcnt vmcnt(0)
    s_barrier
    s_cmp_lg_u32 s3, 0
    s_cbranch_scc1 F1_p3_np
    v_mov_b32 v5, 7
    v_mov_b32 v6, 0
    v_cmp_eq_u32 vcc, 0, v1
    s_and_saveexec_b64 s[38:39], vcc
    s_cmp_lg_u32 s61, 0
    s_cbranch_scc1 HS14_f
    buffer_store_dword v5, v6, s[8:11], s40 offen sc0 sc1
    s_branch HS14_e
HS14_f:
    buffer_store_dword v5, v6, s[8:11], s40 offen
HS14_e:
    s_mov_b64 exec, s[38:39]
F1_p3_np:
    s_lshl_b32 s20, s4, 1
    s_mul_i32 s20, s20, 112
    s_mul_i32 s21, s3, 14
    s_add_u32 s20, s20, s21
    s_lshl_b32 s20, s20, 10
    s_add_u32 s20, s20, 0x1000000
    s_add_u32 s21, s20, 114688
    v_mov_b32 v6, 0
    s_mov_b32 s37, 0
F1_w3_poll:
    buffer_load_dword v5, v6, s[8:11], s41 offen sc0 sc1
    s_waitcnt vmcnt(0)
    v_readfirstlane_b32 s36, v5
    s_add_u32 s37, s37, 1
    s_cmp_ge_u32 s36, 7
    s_cbranch_scc1 F1_w3_go
    s_cmp_gt_u32 s37, 200000
    s_cbranch_scc1 F1_w3_go
    s_sleep 1
    s_branch F1_w3_poll
F1_w3_go:
    buffer_load_dwordx4 v[8:11], v2, s[8:11], s20 offen offset:0 sc1
    buffer_load_dwordx4 v[12:15], v2, s[8:11], s21 offen offset:0 sc1
    buffer_load_dwordx4 v[16:19], v2, s[8:11], s20 offen offset:1024 sc1
    buffer_load_dwordx4 v[20:23], v2, s[8:11], s21 offen offset:1024 sc1
    buffer_load_dwordx4 v[24:27], v2, s[8:11], s20 offen offset:2048 sc1
    buffer_load_dwordx4 v[28:31], v2, s[8:11], s21 offen offset:2048 sc1
    buffer_load_dwordx4 v[32:35], v2, s[8:11], s20 offen offset:3072 sc1
    buffer_load_dwordx4 v[36:39], v2, s[8:11], s21 offen offset:3072 sc1
    s_add_u32 s33, s20, 4096
    buffer_load_dwordx4 v[40:43], v2, s[8:11], s33 offen offset:0 sc1
    s_add_u32 s33, s21, 4096
    buffer_load_dwordx4 v[44:47], v2, s[8:11], s33 offen offset:0 sc1
    s_add_u32 s33, s20, 4096
    buffer_load_dwordx4 v[48:51], v2, s[8:11], s33 offen offset:1024 sc1
    s_add_u32 s33, s21, 4096
    buffer_load_dwordx4 v[52:55], v2, s[8:11], s33 offen offset:1024 sc1
    s_add_u32 s33, s20, 4096
    buffer_load_dwordx4 v[56:59], v2, s[8:11], s33 offen offset:2048 sc1
    s_add_u32 s33, s21, 4096
    buffer_load_dwordx4 v[60:63], v2, s[8:11], s33 offen offset:2048 sc1
    s_add_u32 s33, s20, 4096
    buffer_load_dwordx4 v[64:67], v2, s[8:11], s33 offen offset:3072 sc1
    s_add_u32 s33, s21, 4096
    buffer_load_dwordx4 v[68:71], v2, s[8:11], s33 offen offset:3072 sc1
    s_add_u32 s33, s55, 8192
    buffer_load_dwordx4 v[136:139], v2, s[8:11], s33 offen offset:3072
    s_add_u32 s33, s54, 12288
    buffer_load_dwordx4 v[140:143], v2, s[8:11], s33 offen offset:0
    s_add_u32 s33, s55, 12288
    buffer_load_dwordx4 v[144:147], v2, s[8:11], s33 offen offset:0
    s_add_u32 s33, s54, 12288
    buffer_load_dwordx4 v[148:151], v2, s[8:11], s33 offen offset:1024
    s_add_u32 s33, s55, 12288
    buffer_load_dwordx4 v[152:155], v2, s[8:11], s33 offen offset:1024
    s_waitcnt vmcnt(19)
    v_mfma_f32_32x32x16_bf16 v[72:87], a[36:39], v[8:11], 0
    v_mfma_f32_32x32x16_bf16 v[88:103], a[36:39], v[12:15], 0
    v_mfma_f32_32x32x16_bf16 v[104:119], a[40:43], v[8:11], 0
    v_mfma_f32_32x32x16_bf16 v[120:135], a[40:43], v[12:15], 0
    s_add_u32 s33, s20, 8192
    buffer_load_dwordx4 v[8:11], v2, s[8:11], s33 offen offset:0 sc1
    s_add_u32 s33, s21, 8192
    buffer_load_dwordx4 v[12:15], v2, s[8:11], s33 offen offset:0 sc1
    s_waitcnt vmcnt(19)
    v_mfma_f32_32x32x16_bf16 v[72:87], a[44:47], v[16:19], v[72:87]
    v_mfma_f32_32x32x16_bf16 v[88:103], a[44:47], v[20:23], v[88:103]
    v_mfma_f32_32x32x16_bf16 v[104:119], a[48:51], v[16:19], v[104:119]
    v_mfma_f32_32x32x16_bf16 v[120:135], a[48:51], v[20:23], v[120:135]
    s_add_u32 s33, s20, 8192
    buffer_load_dwordx4 v[16:19], v2, s[8:11], s33 offen offset:1024 sc1
    s_add_u32 s33, s21, 8192
    buffer_load_dwordx4 v[20:23], v2, s[8:11], s33 offen offset:1024 sc1
    s_waitcnt vmcnt(19)
    v_mfma_f32_32x32x16_bf16 v[72:87], a[52:55], v[24:27], v[72:87]
    v_mfma_f32_32x32x16_bf16 v[88:103], a[52:55], v[28:31], v[88:103]
    v_mfma_f32_32x32x16_bf16 v[104:119], a[56:59], v[24:27], v[104:119]
    v_mfma_f32_32x32x16_bf16 v[120:135], a[56:59], v[28:31], v[120:135]
    s_add_u32 s33, s20, 8192
    buffer_load_dwordx4 v[24:27], v2, s[8:11], s33 offen offset:2048 sc1
    s_add_u32 s33, s21, 8192
    buffer_load_dwordx4 v[28:31], v2, s[8:11], s33 offen offset:2048 sc1
    s_waitcnt vmcnt(19)
    v_mfma_f32_32x32x16_bf16 v[72:87], a[60:63], v[32:35], v[72:87]
    v_mfma_f32_32x32x16_bf16 v[88:103], a[60:63], v[36:39], v[88:103]
    v_mfma_f32_32x32x16_bf16 v[104:119], a[64:67], v[32:35], v[104:119]
    v_mfma_f32_32x32x16_bf16 v[120:135], a[64:67], v[36:39], v[120:135]
    s_add_u32 s33, s20, 8192
    buffer_load_dwordx4 v[32:35], v2, s[8:11], s33 offen offset:3072 sc1
    s_add_u32 s33, s21, 8192
    buffer_load_dwordx4 v[36:39], v2, s[8:11], s33 offen offset:3072 sc1
    s_waitcnt vmcnt(19)
    v_mfma_f32_32x32x16_bf16 v[72:87], a[68:71], v[40:43], v[72:87]
    v_mfma_f32_32x32x16_bf16 v[88:103], a[68:71], v[44:47], v[88:103]
    v_mfma_f32_32x32x16_bf16 v[104:119], a[72:75], v[40:43], v[104:119]
    v_mfma_f32_32x32x16_bf16 v[120:135], a[72:75], v[44:47], v[120:135]
    s_add_u32 s33, s20, 12288
    buffer_load_dwordx4 v[40:43], v2, s[8:11], s33 offen offset:0 sc1
    s_add_u32 s33, s21, 12288
    buffer_load_dwordx4 v[44:47], v2, s[8:11], s33 offen offset:0 sc1
    s_waitcnt vmcnt(19)
    v_mfma_f32_32x32x16_bf16 v[72:87], a[76:79], v[48:51], v[72:87]
    v_mfma_f32_32x32x16_bf16 v[88:103], a[76:79], v[52:55], v[88:103]
    v_mfma_f32_32x32x16_bf16 v[104:119], a[80:83], v[48:51], v[104:119]
    v_mfma_f32_32x32x16_bf16 v[120:135], a[80:83], v[52:55], v[120:135]
    s_add_u32 s33, s20, 12288
    buffer_load_dwordx4 v[48:51], v2, s[8:11], s33 offen offset:1024 sc1
    s_add_u32 s33, s21, 12288
    buffer_load_dwordx4 v[52:55], v2, s[8:11], s33 offen offset:1024 sc1
    s_waitcnt vmcnt(19)
    v_mfma_f32_32x32x16_bf16 v[72:87], a[84:87], v[56:59], v[72:87]
    v_mfma_f32_32x32x16_bf16 v[88:103], a[84:87], v[60:63], v[88:103]
    v_mfma_f32_32x32x16_bf16 v[104:119], a[88:91], v[56:59], v[104:119]
    v_mfma_f32_32x32x16_bf16 v[120:135], a[88:91], v[60:63], v[120:135]
    s_waitcnt vmcnt(17)
    v_mfma_f32_32x32x16_bf16 v[72:87], a[92:95], v[64:67], v[72:87]
    v_mfma_f32_32x32x16_bf16 v[88:103], a[92:95], v[68:71], v[88:103]
    v_mfma_f32_32x32x16_bf16 v[104:119], a[0:3], v[64:67], v[104:119]
    v_mfma_f32_32x32x16_bf16 v[120:135], a[0:3], v[68:71], v[120:135]
    s_waitcnt vmcnt(10)
    v_mfma_f32_32x32x16_bf16 v[72:87], a[4:7], v[8:11], v[72:87]
    v_mfma_f32_32x32x16_bf16 v[88:103], a[4:7], v[12:15], v[88:103]
    v_mfma_f32_32x32x16_bf16 v[104:119], a[8:11], v[8:11], v[104:119]
    v_mfma_f32_32x32x16_bf16 v[120:135], a[8:11], v[12:15], v[120:135]
    s_waitcnt vmcnt(8)
    v_mfma_f32_32x32x16_bf16 v[72:87], a[12:15], v[16:19], v[72:87]
    v_mfma_f32_32x32x16_bf16 v[88:103], a[12:15], v[20:23], v[88:103]
    v_mfma_f32_32x32x16_bf16 v[104:119], a[16:19], v[16:19], v[104:119]
    v_mfma_f32_32x32x16_bf16 v[120:135], a[16:19], v[20:23], v[120:135]
    s_waitcnt vmcnt(6)
    v_mfma_f32_32x32x16_bf16 v[72:87], a[20:23], v[24:27], v[72:87]
    v_mfma_f32_32x32x16_bf16 v[88:103], a[20:23], v[28:31], v[88:103]
    v_mfma_f32_32x32x16_bf16 v[104:119], a[24:27], v[24:27], v[104:119]
    v_mfma_f32_32x32x16_bf16 v[120:135], a[24:27], v[28:31], v[120:135]
    s_waitcnt vmcnt(4)
    v_mfma_f32_32x32x16_bf16 v[72:87], a[28:31], v[32:35], v[72:87]
    v_mfma_f32_32x32x16_bf16 v[88:103], a[28:31], v[36:39], v[88:103]
    v_mfma_f32_32x32x16_bf16 v[104:119], v[136:139], v[32:35], v[104:119]
    v_mfma_f32_32x32x16_bf16 v[120:135], v[136:139], v[36:39], v[120:135]
    s_waitcnt vmcnt(2)
    v_mfma_f32_32x32x16_bf16 v[72:87], v[140:143], v[40:43], v[72:87]
    v_mfma_f32_32x32x16_bf16 v[88:103], v[140:143], v[44:47], v[88:103]
    v_mfma_f32_32x32x16_bf16 v[104:119], v[144:147], v[40:43], v[104:119]
    v_mfma_f32_32x32x16_bf16 v[120:135], v[144:147], v[44:47], v[120:135]
    s_waitcnt vmcnt(0)
    v_mfma_f32_32x32x16_bf16 v[72:87], v[148:151], v[48:51], v[72:87]
    v_mfma_f32_32x32x16_bf16 v[88:103], v[148:151], v[52:55], v[88:103]
    v_mfma_f32_32x32x16_bf16 v[104:119], v[152:155], v[48:51], v[104:119]
    v_mfma_f32_32x32x16_bf16 v[120:135], v[152:155], v[52:55], v[120:135]
    s_lshl_b32 s32, s3, 11
    v_add_u32 v5, s32, v2
    v_add_u32 v6, 0x10000, v5
    s_lshl_b32 s32, s3, 14
    v_add_u32 v7, s32, v2
    s_nop 11
    ds_write_b128 v5, v[72:75] offset:0
    ds_write_b128 v5, v[76:79] offset:1024
    ds_write_b128 v5, v[80:83] offset:16384
    ds_write_b128 v5, v[84:87] offset:17408
    ds_write_b128 v5, v[88:91] offset:32768
    ds_write_b128 v5, v[92:95] offset:33792
    ds_write_b128 v5, v[96:99] offset:49152
    ds_write_b128 v5, v[100:103] offset:50176
    ds_write_b128 v6, v[104:107] offset:0
    ds_write_b128 v6, v[108:111] offset:1024
    ds_write_b128 v6, v[112:115] offset:16384
    ds_write_b128 v6, v[116:119] offset:17408
    ds_write_b128 v6, v[120:123] offset:32768
    ds_write_b128 v6, v[124:127] offset:33792
    ds_write_b128 v6, v[128:131] offset:49152
    ds_write_b128 v6, v[132:135] offset:50176
    s_waitcnt lgkmcnt(0)
    s_barrier
    ds_read_b128 v[72:75], v7 offset:0
    ds_read_b128 v[76:79], v7 offset:1024
    ds_read_b128 v[80:83], v7 offset:2048
    ds_read_b128 v[84:87], v7 offset:3072
    ds_read_b128 v[88:91], v7 offset:4096
    ds_read_b128 v[92:95], v7 offset:5120
    ds_read_b128 v[96:99], v7 offset:6144
    ds_read_b128 v[100:103], v7 offset:7168
    ds_read_b128 v[104:107], v7 offset:8192
    ds_read_b128 v[108:111], v7 offset:9216
    ds_read_b128 v[112:115], v7 offset:10240
    ds_read_b128 v[116:119], v7 offset:11264
    ds_read_b128 v[120:123], v7 offset:12288
    ds_read_b128 v[124:127], v7 offset:13312
    ds_read_b128 v[128:131], v7 offset:14336
    ds_read_b128 v[132:135], v7 offset:15360
    s_waitcnt lgkmcnt(12)
    v_add_f32 v8, v72, v80
    v_add_f32 v9, v73, v81
    v_add_f32 v10, v74, v82
    v_add_f32 v11, v75, v83
    v_add_f32 v12, v76, v84
    v_add_f32 v13, v77, v85
    v_add_f32 v14, v78, v86
    v_add_f32 v15, v79, v87
    s_waitcnt lgkmcnt(8)
    v_add_f32 v88, v88, v96
    v_add_f32 v8, v8, v88
    v_add_f32 v89, v89, v97
    v_add_f32 v9, v9, v89
    v_add_f32 v90, v90, v98
    v_add_f32 v10, v10, v90
    v_add_f32 v91, v91, v99
    v_add_f32 v11, v11, v91
    v_add_f32 v92, v92, v100
    v_add_f32 v12, v12, v92
    v_add_f32 v93, v93, v101
    v_add_f32 v13, v13, v93
    v_add_f32 v94, v94, v102
    v_add_f32 v14, v14, v94
    v_add_f32 v95, v95, v103
    v_add_f32 v15, v15, v95
    s_waitcnt lgkmcnt(4)
    v_add_f32 v104, v104, v112
    v_add_f32 v8, v8, v104
    v_add_f32 v105, v105, v113
    v_add_f32 v9, v9, v105
    v_add_f32 v106, v106, v114
    v_add_f32 v10, v10, v106
    v_add_f32 v107, v107, v115
    v_add_f32 v11, v11, v107
    v_add_f32 v108, v108, v116
    v_add_f32 v12, v12, v108
    v_add_f32 v109, v109, v117
    v_add_f32 v13, v13, v109
    v_add_f32 v110, v110, v118
    v_add_f32 v14, v14, v110
    v_add_f32 v111, v111, v119
    v_add_f32 v15, v15, v111
    s_waitcnt lgkmcnt(0)
    v_add_f32 v120, v120, v128
    v_add_f32 v8, v8, v120
    v_add_f32 v121, v121, v129
    v_add_f32 v9, v9, v121
    v_add_f32 v122, v122, v130
    v_add_f32 v10, v10, v122
    v_add_f32 v123, v123, v131
    v_add_f32 v11, v11, v123
    v_add_f32 v124, v124, v132
    v_add_f32 v12, v12, v124
    v_add_f32 v125, v125, v133
    v_add_f32 v13, v13, v125
    v_add_f32 v126, v126, v134
    v_add_f32 v14, v14, v126
    v_add_f32 v127, v127, v135
    v_add_f32 v15, v15, v127
    v_accvgpr_read_b32 v16, a32
    v_accvgpr_read_b32 v17, a33
    v_accvgpr_read_b32 v18, a34
    v_accvgpr_read_b32 v19, a35
    v_lshlrev_b32 v20, 16, v16
    v_and_b32 v21, 0xffff0000, v16
    v_add_f32 v8, v8, v20
    v_add_f32 v9, v9, v21
    v_lshlrev_b32 v20, 16, v17
    v_and_b32 v21, 0xffff0000, v17
    v_add_f32 v10, v10, v20
    v_add_f32 v11, v11, v21
    v_lshlrev_b32 v20, 16, v18
    v_and_b32 v21, 0xffff0000, v18
    v_add_f32 v12, v12, v20
    v_add_f32 v13, v13, v21
    v_lshlrev_b32 v20, 16, v19
    v_and_b32 v21, 0xffff0000, v19
    v_add_f32 v14, v14, v20
    v_add_f32 v15, v15, v21
    v_cvt_pk_bf16_f32 v16, v8, v9
    v_cvt_pk_bf16_f32 v17, v10, v11
    v_cvt_pk_bf16_f32 v18, v12, v13
    v_cvt_pk_bf16_f32 v19, v14, v15
    s_nop 1
    v_permlane32_swap_b32 v16, v18
    v_permlane32_swap_b32 v17, v19
    v_lshlrev_b32 v5, 10, v3
    v_lshl_add_u32 v5, v4, 4, v5
    s_lshl_b32 s31, s45, 15
    s_lshl_b32 s32, s46, 6
    s_add_u32 s31, s31, s32
    s_lshl_b32 s32, s47, 5
    s_add_u32 s31, s31, s32
    buffer_store_dwordx4 v[16:19], v5, s[16:19], s31 offen
f2_kernel_end:
f2_kernel_endx:
    s_endpgm
code_end:
.section .rodata,"a"
.p2align 6
.amdhsa_kernel k0_kernel
  .amdhsa_next_free_vgpr 128
  .amdhsa_next_free_sgpr 100
  .amdhsa_accum_offset 128
  .amdhsa_group_segment_fixed_size 0
  .amdhsa_kernarg_size 88
  .amdhsa_user_sgpr_count 2
  .amdhsa_user_sgpr_kernarg_segment_ptr 1
  .amdhsa_system_sgpr_workgroup_id_x 1
.end_amdhsa_kernel
.p2align 6
.amdhsa_kernel f1_kernel
  .amdhsa_next_free_vgpr 256
  .amdhsa_next_free_sgpr 100
  .amdhsa_accum_offset 160
  .amdhsa_group_segment_fixed_size 0
  .amdhsa_kernarg_size 88
  .amdhsa_user_sgpr_count 2
  .amdhsa_user_sgpr_kernarg_segment_ptr 1
  .amdhsa_system_sgpr_workgroup_id_x 1
.end_amdhsa_kernel
.p2align 6
.amdhsa_kernel f2_kernel
  .amdhsa_next_free_vgpr 256
  .amdhsa_next_free_sgpr 100
  .amdhsa_accum_offset 160
  .amdhsa_group_segment_fixed_size 0
  .amdhsa_kernarg_size 88
  .amdhsa_user_sgpr_count 2
  .amdhsa_user_sgpr_kernarg_segment_ptr 1
  .amdhsa_system_sgpr_workgroup_id_x 1
.end_amdhsa_kernel
```
